```python
import torch

def _softmax(x, axis=-1):
    return torch.softmax(x, dim=axis)

def _gelu(x):
    return torch.nn.functional.gelu(x, approximate='tanh')

def _silu(x):
    return torch.nn.functional.silu(x)

def _sigmoid(x):
    return torch.sigmoid(x)

def _layernorm(x, axis=-1, eps=1e-05):
    m = x.mean(dim=axis, keepdim=True)
    v = x.var(dim=axis, keepdim=True, unbiased=False)
    return (x - m) / torch.sqrt(v + eps)

def _scatter_add(tgt, idx, src, axis=0):
    return tgt.clone().index_add_(axis, idx, src)

def _segment_sum(src, seg, n):
    out = torch.zeros((n,) + src.shape[1:], dtype=src.dtype)
    return out.index_add_(0, seg, src)

def _pad(x, pw):
    flat = tuple((v for pair in reversed(pw) for v in pair))
    return torch.nn.functional.pad(x, flat)
kernel_name = 'recurrent_scan__memory_aug_recurrent_mem_tr__dense_activation_squared_relu__prompt'

def setup_inputs():

    _w = lambda a: (lambda t: t.to(torch.bfloat16) if t.is_floating_point() else t)(torch.as_tensor(a))

    def _A_setup():
        B, S, Dm = (1, 2048, 640)
        H, Dh = (32, 128)
        M, seg = (8, 32)
        seg = min(seg, S)
        S = S // seg * seg
        return {'x': _w((lambda *s: torch.randn(*s, dtype=torch.bfloat16) * 0.05)(B, S, Dm)), 'mem0': _w((lambda *s: torch.randn(*s, dtype=torch.bfloat16) * 0.05)(B, M, Dm)), 'Wq': _w((lambda *s: torch.randn(*s, dtype=torch.bfloat16) * 1.6)(Dm, H, Dh) * Dm ** (-0.5)), 'Wk': _w((lambda *s: torch.randn(*s, dtype=torch.bfloat16) * 1.6)(Dm, H, Dh) * Dm ** (-0.5)), 'Wv': _w((lambda *s: torch.randn(*s, dtype=torch.bfloat16) * 0.05)(Dm, H, Dh) * Dm ** (-0.5)), 'Wo': _w((lambda *s: torch.randn(*s, dtype=torch.bfloat16) * 0.05)(H, Dh, Dm) * (H * Dh) ** (-0.5)), 'seg_len': seg}
    _A_in = _A_setup()

    def _B_setup():
        B, S, D, F = (1, 2048, 640, 1728)
        return {'x': _w((lambda *s: torch.randn(*s, dtype=torch.bfloat16) * 0.05)(B, S, D)), 'w1': _w((lambda *s: torch.randn(*s, dtype=torch.bfloat16) * 0.05)(D, F)), 'b1': _w((lambda *s: torch.randn(*s, dtype=torch.bfloat16) * 0.4)(F)), 'w2': _w((lambda *s: torch.randn(*s, dtype=torch.bfloat16) * 0.05)(F, D)), 'b2': _w((lambda *s: torch.randn(*s, dtype=torch.bfloat16) * 3.2)(D))}
    _B_in = _B_setup()
    return {'A_x': _A_in['x'], 'A_mem0': _A_in['mem0'], 'A_Wq': _A_in['Wq'], 'A_Wk': _A_in['Wk'], 'A_Wv': _A_in['Wv'], 'A_Wo': _A_in['Wo'], 'A_seg_len': _A_in['seg_len'], 'B_x': _B_in['x'], 'B_w1': _B_in['w1'], 'B_b1': _B_in['b1'], 'B_w2': _B_in['w2'], 'B_b2': _B_in['b2']}

def reference(A_x, A_mem0, A_Wq, A_Wk, A_Wv, A_Wo, A_seg_len, B_x, B_w1, B_b1, B_w2, B_b2):

    def _A_ref(x, mem0, Wq, Wk, Wv, Wo, seg_len):
        B, S, Dm = x.shape
        H, Dh = (Wq.shape[1], Wq.shape[2])
        M = mem0.shape[1]
        scale = Dh ** (-0.5)
        n_seg = S // seg_len
        L = M + seg_len
        idx = torch.arange(L)
        mask = (idx[:, None] < M) | (idx[:, None] >= idx[None, :])
        mem = mem0
        outs = []
        for s in range(n_seg):
            xs = x[:, s * seg_len:(s + 1) * seg_len, :].clone()
            h = torch.concatenate([mem, xs], axis=1)
            q = torch.einsum('btd,dhe->bhte', h, Wq)
            k = torch.einsum('btd,dhe->bhte', h, Wk)
            v = torch.einsum('btd,dhe->bhte', h, Wv)
            scores = torch.einsum('bhqe,bhke->bhqk', q, k) * scale
            scores = torch.where(mask[None, None], scores, -1000000000.0)
            p = _softmax(scores, axis=-1)
            o = torch.einsum('bhqk,bhke->bhqe', p, v)
            o = torch.einsum('bhte,hed->btd', o, Wo)
            mem = o[:, :M, :].clone()
            outs.append(o[:, M:, :])
        return torch.concatenate(outs, axis=1)

    def _B_ref(x, w1, b1, w2, b2):
        h = torch.einsum('bsd,df->bsf', x, w1) + b1
        zero = torch.zeros_like(h)
        r = torch.where(h > zero, h, zero)
        h = r * r
        out = torch.einsum('bsf,fd->bsd', h, w2) + b2
        return out
    x = A_x
    xn = _layernorm(x, axis=-1)
    s = _A_ref(xn, A_mem0, A_Wq, A_Wk, A_Wv, A_Wo, A_seg_len)
    g = _silu(_B_ref(xn, B_w1, B_b1, B_w2, B_b2))
    return x + s * g
```

```asm
; @launch kernel=ln_init_kernel grid=(488,1,1) block=(256,1,1) lds=2048
; @launch kernel=mega_kernel grid=(256,1,1) block=(512,1,1) lds=163840
.amdgcn_target "amdgcn-amd-amdhsa--gfx950"
.text
.globl ln_init_kernel
.p2align 8
.type ln_init_kernel,@function
ln_init_kernel:
    s_cmp_ge_u32 s2, 488
    s_cbranch_scc1 K0_done
    s_load_dwordx2 s[4:5], s[0:1], 0
    s_load_dwordx2 s[6:7], s[0:1], 8
    s_load_dwordx2 s[8:9], s[0:1], 112
    s_waitcnt lgkmcnt(0)
    v_lshlrev_b32 v1, 4, v0
    s_cmp_lt_u32 s2, 136
    s_cbranch_scc1 K0_nz
    s_add_u32 s12, s8, 0x4d00000
    s_addc_u32 s13, s9, 0
    s_mov_b32 s14, 0x1600000
    s_mov_b32 s15, 0x20000
    s_sub_u32 s3, s2, 136
    s_lshl_b32 s3, s3, 16
    v_mov_b32 v4, -1
    v_mov_b32 v5, -1
    v_mov_b32 v6, -1
    v_mov_b32 v7, -1
    buffer_store_dwordx4 v[4:7], v1, s[12:15], s3 offen
    s_add_u32 s3, s3, 4096
    buffer_store_dwordx4 v[4:7], v1, s[12:15], s3 offen
    s_add_u32 s3, s3, 4096
    buffer_store_dwordx4 v[4:7], v1, s[12:15], s3 offen
    s_add_u32 s3, s3, 4096
    buffer_store_dwordx4 v[4:7], v1, s[12:15], s3 offen
    s_add_u32 s3, s3, 4096
    buffer_store_dwordx4 v[4:7], v1, s[12:15], s3 offen
    s_add_u32 s3, s3, 4096
    buffer_store_dwordx4 v[4:7], v1, s[12:15], s3 offen
    s_add_u32 s3, s3, 4096
    buffer_store_dwordx4 v[4:7], v1, s[12:15], s3 offen
    s_add_u32 s3, s3, 4096
    buffer_store_dwordx4 v[4:7], v1, s[12:15], s3 offen
    s_add_u32 s3, s3, 4096
    buffer_store_dwordx4 v[4:7], v1, s[12:15], s3 offen
    s_add_u32 s3, s3, 4096
    buffer_store_dwordx4 v[4:7], v1, s[12:15], s3 offen
    s_add_u32 s3, s3, 4096
    buffer_store_dwordx4 v[4:7], v1, s[12:15], s3 offen
    s_add_u32 s3, s3, 4096
    buffer_store_dwordx4 v[4:7], v1, s[12:15], s3 offen
    s_add_u32 s3, s3, 4096
    buffer_store_dwordx4 v[4:7], v1, s[12:15], s3 offen
    s_add_u32 s3, s3, 4096
    buffer_store_dwordx4 v[4:7], v1, s[12:15], s3 offen
    s_add_u32 s3, s3, 4096
    buffer_store_dwordx4 v[4:7], v1, s[12:15], s3 offen
    s_add_u32 s3, s3, 4096
    buffer_store_dwordx4 v[4:7], v1, s[12:15], s3 offen
    s_cmp_lg_u32 s2, 140
    s_cbranch_scc1 K0_nz
    s_add_u32 s12, s8, 0x7200000
    s_addc_u32 s13, s9, 0
    s_mov_b32 s14, 0xa000
    s_mov_b32 s15, 0x20000
    v_mov_b32 v4, 0
    v_mov_b32 v5, 0
    v_mov_b32 v6, 0
    v_mov_b32 v7, 0
    s_mov_b32 s3, 0
    buffer_store_dwordx4 v[4:7], v1, s[12:15], s3 offen
    s_mov_b32 s3, 4096
    buffer_store_dwordx4 v[4:7], v1, s[12:15], s3 offen
    s_mov_b32 s3, 8192
    buffer_store_dwordx4 v[4:7], v1, s[12:15], s3 offen
    s_mov_b32 s3, 12288
    buffer_store_dwordx4 v[4:7], v1, s[12:15], s3 offen
    s_mov_b32 s3, 16384
    buffer_store_dwordx4 v[4:7], v1, s[12:15], s3 offen
    s_mov_b32 s3, 20480
    buffer_store_dwordx4 v[4:7], v1, s[12:15], s3 offen
    s_mov_b32 s3, 24576
    buffer_store_dwordx4 v[4:7], v1, s[12:15], s3 offen
    s_mov_b32 s3, 28672
    buffer_store_dwordx4 v[4:7], v1, s[12:15], s3 offen
    s_mov_b32 s3, 32768
    buffer_store_dwordx4 v[4:7], v1, s[12:15], s3 offen
    s_mov_b32 s3, 36864
    buffer_store_dwordx4 v[4:7], v1, s[12:15], s3 offen
K0_nz:
    s_cmp_lt_u32 s2, 128
    s_cbranch_scc1 K0_ln
    s_cmp_ge_u32 s2, 136
    s_cbranch_scc1 K0_done
    s_mov_b32 s16, s6
    s_mov_b32 s17, s7
    s_mov_b32 s18, 0x2800
    s_mov_b32 s19, 0x20000
    s_sub_u32 s3, s2, 128
    s_mul_i32 s3, s3, 10240
    s_add_u32 s3, s3, 0x4cec000
    s_add_u32 s20, s8, s3
    s_addc_u32 s21, s9, 0
    s_mov_b32 s22, 10240
    s_mov_b32 s23, 0x20000
    v_and_b32 v20, 7, v0
    v_mul_u32_u24 v20, 1280, v20
    v_bfe_u32 v21, v0, 3, 1
    v_lshl_add_u32 v20, v21, 6, v20
    v_bfe_u32 v21, v0, 4, 2
    v_lshl_add_u32 v20, v21, 4, v20
    v_lshrrev_b32 v21, 6, v0
    v_lshl_add_u32 v20, v21, 7, v20
    buffer_load_dwordx4 v[8:11], v20, s[16:19], 0 offen offset:0
    buffer_load_dwordx4 v[12:15], v20, s[16:19], 0 offen offset:512
    buffer_load_dwordx4 v[16:19], v20, s[16:19], 0 offen offset:1024
    v_add_u32 v3, 4096, v1
    v_add_u32 v4, 8192, v1
    s_waitcnt vmcnt(0)
    v_min_u32 v8, -2, v8
    v_min_u32 v9, -2, v9
    v_min_u32 v10, -2, v10
    v_min_u32 v11, -2, v11
    v_min_u32 v12, -2, v12
    v_min_u32 v13, -2, v13
    v_min_u32 v14, -2, v14
    v_min_u32 v15, -2, v15
    v_min_u32 v16, -2, v16
    v_min_u32 v17, -2, v17
    v_min_u32 v18, -2, v18
    v_min_u32 v19, -2, v19
    buffer_store_dwordx4 v[8:11], v1, s[20:23], 0 offen
    buffer_store_dwordx4 v[12:15], v3, s[20:23], 0 offen
    buffer_store_dwordx4 v[16:19], v4, s[20:23], 0 offen
    s_branch K0_done
K0_ln:
    s_mov_b32 s16, s4
    s_mov_b32 s17, s5
    s_mov_b32 s18, 0x280000
    s_mov_b32 s19, 0x20000
    s_mov_b32 s20, s8
    s_mov_b32 s21, s9
    s_mov_b32 s22, 0x280000
    s_mov_b32 s23, 0x20000
    v_and_b32 v1, 63, v0
    v_lshrrev_b32 v2, 6, v0
    v_and_b32 v3, 15, v1
    v_lshrrev_b32 v4, 4, v1
    v_mul_u32_u24 v5, 1280, v3
    v_lshl_add_u32 v5, v4, 3, v5
    v_mul_u32_u24 v6, 320, v2
    v_add_u32 v5, v5, v6
    s_mul_i32 s3, s2, 20480
    buffer_load_dwordx2 v[10:11], v5, s[16:19], s3 offen offset:0
    buffer_load_dwordx2 v[12:13], v5, s[16:19], s3 offen offset:32
    buffer_load_dwordx2 v[14:15], v5, s[16:19], s3 offen offset:64
    buffer_load_dwordx2 v[16:17], v5, s[16:19], s3 offen offset:96
    buffer_load_dwordx2 v[18:19], v5, s[16:19], s3 offen offset:128
    buffer_load_dwordx2 v[20:21], v5, s[16:19], s3 offen offset:160
    buffer_load_dwordx2 v[22:23], v5, s[16:19], s3 offen offset:192
    buffer_load_dwordx2 v[24:25], v5, s[16:19], s3 offen offset:224
    buffer_load_dwordx2 v[26:27], v5, s[16:19], s3 offen offset:256
    buffer_load_dwordx2 v[28:29], v5, s[16:19], s3 offen offset:288
    v_lshlrev_b32 v7, 6, v3
    v_lshl_add_u32 v8, v2, 4, v7
    v_lshl_add_u32 v8, v4, 2, v8
    s_waitcnt vmcnt(0)
    v_lshlrev_b32 v32, 16, v10
    v_and_b32 v33, 0xffff0000, v10
    v_lshlrev_b32 v34, 16, v11
    v_and_b32 v35, 0xffff0000, v11
    v_lshlrev_b32 v36, 16, v12
    v_and_b32 v37, 0xffff0000, v12
    v_lshlrev_b32 v38, 16, v13
    v_and_b32 v39, 0xffff0000, v13
    v_lshlrev_b32 v40, 16, v14
    v_and_b32 v41, 0xffff0000, v14
    v_lshlrev_b32 v42, 16, v15
    v_and_b32 v43, 0xffff0000, v15
    v_lshlrev_b32 v44, 16, v16
    v_and_b32 v45, 0xffff0000, v16
    v_lshlrev_b32 v46, 16, v17
    v_and_b32 v47, 0xffff0000, v17
    v_lshlrev_b32 v48, 16, v18
    v_and_b32 v49, 0xffff0000, v18
    v_lshlrev_b32 v50, 16, v19
    v_and_b32 v51, 0xffff0000, v19
    v_lshlrev_b32 v52, 16, v20
    v_and_b32 v53, 0xffff0000, v20
    v_lshlrev_b32 v54, 16, v21
    v_and_b32 v55, 0xffff0000, v21
    v_lshlrev_b32 v56, 16, v22
    v_and_b32 v57, 0xffff0000, v22
    v_lshlrev_b32 v58, 16, v23
    v_and_b32 v59, 0xffff0000, v23
    v_lshlrev_b32 v60, 16, v24
    v_and_b32 v61, 0xffff0000, v24
    v_lshlrev_b32 v62, 16, v25
    v_and_b32 v63, 0xffff0000, v25
    v_lshlrev_b32 v64, 16, v26
    v_and_b32 v65, 0xffff0000, v26
    v_lshlrev_b32 v66, 16, v27
    v_and_b32 v67, 0xffff0000, v27
    v_lshlrev_b32 v68, 16, v28
    v_and_b32 v69, 0xffff0000, v28
    v_lshlrev_b32 v70, 16, v29
    v_and_b32 v71, 0xffff0000, v29
    v_add_f32 v9, v32, v33
    v_add_f32 v9, v9, v34
    v_add_f32 v9, v9, v35
    v_add_f32 v9, v9, v36
    v_add_f32 v9, v9, v37
    v_add_f32 v9, v9, v38
    v_add_f32 v9, v9, v39
    v_add_f32 v9, v9, v40
    v_add_f32 v9, v9, v41
    v_add_f32 v9, v9, v42
    v_add_f32 v9, v9, v43
    v_add_f32 v9, v9, v44
    v_add_f32 v9, v9, v45
    v_add_f32 v9, v9, v46
    v_add_f32 v9, v9, v47
    v_add_f32 v9, v9, v48
    v_add_f32 v9, v9, v49
    v_add_f32 v9, v9, v50
    v_add_f32 v9, v9, v51
    v_add_f32 v9, v9, v52
    v_add_f32 v9, v9, v53
    v_add_f32 v9, v9, v54
    v_add_f32 v9, v9, v55
    v_add_f32 v9, v9, v56
    v_add_f32 v9, v9, v57
    v_add_f32 v9, v9, v58
    v_add_f32 v9, v9, v59
    v_add_f32 v9, v9, v60
    v_add_f32 v9, v9, v61
    v_add_f32 v9, v9, v62
    v_add_f32 v9, v9, v63
    v_add_f32 v9, v9, v64
    v_add_f32 v9, v9, v65
    v_add_f32 v9, v9, v66
    v_add_f32 v9, v9, v67
    v_add_f32 v9, v9, v68
    v_add_f32 v9, v9, v69
    v_add_f32 v9, v9, v70
    v_add_f32 v9, v9, v71
    ds_write_b32 v8, v9
    s_waitcnt lgkmcnt(0)
    s_barrier
    ds_read_b128 v[72:75], v7 offset:0
    ds_read_b128 v[76:79], v7 offset:16
    ds_read_b128 v[80:83], v7 offset:32
    ds_read_b128 v[84:87], v7 offset:48
    s_waitcnt lgkmcnt(0)
    v_add_f32 v9, v72, v73
    v_add_f32 v9, v9, v74
    v_add_f32 v9, v9, v75
    v_add_f32 v9, v9, v76
    v_add_f32 v9, v9, v77
    v_add_f32 v9, v9, v78
    v_add_f32 v9, v9, v79
    v_add_f32 v9, v9, v80
    v_add_f32 v9, v9, v81
    v_add_f32 v9, v9, v82
    v_add_f32 v9, v9, v83
    v_add_f32 v9, v9, v84
    v_add_f32 v9, v9, v85
    v_add_f32 v9, v9, v86
    v_add_f32 v9, v9, v87
    v_mul_f32 v9, 0x3acccccd, v9
    v_sub_f32 v30, v32, v9
    v_mul_f32 v31, v30, v30
    v_sub_f32 v30, v33, v9
    v_fmac_f32 v31, v30, v30
    v_sub_f32 v30, v34, v9
    v_fmac_f32 v31, v30, v30
    v_sub_f32 v30, v35, v9
    v_fmac_f32 v31, v30, v30
    v_sub_f32 v30, v36, v9
    v_fmac_f32 v31, v30, v30
    v_sub_f32 v30, v37, v9
    v_fmac_f32 v31, v30, v30
    v_sub_f32 v30, v38, v9
    v_fmac_f32 v31, v30, v30
    v_sub_f32 v30, v39, v9
    v_fmac_f32 v31, v30, v30
    v_sub_f32 v30, v40, v9
    v_fmac_f32 v31, v30, v30
    v_sub_f32 v30, v41, v9
    v_fmac_f32 v31, v30, v30
    v_sub_f32 v30, v42, v9
    v_fmac_f32 v31, v30, v30
    v_sub_f32 v30, v43, v9
    v_fmac_f32 v31, v30, v30
    v_sub_f32 v30, v44, v9
    v_fmac_f32 v31, v30, v30
    v_sub_f32 v30, v45, v9
    v_fmac_f32 v31, v30, v30
    v_sub_f32 v30, v46, v9
    v_fmac_f32 v31, v30, v30
    v_sub_f32 v30, v47, v9
    v_fmac_f32 v31, v30, v30
    v_sub_f32 v30, v48, v9
    v_fmac_f32 v31, v30, v30
    v_sub_f32 v30, v49, v9
    v_fmac_f32 v31, v30, v30
    v_sub_f32 v30, v50, v9
    v_fmac_f32 v31, v30, v30
    v_sub_f32 v30, v51, v9
    v_fmac_f32 v31, v30, v30
    v_sub_f32 v30, v52, v9
    v_fmac_f32 v31, v30, v30
    v_sub_f32 v30, v53, v9
    v_fmac_f32 v31, v30, v30
    v_sub_f32 v30, v54, v9
    v_fmac_f32 v31, v30, v30
    v_sub_f32 v30, v55, v9
    v_fmac_f32 v31, v30, v30
    v_sub_f32 v30, v56, v9
    v_fmac_f32 v31, v30, v30
    v_sub_f32 v30, v57, v9
    v_fmac_f32 v31, v30, v30
    v_sub_f32 v30, v58, v9
    v_fmac_f32 v31, v30, v30
    v_sub_f32 v30, v59, v9
    v_fmac_f32 v31, v30, v30
    v_sub_f32 v30, v60, v9
    v_fmac_f32 v31, v30, v30
    v_sub_f32 v30, v61, v9
    v_fmac_f32 v31, v30, v30
    v_sub_f32 v30, v62, v9
    v_fmac_f32 v31, v30, v30
    v_sub_f32 v30, v63, v9
    v_fmac_f32 v31, v30, v30
    v_sub_f32 v30, v64, v9
    v_fmac_f32 v31, v30, v30
    v_sub_f32 v30, v65, v9
    v_fmac_f32 v31, v30, v30
    v_sub_f32 v30, v66, v9
    v_fmac_f32 v31, v30, v30
    v_sub_f32 v30, v67, v9
    v_fmac_f32 v31, v30, v30
    v_sub_f32 v30, v68, v9
    v_fmac_f32 v31, v30, v30
    v_sub_f32 v30, v69, v9
    v_fmac_f32 v31, v30, v30
    v_sub_f32 v30, v70, v9
    v_fmac_f32 v31, v30, v30
    v_sub_f32 v30, v71, v9
    v_fmac_f32 v31, v30, v30
    ds_write_b32 v8, v31 offset:1024
    s_waitcnt lgkmcnt(0)
    s_barrier
    ds_read_b128 v[72:75], v7 offset:1024
    ds_read_b128 v[76:79], v7 offset:1040
    ds_read_b128 v[80:83], v7 offset:1056
    ds_read_b128 v[84:87], v7 offset:1072
    s_waitcnt lgkmcnt(0)
    v_add_f32 v31, v72, v73
    v_add_f32 v31, v31, v74
    v_add_f32 v31, v31, v75
    v_add_f32 v31, v31, v76
    v_add_f32 v31, v31, v77
    v_add_f32 v31, v31, v78
    v_add_f32 v31, v31, v79
    v_add_f32 v31, v31, v80
    v_add_f32 v31, v31, v81
    v_add_f32 v31, v31, v82
    v_add_f32 v31, v31, v83
    v_add_f32 v31, v31, v84
    v_add_f32 v31, v31, v85
    v_add_f32 v31, v31, v86
    v_add_f32 v31, v31, v87
    v_mul_f32 v31, 0x3acccccd, v31
    v_cvt_pk_bf16_f32 v30, v9, v31
    v_lshlrev_b32 v9, 16, v30
    v_and_b32 v31, 0xffff0000, v30
    v_add_f32 v31, 0x3727c5ac, v31
    v_cvt_pk_bf16_f32 v30, v31, v31
    v_lshlrev_b32 v31, 16, v30
    v_sqrt_f32 v31, v31
    s_nop 0
    v_cvt_pk_bf16_f32 v30, v31, v31
    v_lshlrev_b32 v31, 16, v30
    v_rcp_f32 v31, v31
    s_nop 0
    v_sub_f32 v72, v32, v9
    v_sub_f32 v73, v33, v9
    v_cvt_pk_bf16_f32 v74, v72, v73
    v_lshlrev_b32 v72, 16, v74
    v_and_b32 v73, 0xffff0000, v74
    v_mul_f32 v72, v72, v31
    v_mul_f32 v73, v73, v31
    v_cvt_pk_bf16_f32 v10, v72, v73
    v_sub_f32 v72, v34, v9
    v_sub_f32 v73, v35, v9
    v_cvt_pk_bf16_f32 v74, v72, v73
    v_lshlrev_b32 v72, 16, v74
    v_and_b32 v73, 0xffff0000, v74
    v_mul_f32 v72, v72, v31
    v_mul_f32 v73, v73, v31
    v_cvt_pk_bf16_f32 v11, v72, v73
    v_sub_f32 v72, v36, v9
    v_sub_f32 v73, v37, v9
    v_cvt_pk_bf16_f32 v74, v72, v73
    v_lshlrev_b32 v72, 16, v74
    v_and_b32 v73, 0xffff0000, v74
    v_mul_f32 v72, v72, v31
    v_mul_f32 v73, v73, v31
    v_cvt_pk_bf16_f32 v12, v72, v73
    v_sub_f32 v72, v38, v9
    v_sub_f32 v73, v39, v9
    v_cvt_pk_bf16_f32 v74, v72, v73
    v_lshlrev_b32 v72, 16, v74
    v_and_b32 v73, 0xffff0000, v74
    v_mul_f32 v72, v72, v31
    v_mul_f32 v73, v73, v31
    v_cvt_pk_bf16_f32 v13, v72, v73
    v_sub_f32 v72, v40, v9
    v_sub_f32 v73, v41, v9
    v_cvt_pk_bf16_f32 v74, v72, v73
    v_lshlrev_b32 v72, 16, v74
    v_and_b32 v73, 0xffff0000, v74
    v_mul_f32 v72, v72, v31
    v_mul_f32 v73, v73, v31
    v_cvt_pk_bf16_f32 v14, v72, v73
    v_sub_f32 v72, v42, v9
    v_sub_f32 v73, v43, v9
    v_cvt_pk_bf16_f32 v74, v72, v73
    v_lshlrev_b32 v72, 16, v74
    v_and_b32 v73, 0xffff0000, v74
    v_mul_f32 v72, v72, v31
    v_mul_f32 v73, v73, v31
    v_cvt_pk_bf16_f32 v15, v72, v73
    v_sub_f32 v72, v44, v9
    v_sub_f32 v73, v45, v9
    v_cvt_pk_bf16_f32 v74, v72, v73
    v_lshlrev_b32 v72, 16, v74
    v_and_b32 v73, 0xffff0000, v74
    v_mul_f32 v72, v72, v31
    v_mul_f32 v73, v73, v31
    v_cvt_pk_bf16_f32 v16, v72, v73
    v_sub_f32 v72, v46, v9
    v_sub_f32 v73, v47, v9
    v_cvt_pk_bf16_f32 v74, v72, v73
    v_lshlrev_b32 v72, 16, v74
    v_and_b32 v73, 0xffff0000, v74
    v_mul_f32 v72, v72, v31
    v_mul_f32 v73, v73, v31
    v_cvt_pk_bf16_f32 v17, v72, v73
    v_sub_f32 v72, v48, v9
    v_sub_f32 v73, v49, v9
    v_cvt_pk_bf16_f32 v74, v72, v73
    v_lshlrev_b32 v72, 16, v74
    v_and_b32 v73, 0xffff0000, v74
    v_mul_f32 v72, v72, v31
    v_mul_f32 v73, v73, v31
    v_cvt_pk_bf16_f32 v18, v72, v73
    v_sub_f32 v72, v50, v9
    v_sub_f32 v73, v51, v9
    v_cvt_pk_bf16_f32 v74, v72, v73
    v_lshlrev_b32 v72, 16, v74
    v_and_b32 v73, 0xffff0000, v74
    v_mul_f32 v72, v72, v31
    v_mul_f32 v73, v73, v31
    v_cvt_pk_bf16_f32 v19, v72, v73
    v_sub_f32 v72, v52, v9
    v_sub_f32 v73, v53, v9
    v_cvt_pk_bf16_f32 v74, v72, v73
    v_lshlrev_b32 v72, 16, v74
    v_and_b32 v73, 0xffff0000, v74
    v_mul_f32 v72, v72, v31
    v_mul_f32 v73, v73, v31
    v_cvt_pk_bf16_f32 v20, v72, v73
    v_sub_f32 v72, v54, v9
    v_sub_f32 v73, v55, v9
    v_cvt_pk_bf16_f32 v74, v72, v73
    v_lshlrev_b32 v72, 16, v74
    v_and_b32 v73, 0xffff0000, v74
    v_mul_f32 v72, v72, v31
    v_mul_f32 v73, v73, v31
    v_cvt_pk_bf16_f32 v21, v72, v73
    v_sub_f32 v72, v56, v9
    v_sub_f32 v73, v57, v9
    v_cvt_pk_bf16_f32 v74, v72, v73
    v_lshlrev_b32 v72, 16, v74
    v_and_b32 v73, 0xffff0000, v74
    v_mul_f32 v72, v72, v31
    v_mul_f32 v73, v73, v31
    v_cvt_pk_bf16_f32 v22, v72, v73
    v_sub_f32 v72, v58, v9
    v_sub_f32 v73, v59, v9
    v_cvt_pk_bf16_f32 v74, v72, v73
    v_lshlrev_b32 v72, 16, v74
    v_and_b32 v73, 0xffff0000, v74
    v_mul_f32 v72, v72, v31
    v_mul_f32 v73, v73, v31
    v_cvt_pk_bf16_f32 v23, v72, v73
    v_sub_f32 v72, v60, v9
    v_sub_f32 v73, v61, v9
    v_cvt_pk_bf16_f32 v74, v72, v73
    v_lshlrev_b32 v72, 16, v74
    v_and_b32 v73, 0xffff0000, v74
    v_mul_f32 v72, v72, v31
    v_mul_f32 v73, v73, v31
    v_cvt_pk_bf16_f32 v24, v72, v73
    v_sub_f32 v72, v62, v9
    v_sub_f32 v73, v63, v9
    v_cvt_pk_bf16_f32 v74, v72, v73
    v_lshlrev_b32 v72, 16, v74
    v_and_b32 v73, 0xffff0000, v74
    v_mul_f32 v72, v72, v31
    v_mul_f32 v73, v73, v31
    v_cvt_pk_bf16_f32 v25, v72, v73
    v_sub_f32 v72, v64, v9
    v_sub_f32 v73, v65, v9
    v_cvt_pk_bf16_f32 v74, v72, v73
    v_lshlrev_b32 v72, 16, v74
    v_and_b32 v73, 0xffff0000, v74
    v_mul_f32 v72, v72, v31
    v_mul_f32 v73, v73, v31
    v_cvt_pk_bf16_f32 v26, v72, v73
    v_sub_f32 v72, v66, v9
    v_sub_f32 v73, v67, v9
    v_cvt_pk_bf16_f32 v74, v72, v73
    v_lshlrev_b32 v72, 16, v74
    v_and_b32 v73, 0xffff0000, v74
    v_mul_f32 v72, v72, v31
    v_mul_f32 v73, v73, v31
    v_cvt_pk_bf16_f32 v27, v72, v73
    v_sub_f32 v72, v68, v9
    v_sub_f32 v73, v69, v9
    v_cvt_pk_bf16_f32 v74, v72, v73
    v_lshlrev_b32 v72, 16, v74
    v_and_b32 v73, 0xffff0000, v74
    v_mul_f32 v72, v72, v31
    v_mul_f32 v73, v73, v31
    v_cvt_pk_bf16_f32 v28, v72, v73
    v_sub_f32 v72, v70, v9
    v_sub_f32 v73, v71, v9
    v_cvt_pk_bf16_f32 v74, v72, v73
    v_lshlrev_b32 v72, 16, v74
    v_and_b32 v73, 0xffff0000, v74
    v_mul_f32 v72, v72, v31
    v_mul_f32 v73, v73, v31
    v_cvt_pk_bf16_f32 v29, v72, v73
    v_mul_u32_u24 v6, 5120, v2
    v_lshl_add_u32 v6, v1, 4, v6
    buffer_store_dwordx4 v[10:13], v6, s[20:23], s3 offen offset:0
    buffer_store_dwordx4 v[14:17], v6, s[20:23], s3 offen offset:1024
    buffer_store_dwordx4 v[18:21], v6, s[20:23], s3 offen offset:2048
    buffer_store_dwordx4 v[22:25], v6, s[20:23], s3 offen offset:3072
    v_add_u32 v6, 4096, v6
    buffer_store_dwordx4 v[26:29], v6, s[20:23], s3 offen
K0_done:
    s_endpgm
.text
.globl mega_kernel
.p2align 8
.type mega_kernel,@function
mega_kernel:
    s_cmp_ge_u32 s2, 256
    s_cbranch_scc1 M_done0
    s_load_dwordx8 s[48:55], s[0:1], 16
    s_load_dwordx4 s[56:59], s[0:1], 104
    v_lshrrev_b32 v1, 6, v0
    s_nop 0
    v_readfirstlane_b32 s33, v1
    v_and_b32 v0, 63, v0
    s_mov_b32 s44, 0x40000
    s_waitcnt lgkmcnt(0)
    s_cmp_lg_u32 s33, 0
    s_cbranch_scc1 R_wait_role
    s_add_u32 s4, s58, 0x7208800
    s_addc_u32 s5, s59, 0
    s_mov_b32 s6, 0x400
    s_mov_b32 s7, 0x20000
    s_getreg_b32 s40, hwreg(HW_REG_XCC_ID)
    s_and_b32 s40, s40, 7
    s_mov_b64 exec, 1
    s_lshl_b32 s3, s40, 7
    v_mov_b32 v1, s3
    v_mov_b32 v2, 1
    buffer_atomic_add v2, v1, s[4:7], 0 offen sc0
    s_waitcnt vmcnt(0)
    v_readfirstlane_b32 s41, v2
    s_mov_b64 exec, 0xff
    v_lshlrev_b32 v1, 7, v0
R_poll:
    s_sub_u32 s44, s44, 1
    s_cbranch_scc1 M_done0
    buffer_load_dword v4, v1, s[4:7], 0 offen sc1
    s_waitcnt vmcnt(0)
    s_mov_b32 s3, 0
    s_mov_b32 s45, 0
    v_readlane_b32 s8, v4, 0
    s_cmp_gt_u32 s40, 0
    s_cselect_b32 s9, s8, 0
    s_add_u32 s45, s45, s9
    s_add_u32 s3, s3, s8
    v_readlane_b32 s8, v4, 1
    s_cmp_gt_u32 s40, 1
    s_cselect_b32 s9, s8, 0
    s_add_u32 s45, s45, s9
    s_add_u32 s3, s3, s8
    v_readlane_b32 s8, v4, 2
    s_cmp_gt_u32 s40, 2
    s_cselect_b32 s9, s8, 0
    s_add_u32 s45, s45, s9
    s_add_u32 s3, s3, s8
    v_readlane_b32 s8, v4, 3
    s_cmp_gt_u32 s40, 3
    s_cselect_b32 s9, s8, 0
    s_add_u32 s45, s45, s9
    s_add_u32 s3, s3, s8
    v_readlane_b32 s8, v4, 4
    s_cmp_gt_u32 s40, 4
    s_cselect_b32 s9, s8, 0
    s_add_u32 s45, s45, s9
    s_add_u32 s3, s3, s8
    v_readlane_b32 s8, v4, 5
    s_cmp_gt_u32 s40, 5
    s_cselect_b32 s9, s8, 0
    s_add_u32 s45, s45, s9
    s_add_u32 s3, s3, s8
    v_readlane_b32 s8, v4, 6
    s_cmp_gt_u32 s40, 6
    s_cselect_b32 s9, s8, 0
    s_add_u32 s45, s45, s9
    s_add_u32 s3, s3, s8
    v_readlane_b32 s8, v4, 7
    s_cmp_gt_u32 s40, 7
    s_cselect_b32 s9, s8, 0
    s_add_u32 s45, s45, s9
    s_add_u32 s3, s3, s8
    s_cmp_lt_u32 s3, 256
    s_cbranch_scc1 R_poll
    s_add_u32 s45, s45, s41
    v_cmp_ne_u32 vcc, 32, v4
    s_mov_b32 s42, 0
    s_cmp_eq_u64 vcc, 0
    s_cbranch_scc1 R_fast
    s_mov_b32 s42, 1
    s_lshr_b32 s40, s45, 5
    s_and_b32 s41, s45, 31
R_fast:
    s_mov_b64 exec, 1
    v_mov_b32 v4, s40
    v_mov_b32 v5, s41
    v_mov_b32 v6, s42
    v_mov_b32 v7, 0
    v_mov_b32 v1, 0
    ds_write_b128 v1, v[4:7]
    s_waitcnt lgkmcnt(0)
    s_mov_b64 exec, -1
R_wait_role:
    s_barrier
    v_mov_b32 v1, 0
    ds_read_b128 v[4:7], v1
    s_waitcnt lgkmcnt(0)
    v_readfirstlane_b32 s40, v4
    v_readfirstlane_b32 s41, v5
    v_readfirstlane_b32 s42, v6
    s_and_b32 s40, s40, 7
    s_and_b32 s41, s41, 31
    s_cmp_ge_u32 s41, 16
    s_cbranch_scc1 M_worker
    s_mov_b32 s43, 0
    s_cmp_lt_u32 s33, 4
    s_cbranch_scc1 C_attn
    s_cmp_eq_u32 s33, 7
    s_cbranch_scc1 C_red
    s_cmp_eq_u32 s33, 4
    s_cselect_b32 s4, s48, s50
    s_cselect_b32 s5, s49, s51
    s_cmp_eq_u32 s33, 6
    s_cselect_b32 s4, s52, s4
    s_cselect_b32 s5, s53, s5
    s_mov_b32 s6, 5242880
    s_mov_b32 s7, 0x20000
    s_lshr_b32 s46, s41, 2
    s_lshl_b32 s3, s40, 2
    s_add_u32 s46, s46, s3
    s_and_b32 s47, s41, 3
    v_lshlrev_b32 v216, 4, v0
    s_lshl_b32 s3, s46, 8
    s_lshl_b32 s8, s47, 6
    s_add_u32 s3, s3, s8
    v_lshrrev_b32 v240, 2, v0
    v_lshlrev_b32 v240, 13, v240
    v_and_b32 v239, 3, v0
    v_lshl_add_u32 v240, v239, 4, v240
    v_add_u32 v240, s3, v240
    s_sub_u32 s8, s33, 4
    s_mul_i32 s8, s8, 20480
    s_add_u32 s8, s8, 16384
    v_lshrrev_b32 v238, 4, v0
    v_bfe_u32 v237, v0, 2, 2
    v_lshl_add_u32 v238, v238, 3, v237
    v_lshlrev_b32 v238, 6, v238
    v_lshl_add_u32 v238, v239, 3, v238
    v_add_u32 v238, s8, v238
    s_add_u32 m0, s8, 0
    s_mov_b32 s3, 0
    buffer_load_dwordx4 v240, s[4:7], s3 offen lds
    s_add_u32 m0, s8, 1024
    s_mov_b32 s3, 131072
    buffer_load_dwordx4 v240, s[4:7], s3 offen lds
    s_add_u32 m0, s8, 2048
    s_mov_b32 s3, 262144
    buffer_load_dwordx4 v240, s[4:7], s3 offen lds
    s_add_u32 m0, s8, 3072
    s_mov_b32 s3, 393216
    buffer_load_dwordx4 v240, s[4:7], s3 offen lds
    s_add_u32 m0, s8, 4096
    s_mov_b32 s3, 524288
    buffer_load_dwordx4 v240, s[4:7], s3 offen lds
    s_add_u32 m0, s8, 5120
    s_mov_b32 s3, 655360
    buffer_load_dwordx4 v240, s[4:7], s3 offen lds
    s_add_u32 m0, s8, 6144
    s_mov_b32 s3, 786432
    buffer_load_dwordx4 v240, s[4:7], s3 offen lds
    s_add_u32 m0, s8, 7168
    s_mov_b32 s3, 917504
    buffer_load_dwordx4 v240, s[4:7], s3 offen lds
    s_add_u32 m0, s8, 8192
    s_mov_b32 s3, 1048576
    buffer_load_dwordx4 v240, s[4:7], s3 offen lds
    s_add_u32 m0, s8, 9216
    s_mov_b32 s3, 1179648
    buffer_load_dwordx4 v240, s[4:7], s3 offen lds
    s_add_u32 m0, s8, 10240
    s_mov_b32 s3, 1310720
    buffer_load_dwordx4 v240, s[4:7], s3 offen lds
    s_add_u32 m0, s8, 11264
    s_mov_b32 s3, 1441792
    buffer_load_dwordx4 v240, s[4:7], s3 offen lds
    s_add_u32 m0, s8, 12288
    s_mov_b32 s3, 1572864
    buffer_load_dwordx4 v240, s[4:7], s3 offen lds
    s_add_u32 m0, s8, 13312
    s_mov_b32 s3, 1703936
    buffer_load_dwordx4 v240, s[4:7], s3 offen lds
    s_add_u32 m0, s8, 14336
    s_mov_b32 s3, 1835008
    buffer_load_dwordx4 v240, s[4:7], s3 offen lds
    s_add_u32 m0, s8, 15360
    s_mov_b32 s3, 1966080
    buffer_load_dwordx4 v240, s[4:7], s3 offen lds
    s_add_u32 m0, s8, 16384
    s_mov_b32 s3, 2097152
    buffer_load_dwordx4 v240, s[4:7], s3 offen lds
    s_add_u32 m0, s8, 17408
    s_mov_b32 s3, 2228224
    buffer_load_dwordx4 v240, s[4:7], s3 offen lds
    s_add_u32 m0, s8, 18432
    s_mov_b32 s3, 2359296
    buffer_load_dwordx4 v240, s[4:7], s3 offen lds
    s_add_u32 m0, s8, 19456
    s_mov_b32 s3, 2490368
    buffer_load_dwordx4 v240, s[4:7], s3 offen lds
    s_waitcnt vmcnt(0)
    ds_read_b64_tr_b16 v[0:1], v238 offset:0
    ds_read_b64_tr_b16 v[2:3], v238 offset:256
    ds_read_b64_tr_b16 v[4:5], v238 offset:32
    ds_read_b64_tr_b16 v[6:7], v238 offset:288
    ds_read_b64_tr_b16 v[8:9], v238 offset:2048
    ds_read_b64_tr_b16 v[10:11], v238 offset:2304
    ds_read_b64_tr_b16 v[12:13], v238 offset:2080
    ds_read_b64_tr_b16 v[14:15], v238 offset:2336
    ds_read_b64_tr_b16 v[16:17], v238 offset:4096
    ds_read_b64_tr_b16 v[18:19], v238 offset:4352
    ds_read_b64_tr_b16 v[20:21], v238 offset:4128
    ds_read_b64_tr_b16 v[22:23], v238 offset:4384
    ds_read_b64_tr_b16 v[24:25], v238 offset:6144
    ds_read_b64_tr_b16 v[26:27], v238 offset:6400
    ds_read_b64_tr_b16 v[28:29], v238 offset:6176
    ds_read_b64_tr_b16 v[30:31], v238 offset:6432
    ds_read_b64_tr_b16 v[32:33], v238 offset:8192
    ds_read_b64_tr_b16 v[34:35], v238 offset:8448
    ds_read_b64_tr_b16 v[36:37], v238 offset:8224
    ds_read_b64_tr_b16 v[38:39], v238 offset:8480
    ds_read_b64_tr_b16 v[40:41], v238 offset:10240
    ds_read_b64_tr_b16 v[42:43], v238 offset:10496
    ds_read_b64_tr_b16 v[44:45], v238 offset:10272
    ds_read_b64_tr_b16 v[46:47], v238 offset:10528
    ds_read_b64_tr_b16 v[48:49], v238 offset:12288
    ds_read_b64_tr_b16 v[50:51], v238 offset:12544
    ds_read_b64_tr_b16 v[52:53], v238 offset:12320
    ds_read_b64_tr_b16 v[54:55], v238 offset:12576
    ds_read_b64_tr_b16 v[56:57], v238 offset:14336
    ds_read_b64_tr_b16 v[58:59], v238 offset:14592
    ds_read_b64_tr_b16 v[60:61], v238 offset:14368
    ds_read_b64_tr_b16 v[62:63], v238 offset:14624
    ds_read_b64_tr_b16 v[64:65], v238 offset:16384
    ds_read_b64_tr_b16 v[66:67], v238 offset:16640
    ds_read_b64_tr_b16 v[68:69], v238 offset:16416
    ds_read_b64_tr_b16 v[70:71], v238 offset:16672
    ds_read_b64_tr_b16 v[72:73], v238 offset:18432
    ds_read_b64_tr_b16 v[74:75], v238 offset:18688
    ds_read_b64_tr_b16 v[76:77], v238 offset:18464
    ds_read_b64_tr_b16 v[78:79], v238 offset:18720
    s_waitcnt lgkmcnt(0)
    s_add_u32 m0, s8, 0
    s_mov_b32 s3, 2621440
    buffer_load_dwordx4 v240, s[4:7], s3 offen lds
    s_add_u32 m0, s8, 1024
    s_mov_b32 s3, 2752512
    buffer_load_dwordx4 v240, s[4:7], s3 offen lds
    s_add_u32 m0, s8, 2048
    s_mov_b32 s3, 2883584
    buffer_load_dwordx4 v240, s[4:7], s3 offen lds
    s_add_u32 m0, s8, 3072
    s_mov_b32 s3, 3014656
    buffer_load_dwordx4 v240, s[4:7], s3 offen lds
    s_add_u32 m0, s8, 4096
    s_mov_b32 s3, 3145728
    buffer_load_dwordx4 v240, s[4:7], s3 offen lds
    s_add_u32 m0, s8, 5120
    s_mov_b32 s3, 3276800
    buffer_load_dwordx4 v240, s[4:7], s3 offen lds
    s_add_u32 m0, s8, 6144
    s_mov_b32 s3, 3407872
    buffer_load_dwordx4 v240, s[4:7], s3 offen lds
    s_add_u32 m0, s8, 7168
    s_mov_b32 s3, 3538944
    buffer_load_dwordx4 v240, s[4:7], s3 offen lds
    s_add_u32 m0, s8, 8192
    s_mov_b32 s3, 3670016
    buffer_load_dwordx4 v240, s[4:7], s3 offen lds
    s_add_u32 m0, s8, 9216
    s_mov_b32 s3, 3801088
    buffer_load_dwordx4 v240, s[4:7], s3 offen lds
    s_add_u32 m0, s8, 10240
    s_mov_b32 s3, 3932160
    buffer_load_dwordx4 v240, s[4:7], s3 offen lds
    s_add_u32 m0, s8, 11264
    s_mov_b32 s3, 4063232
    buffer_load_dwordx4 v240, s[4:7], s3 offen lds
    s_add_u32 m0, s8, 12288
    s_mov_b32 s3, 4194304
    buffer_load_dwordx4 v240, s[4:7], s3 offen lds
    s_add_u32 m0, s8, 13312
    s_mov_b32 s3, 4325376
    buffer_load_dwordx4 v240, s[4:7], s3 offen lds
    s_add_u32 m0, s8, 14336
    s_mov_b32 s3, 4456448
    buffer_load_dwordx4 v240, s[4:7], s3 offen lds
    s_add_u32 m0, s8, 15360
    s_mov_b32 s3, 4587520
    buffer_load_dwordx4 v240, s[4:7], s3 offen lds
    s_add_u32 m0, s8, 16384
    s_mov_b32 s3, 4718592
    buffer_load_dwordx4 v240, s[4:7], s3 offen lds
    s_add_u32 m0, s8, 17408
    s_mov_b32 s3, 4849664
    buffer_load_dwordx4 v240, s[4:7], s3 offen lds
    s_add_u32 m0, s8, 18432
    s_mov_b32 s3, 4980736
    buffer_load_dwordx4 v240, s[4:7], s3 offen lds
    s_add_u32 m0, s8, 19456
    s_mov_b32 s3, 5111808
    buffer_load_dwordx4 v240, s[4:7], s3 offen lds
    s_waitcnt vmcnt(0)
    ds_read_b64_tr_b16 v[80:81], v238 offset:0
    ds_read_b64_tr_b16 v[82:83], v238 offset:256
    ds_read_b64_tr_b16 v[84:85], v238 offset:32
    ds_read_b64_tr_b16 v[86:87], v238 offset:288
    ds_read_b64_tr_b16 v[88:89], v238 offset:2048
    ds_read_b64_tr_b16 v[90:91], v238 offset:2304
    ds_read_b64_tr_b16 v[92:93], v238 offset:2080
    ds_read_b64_tr_b16 v[94:95], v238 offset:2336
    ds_read_b64_tr_b16 v[96:97], v238 offset:4096
    ds_read_b64_tr_b16 v[98:99], v238 offset:4352
    ds_read_b64_tr_b16 v[100:101], v238 offset:4128
    ds_read_b64_tr_b16 v[102:103], v238 offset:4384
    ds_read_b64_tr_b16 v[104:105], v238 offset:6144
    ds_read_b64_tr_b16 v[106:107], v238 offset:6400
    ds_read_b64_tr_b16 v[108:109], v238 offset:6176
    ds_read_b64_tr_b16 v[110:111], v238 offset:6432
    ds_read_b64_tr_b16 v[112:113], v238 offset:8192
    ds_read_b64_tr_b16 v[114:115], v238 offset:8448
    ds_read_b64_tr_b16 v[116:117], v238 offset:8224
    ds_read_b64_tr_b16 v[118:119], v238 offset:8480
    ds_read_b64_tr_b16 v[120:121], v238 offset:10240
    ds_read_b64_tr_b16 v[122:123], v238 offset:10496
    ds_read_b64_tr_b16 v[124:125], v238 offset:10272
    ds_read_b64_tr_b16 v[126:127], v238 offset:10528
    ds_read_b64_tr_b16 v[128:129], v238 offset:12288
    ds_read_b64_tr_b16 v[130:131], v238 offset:12544
    ds_read_b64_tr_b16 v[132:133], v238 offset:12320
    ds_read_b64_tr_b16 v[134:135], v238 offset:12576
    ds_read_b64_tr_b16 v[136:137], v238 offset:14336
    ds_read_b64_tr_b16 v[138:139], v238 offset:14592
    ds_read_b64_tr_b16 v[140:141], v238 offset:14368
    ds_read_b64_tr_b16 v[142:143], v238 offset:14624
    ds_read_b64_tr_b16 v[144:145], v238 offset:16384
    ds_read_b64_tr_b16 v[146:147], v238 offset:16640
    ds_read_b64_tr_b16 v[148:149], v238 offset:16416
    ds_read_b64_tr_b16 v[150:151], v238 offset:16672
    ds_read_b64_tr_b16 v[152:153], v238 offset:18432
    ds_read_b64_tr_b16 v[154:155], v238 offset:18688
    ds_read_b64_tr_b16 v[156:157], v238 offset:18464
    ds_read_b64_tr_b16 v[158:159], v238 offset:18720
    s_waitcnt lgkmcnt(0)
    s_barrier
    s_add_u32 s8, s58, 0x4cec000
    s_addc_u32 s9, s59, 0
    s_mov_b32 s10, 0x500000
    s_mov_b32 s11, 0x20000
    s_mul_i32 s16, s40, 10240
    s_cmp_eq_u32 s33, 6
    s_cbranch_scc1 C_vsetup
    s_add_u32 s12, s58, 0x5200000
    s_addc_u32 s13, s59, 0
    s_mov_b32 s14, 0x800000
    s_mov_b32 s15, 0x20000
    s_lshl_b32 s3, s47, 10
    s_sub_u32 s17, s33, 4
    s_lshl_b32 s17, s17, 7
    s_add_u32 s3, s3, s17
    s_lshl_b32 s17, s46, 12
    s_add_u32 s3, s3, s17
    s_mov_b32 s18, 131072
    s_mov_b32 s20, 0x00ff00ff
    s_mov_b32 s21, 0x00ff00ff
    s_branch C_qkv_go
C_vsetup:
    s_add_u32 s12, s58, 0x5a00000
    s_addc_u32 s13, s59, 0
    s_mov_b32 s14, 0x400000
    s_mov_b32 s15, 0x20000
    s_lshl_b32 s3, s47, 9
    s_lshl_b32 s17, s46, 11
    s_add_u32 s3, s3, s17
    s_mov_b32 s18, 65536
    s_mov_b32 s20, -1
    s_mov_b32 s21, 0
C_qkv_go:
    v_add_u32 v217, s3, v216
    v_add_u32 v218, 4096, v216
    v_add_u32 v219, 8192, v216
    s_setprio 2
    s_mov_b32 s17, 0
    s_add_u32 s24, s58, 0x1400000
    s_addc_u32 s25, s59, 0
    s_mov_b32 s26, 0x2000000
    s_mov_b32 s27, 0x20000
    s_lshl_b32 s28, s40, 14
    s_lshl_b32 s29, s40, 15
    s_add_u32 s29, s29, 0x1000000
    s_lshl_b32 s31, s41, 2
    s_lshl_b32 s3, s33, 1
    s_add_u32 s31, s31, s3
    s_sub_u32 s31, s31, 8
    s_lshr_b32 s34, s31, 4
    s_and_b32 s35, s31, 7
    s_bfe_u32 s31, s31, 0x10003
    s_lshl_b32 s30, s34, 13
    s_lshl_b32 s36, s35, 10
    s_add_u32 s30, s30, s36
    s_lshl_b32 s34, s34, 12
    s_lshr_b32 s36, s35, 2
    s_lshl_b32 s36, s36, 17
    s_add_u32 s34, s34, s36
    s_and_b32 s36, s35, 3
    s_lshl_b32 s36, s36, 10
    s_add_u32 s34, s34, s36
    s_cmp_eq_u32 s31, 0
    s_cmov_b32 s30, s34
    s_add_u32 s60, s58, 0x4cec000
    s_addc_u32 s61, s59, 0
    s_mov_b32 s62, 0x1114000
    s_mov_b32 s63, 0x20000
    s_lshl_b32 s36, s41, 10
    s_lshl_b32 s37, s40, 14
    s_add_u32 s37, s37, s36
    s_add_u32 s37, s37, 5324800
    s_lshl_b32 s38, s40, 13
    s_add_u32 s38, s38, s36
    s_add_u32 s38, s38, 13713408
    s_mov_b32 s39, 65536
    s_mul_i32 s100, s40, 10240
    s_add_u32 s100, s100, s36
    s_cmp_lt_u32 s41, 8
    s_cbranch_scc1 C_tch_ok
    s_sub_u32 s38, s100, 8192
    s_mov_b32 s39, 81920
C_tch_ok:
    s_add_u32 s100, s100, 8192
    s_cmp_lg_u32 s33, 6
    s_cbranch_scc1 C_txa
    buffer_load_dwordx4 v[232:235], v216, s[60:63], s37 offen
    buffer_load_dwordx4 v[232:235], v216, s[60:63], s38 offen
    s_add_u32 s37, s37, 131072
    s_add_u32 s38, s38, s39
    s_cmp_gt_u32 s41, 1
    s_cbranch_scc1 C_txa
    buffer_load_dwordx4 v[232:235], v216, s[60:63], s100 offen
    s_add_u32 s100, s100, 81920
C_txa:
    s_cmp_lg_u32 s33, 6
    s_cbranch_scc1 C_txb
    buffer_load_dwordx4 v[232:235], v216, s[60:63], s37 offen
    buffer_load_dwordx4 v[232:235], v216, s[60:63], s38 offen
    s_add_u32 s37, s37, 131072
    s_add_u32 s38, s38, s39
    s_cmp_gt_u32 s41, 1
    s_cbranch_scc1 C_txb
    buffer_load_dwordx4 v[232:235], v216, s[60:63], s100 offen
    s_add_u32 s100, s100, 81920
C_txb:
    s_add_u32 s76, s58, 0x7200000
    s_addc_u32 s77, s59, 0
    s_mov_b32 s78, 0xa000
    s_mov_b32 s79, 0x20000
    s_lshl_b32 s74, s40, 4
    s_lshl_b32 s3, s74, 7
    v_mov_b32 v254, 0
FW_1:
    buffer_load_dword v255, v254, s[76:79], s3 offen sc1
    s_waitcnt vmcnt(0)
    v_readfirstlane_b32 s75, v255
    s_cmp_ge_u32 s75, 16
    s_cbranch_scc1 FK_2
    s_sleep 2
    s_sub_u32 s44, s44, 1
    s_cbranch_scc0 FW_1
    s_branch M_done
FK_2:
C_kvoki:
    s_cmp_eq_u32 s33, 6
    s_cbranch_scc1 C_wda
    s_cmp_eq_u32 s31, 0
    s_cselect_b32 s34, s28, s29
    s_add_u32 s34, s34, s30
    s_add_u32 s34, s34, 262144
    buffer_load_dwordx4 v[232:235], v216, s[24:27], s34 offen
    buffer_load_dwordx4 v[232:235], v216, s[24:27], s34 offen offset:1024
C_wda:
    s_cmp_eq_u32 s33, 6
    s_cbranch_scc1 C_wdb
    s_cmp_eq_u32 s31, 0
    s_cselect_b32 s34, s28, s29
    s_add_u32 s34, s34, s30
    s_add_u32 s34, s34, 524288
    buffer_load_dwordx4 v[232:235], v216, s[24:27], s34 offen
    buffer_load_dwordx4 v[232:235], v216, s[24:27], s34 offen offset:1024
C_wdb:
    s_cmp_lg_u32 s33, 4
    s_cbranch_scc1 C_dma01
    s_mov_b32 m0, 16384
    s_add_u32 s34, s28, 0
    buffer_load_dwordx4 v216, s[24:27], s34 offen sc1 lds
    s_mov_b32 m0, 17408
    s_add_u32 s34, s28, 1024
    buffer_load_dwordx4 v216, s[24:27], s34 offen sc1 lds
    s_mov_b32 m0, 18432
    s_add_u32 s34, s28, 2048
    buffer_load_dwordx4 v216, s[24:27], s34 offen sc1 lds
    s_mov_b32 m0, 19456
    s_add_u32 s34, s28, 3072
    buffer_load_dwordx4 v216, s[24:27], s34 offen sc1 lds
    s_mov_b32 m0, 20480
    s_add_u32 s34, s28, 131072
    buffer_load_dwordx4 v216, s[24:27], s34 offen sc1 lds
    s_mov_b32 m0, 21504
    s_add_u32 s34, s28, 132096
    buffer_load_dwordx4 v216, s[24:27], s34 offen sc1 lds
    s_mov_b32 m0, 22528
    s_add_u32 s34, s28, 133120
    buffer_load_dwordx4 v216, s[24:27], s34 offen sc1 lds
    s_mov_b32 m0, 23552
    s_add_u32 s34, s28, 134144
    buffer_load_dwordx4 v216, s[24:27], s34 offen sc1 lds
    s_mov_b32 m0, 24576
    s_add_u32 s34, s29, 0
    buffer_load_dwordx4 v216, s[24:27], s34 offen sc1 lds
    s_mov_b32 m0, 25600
    s_add_u32 s34, s29, 1024
    buffer_load_dwordx4 v216, s[24:27], s34 offen sc1 lds
    s_mov_b32 m0, 26624
    s_add_u32 s34, s29, 2048
    buffer_load_dwordx4 v216, s[24:27], s34 offen sc1 lds
    s_mov_b32 m0, 27648
    s_add_u32 s34, s29, 3072
    buffer_load_dwordx4 v216, s[24:27], s34 offen sc1 lds
    s_mov_b32 m0, 28672
    s_add_u32 s34, s29, 4096
    buffer_load_dwordx4 v216, s[24:27], s34 offen sc1 lds
    s_mov_b32 m0, 29696
    s_add_u32 s34, s29, 5120
    buffer_load_dwordx4 v216, s[24:27], s34 offen sc1 lds
    s_mov_b32 m0, 30720
    s_add_u32 s34, s29, 6144
    buffer_load_dwordx4 v216, s[24:27], s34 offen sc1 lds
    s_mov_b32 m0, 31744
    s_add_u32 s34, s29, 7168
    buffer_load_dwordx4 v216, s[24:27], s34 offen sc1 lds
    s_mov_b32 m0, 32768
    s_add_u32 s34, s28, 4096
    buffer_load_dwordx4 v216, s[24:27], s34 offen sc1 lds
    s_mov_b32 m0, 33792
    s_add_u32 s34, s28, 5120
    buffer_load_dwordx4 v216, s[24:27], s34 offen sc1 lds
    s_mov_b32 m0, 34816
    s_add_u32 s34, s28, 6144
    buffer_load_dwordx4 v216, s[24:27], s34 offen sc1 lds
    s_mov_b32 m0, 35840
    s_add_u32 s34, s28, 7168
    buffer_load_dwordx4 v216, s[24:27], s34 offen sc1 lds
    s_mov_b32 m0, 36864
    s_add_u32 s34, s28, 135168
    buffer_load_dwordx4 v216, s[24:27], s34 offen sc1 lds
    s_mov_b32 m0, 37888
    s_add_u32 s34, s28, 136192
    buffer_load_dwordx4 v216, s[24:27], s34 offen sc1 lds
    s_branch C_dmae0
C_dma01:
    s_cmp_lg_u32 s33, 5
    s_cbranch_scc1 C_dma02
    s_mov_b32 m0, 38912
    s_add_u32 s34, s28, 137216
    buffer_load_dwordx4 v216, s[24:27], s34 offen sc1 lds
    s_mov_b32 m0, 39936
    s_add_u32 s34, s28, 138240
    buffer_load_dwordx4 v216, s[24:27], s34 offen sc1 lds
    s_mov_b32 m0, 40960
    s_add_u32 s34, s29, 8192
    buffer_load_dwordx4 v216, s[24:27], s34 offen sc1 lds
    s_mov_b32 m0, 41984
    s_add_u32 s34, s29, 9216
    buffer_load_dwordx4 v216, s[24:27], s34 offen sc1 lds
    s_mov_b32 m0, 43008
    s_add_u32 s34, s29, 10240
    buffer_load_dwordx4 v216, s[24:27], s34 offen sc1 lds
    s_mov_b32 m0, 44032
    s_add_u32 s34, s29, 11264
    buffer_load_dwordx4 v216, s[24:27], s34 offen sc1 lds
    s_mov_b32 m0, 45056
    s_add_u32 s34, s29, 12288
    buffer_load_dwordx4 v216, s[24:27], s34 offen sc1 lds
    s_mov_b32 m0, 46080
    s_add_u32 s34, s29, 13312
    buffer_load_dwordx4 v216, s[24:27], s34 offen sc1 lds
    s_mov_b32 m0, 47104
    s_add_u32 s34, s29, 14336
    buffer_load_dwordx4 v216, s[24:27], s34 offen sc1 lds
    s_mov_b32 m0, 48128
    s_add_u32 s34, s29, 15360
    buffer_load_dwordx4 v216, s[24:27], s34 offen sc1 lds
    s_mov_b32 m0, 49152
    s_add_u32 s34, s28, 8192
    buffer_load_dwordx4 v216, s[24:27], s34 offen sc1 lds
    s_mov_b32 m0, 50176
    s_add_u32 s34, s28, 9216
    buffer_load_dwordx4 v216, s[24:27], s34 offen sc1 lds
    s_mov_b32 m0, 51200
    s_add_u32 s34, s28, 10240
    buffer_load_dwordx4 v216, s[24:27], s34 offen sc1 lds
    s_mov_b32 m0, 52224
    s_add_u32 s34, s28, 11264
    buffer_load_dwordx4 v216, s[24:27], s34 offen sc1 lds
    s_mov_b32 m0, 53248
    s_add_u32 s34, s28, 139264
    buffer_load_dwordx4 v216, s[24:27], s34 offen sc1 lds
    s_mov_b32 m0, 54272
    s_add_u32 s34, s28, 140288
    buffer_load_dwordx4 v216, s[24:27], s34 offen sc1 lds
    s_mov_b32 m0, 55296
    s_add_u32 s34, s28, 141312
    buffer_load_dwordx4 v216, s[24:27], s34 offen sc1 lds
    s_mov_b32 m0, 56320
    s_add_u32 s34, s28, 142336
    buffer_load_dwordx4 v216, s[24:27], s34 offen sc1 lds
    s_mov_b32 m0, 57344
    s_add_u32 s34, s29, 16384
    buffer_load_dwordx4 v216, s[24:27], s34 offen sc1 lds
    s_mov_b32 m0, 58368
    s_add_u32 s34, s29, 17408
    buffer_load_dwordx4 v216, s[24:27], s34 offen sc1 lds
    s_mov_b32 m0, 59392
    s_add_u32 s34, s29, 18432
    buffer_load_dwordx4 v216, s[24:27], s34 offen sc1 lds
    s_branch C_dmae0
C_dma02:
    s_mov_b32 m0, 60416
    s_add_u32 s34, s29, 19456
    buffer_load_dwordx4 v216, s[24:27], s34 offen sc1 lds
    s_mov_b32 m0, 61440
    s_add_u32 s34, s29, 20480
    buffer_load_dwordx4 v216, s[24:27], s34 offen sc1 lds
    s_mov_b32 m0, 62464
    s_add_u32 s34, s29, 21504
    buffer_load_dwordx4 v216, s[24:27], s34 offen sc1 lds
    s_mov_b32 m0, 63488
    s_add_u32 s34, s29, 22528
    buffer_load_dwordx4 v216, s[24:27], s34 offen sc1 lds
    s_mov_b32 m0, 64512
    s_add_u32 s34, s29, 23552
    buffer_load_dwordx4 v216, s[24:27], s34 offen sc1 lds
    s_mov_b32 m0, 65536
    s_add_u32 s34, s28, 12288
    buffer_load_dwordx4 v216, s[24:27], s34 offen sc1 lds
    s_mov_b32 m0, 66560
    s_add_u32 s34, s28, 13312
    buffer_load_dwordx4 v216, s[24:27], s34 offen sc1 lds
    s_mov_b32 m0, 67584
    s_add_u32 s34, s28, 14336
    buffer_load_dwordx4 v216, s[24:27], s34 offen sc1 lds
    s_mov_b32 m0, 68608
    s_add_u32 s34, s28, 15360
    buffer_load_dwordx4 v216, s[24:27], s34 offen sc1 lds
    s_mov_b32 m0, 69632
    s_add_u32 s34, s28, 143360
    buffer_load_dwordx4 v216, s[24:27], s34 offen sc1 lds
    s_mov_b32 m0, 70656
    s_add_u32 s34, s28, 144384
    buffer_load_dwordx4 v216, s[24:27], s34 offen sc1 lds
    s_mov_b32 m0, 71680
    s_add_u32 s34, s28, 145408
    buffer_load_dwordx4 v216, s[24:27], s34 offen sc1 lds
    s_mov_b32 m0, 72704
    s_add_u32 s34, s28, 146432
    buffer_load_dwordx4 v216, s[24:27], s34 offen sc1 lds
    s_mov_b32 m0, 73728
    s_add_u32 s34, s29, 24576
    buffer_load_dwordx4 v216, s[24:27], s34 offen sc1 lds
    s_mov_b32 m0, 74752
    s_add_u32 s34, s29, 25600
    buffer_load_dwordx4 v216, s[24:27], s34 offen sc1 lds
    s_mov_b32 m0, 75776
    s_add_u32 s34, s29, 26624
    buffer_load_dwordx4 v216, s[24:27], s34 offen sc1 lds
    s_mov_b32 m0, 76800
    s_add_u32 s34, s29, 27648
    buffer_load_dwordx4 v216, s[24:27], s34 offen sc1 lds
    s_mov_b32 m0, 77824
    s_add_u32 s34, s29, 28672
    buffer_load_dwordx4 v216, s[24:27], s34 offen sc1 lds
    s_mov_b32 m0, 78848
    s_add_u32 s34, s29, 29696
    buffer_load_dwordx4 v216, s[24:27], s34 offen sc1 lds
    s_mov_b32 m0, 79872
    s_add_u32 s34, s29, 30720
    buffer_load_dwordx4 v216, s[24:27], s34 offen sc1 lds
    s_mov_b32 m0, 80896
    s_add_u32 s34, s29, 31744
    buffer_load_dwordx4 v216, s[24:27], s34 offen sc1 lds
    s_branch C_dmae0
C_dma03:
C_dmae0:
    s_add_u32 s28, s28, 262144
    s_add_u32 s29, s29, 262144
    s_waitcnt vmcnt(0)
    s_barrier
    s_cmp_eq_u32 s33, 6
    s_cbranch_scc1 C_qkv_loopV
C_qkv_loopQ:
    s_sleep 3
    buffer_load_dwordx4 v[160:163], v216, s[8:11], s16 offen offset:0 sc1
    buffer_load_dwordx4 v[164:167], v216, s[8:11], s16 offen offset:1024 sc1
    buffer_load_dwordx4 v[168:171], v216, s[8:11], s16 offen offset:2048 sc1
    buffer_load_dwordx4 v[172:175], v216, s[8:11], s16 offen offset:3072 sc1
    buffer_load_dwordx4 v[176:179], v218, s[8:11], s16 offen offset:0 sc1
    buffer_load_dwordx4 v[180:183], v218, s[8:11], s16 offen offset:1024 sc1
    buffer_load_dwordx4 v[184:187], v218, s[8:11], s16 offen offset:2048 sc1
    buffer_load_dwordx4 v[188:191], v218, s[8:11], s16 offen offset:3072 sc1
    buffer_load_dwordx4 v[192:195], v219, s[8:11], s16 offen offset:0 sc1
    buffer_load_dwordx4 v[196:199], v219, s[8:11], s16 offen offset:1024 sc1
C_qchkQ0:
    s_waitcnt vmcnt(8)
    v_max3_u32 v222, v160, v161, v162
    v_max3_u32 v222, v222, v163, v164
    v_max3_u32 v222, v222, v165, v166
    v_max_u32 v222, v222, v167
    v_cmp_eq_u32 vcc, -1, v222
    s_cbranch_vccnz C_qretQ0
C_qmmQ0:
    v_mfma_f32_16x16x32_bf16 v[200:203], v[0:3], v[160:163], 0
    v_mfma_f32_16x16x32_bf16 v[208:211], v[4:7], v[160:163], 0
    v_mfma_f32_16x16x32_bf16 v[204:207], v[8:11], v[160:163], 0
    v_mfma_f32_16x16x32_bf16 v[212:215], v[12:15], v[160:163], 0
    s_waitcnt vmcnt(6)
    v_mfma_f32_16x16x32_bf16 v[200:203], v[16:19], v[164:167], v[200:203]
    v_max3_u32 v222, v168, v169, v170
    v_max3_u32 v222, v222, v171, v172
    v_mfma_f32_16x16x32_bf16 v[208:211], v[20:23], v[164:167], v[208:211]
    v_max3_u32 v222, v222, v173, v174
    v_max_u32 v222, v222, v175
    v_mfma_f32_16x16x32_bf16 v[204:207], v[24:27], v[164:167], v[204:207]
    v_cmp_eq_u32 vcc, -1, v222
    v_mfma_f32_16x16x32_bf16 v[212:215], v[28:31], v[164:167], v[212:215]
    s_cbranch_vccnz C_qretQ1
C_qmmQ1:
    v_mfma_f32_16x16x32_bf16 v[200:203], v[32:35], v[168:171], v[200:203]
    v_mfma_f32_16x16x32_bf16 v[208:211], v[36:39], v[168:171], v[208:211]
    v_mfma_f32_16x16x32_bf16 v[204:207], v[40:43], v[168:171], v[204:207]
    v_mfma_f32_16x16x32_bf16 v[212:215], v[44:47], v[168:171], v[212:215]
    s_waitcnt vmcnt(4)
    v_mfma_f32_16x16x32_bf16 v[200:203], v[48:51], v[172:175], v[200:203]
    v_max3_u32 v222, v176, v177, v178
    v_max3_u32 v222, v222, v179, v180
    v_mfma_f32_16x16x32_bf16 v[208:211], v[52:55], v[172:175], v[208:211]
    v_max3_u32 v222, v222, v181, v182
    v_max_u32 v222, v222, v183
    v_mfma_f32_16x16x32_bf16 v[204:207], v[56:59], v[172:175], v[204:207]
    v_cmp_eq_u32 vcc, -1, v222
    v_mfma_f32_16x16x32_bf16 v[212:215], v[60:63], v[172:175], v[212:215]
    s_cbranch_vccnz C_qretQ2
C_qmmQ2:
    v_mfma_f32_16x16x32_bf16 v[200:203], v[64:67], v[176:179], v[200:203]
    v_mfma_f32_16x16x32_bf16 v[208:211], v[68:71], v[176:179], v[208:211]
    v_mfma_f32_16x16x32_bf16 v[204:207], v[72:75], v[176:179], v[204:207]
    v_mfma_f32_16x16x32_bf16 v[212:215], v[76:79], v[176:179], v[212:215]
    s_waitcnt vmcnt(2)
    v_mfma_f32_16x16x32_bf16 v[200:203], v[80:83], v[180:183], v[200:203]
    v_max3_u32 v222, v184, v185, v186
    v_max3_u32 v222, v222, v187, v188
    v_mfma_f32_16x16x32_bf16 v[208:211], v[84:87], v[180:183], v[208:211]
    v_max3_u32 v222, v222, v189, v190
    v_max_u32 v222, v222, v191
    v_mfma_f32_16x16x32_bf16 v[204:207], v[88:91], v[180:183], v[204:207]
    v_cmp_eq_u32 vcc, -1, v222
    v_mfma_f32_16x16x32_bf16 v[212:215], v[92:95], v[180:183], v[212:215]
    s_cbranch_vccnz C_qretQ3
C_qmmQ3:
    v_mfma_f32_16x16x32_bf16 v[200:203], v[96:99], v[184:187], v[200:203]
    v_mfma_f32_16x16x32_bf16 v[208:211], v[100:103], v[184:187], v[208:211]
    v_mfma_f32_16x16x32_bf16 v[204:207], v[104:107], v[184:187], v[204:207]
    v_mfma_f32_16x16x32_bf16 v[212:215], v[108:111], v[184:187], v[212:215]
    s_waitcnt vmcnt(0)
    v_mfma_f32_16x16x32_bf16 v[200:203], v[112:115], v[188:191], v[200:203]
    v_max3_u32 v222, v192, v193, v194
    v_max3_u32 v222, v222, v195, v196
    v_mfma_f32_16x16x32_bf16 v[208:211], v[116:119], v[188:191], v[208:211]
    v_max3_u32 v222, v222, v197, v198
    v_max_u32 v222, v222, v199
    v_mfma_f32_16x16x32_bf16 v[204:207], v[120:123], v[188:191], v[204:207]
    v_cmp_eq_u32 vcc, -1, v222
    v_mfma_f32_16x16x32_bf16 v[212:215], v[124:127], v[188:191], v[212:215]
    s_cbranch_vccnz C_qretQ4
C_qmmQ4:
    v_mfma_f32_16x16x32_bf16 v[200:203], v[128:131], v[192:195], v[200:203]
    v_mfma_f32_16x16x32_bf16 v[208:211], v[132:135], v[192:195], v[208:211]
    v_mfma_f32_16x16x32_bf16 v[204:207], v[136:139], v[192:195], v[204:207]
    v_mfma_f32_16x16x32_bf16 v[212:215], v[140:143], v[192:195], v[212:215]
    v_mfma_f32_16x16x32_bf16 v[200:203], v[144:147], v[196:199], v[200:203]
    v_mfma_f32_16x16x32_bf16 v[208:211], v[148:151], v[196:199], v[208:211]
    v_mfma_f32_16x16x32_bf16 v[204:207], v[152:155], v[196:199], v[204:207]
    v_mfma_f32_16x16x32_bf16 v[212:215], v[156:159], v[196:199], v[212:215]
    s_nop 6
    v_add_f32_dpp v200, v204, v200 row_ror:8 row_mask:0xf bank_mask:0xf
    v_add_f32_dpp v201, v205, v201 row_ror:8 row_mask:0xf bank_mask:0xf
    v_add_f32_dpp v202, v206, v202 row_ror:8 row_mask:0xf bank_mask:0xf
    v_add_f32_dpp v203, v207, v203 row_ror:8 row_mask:0xf bank_mask:0xf
    v_add_f32_dpp v208, v212, v208 row_ror:8 row_mask:0xf bank_mask:0xf
    v_add_f32_dpp v209, v213, v209 row_ror:8 row_mask:0xf bank_mask:0xf
    v_add_f32_dpp v210, v214, v210 row_ror:8 row_mask:0xf bank_mask:0xf
    v_add_f32_dpp v211, v215, v211 row_ror:8 row_mask:0xf bank_mask:0xf
    v_cvt_pk_bf16_f32 v224, v200, v201
    v_cvt_pk_bf16_f32 v225, v202, v203
    v_cvt_pk_bf16_f32 v226, v208, v209
    v_cvt_pk_bf16_f32 v227, v210, v211
    v_min_u32 v224, -2, v224
    v_min_u32 v225, -2, v225
    v_min_u32 v226, -2, v226
    v_min_u32 v227, -2, v227
    s_mov_b64 exec, s[20:21]
    s_cmp_lg_u32 s42, 0
    s_cbranch_scc1 XS_3
    buffer_store_dwordx4 v[224:227], v217, s[12:15], s17 offen
    s_branch XD_4
XS_3:
    buffer_store_dwordx4 v[224:227], v217, s[12:15], s17 offen sc1
XD_4:
    s_mov_b64 exec, -1
    s_add_u32 s43, s43, 1
    s_cmp_ge_u32 s43, 64
    s_cbranch_scc1 M_done
    s_add_u32 s17, s17, s18
    s_add_u32 s16, s16, 81920
    s_barrier
    s_setprio 0
    s_sleep 11
    s_cmp_lg_u32 s33, 4
    s_cbranch_scc1 C_dmaQ1
    s_mov_b32 m0, 16384
    s_add_u32 s34, s28, 0
    buffer_load_dwordx4 v216, s[24:27], s34 offen sc1 lds
    s_mov_b32 m0, 17408
    s_add_u32 s34, s28, 1024
    buffer_load_dwordx4 v216, s[24:27], s34 offen sc1 lds
    s_mov_b32 m0, 18432
    s_add_u32 s34, s28, 2048
    buffer_load_dwordx4 v216, s[24:27], s34 offen sc1 lds
    s_mov_b32 m0, 19456
    s_add_u32 s34, s28, 3072
    buffer_load_dwordx4 v216, s[24:27], s34 offen sc1 lds
    s_mov_b32 m0, 20480
    s_add_u32 s34, s28, 131072
    buffer_load_dwordx4 v216, s[24:27], s34 offen sc1 lds
    s_mov_b32 m0, 21504
    s_add_u32 s34, s28, 132096
    buffer_load_dwordx4 v216, s[24:27], s34 offen sc1 lds
    s_mov_b32 m0, 22528
    s_add_u32 s34, s28, 133120
    buffer_load_dwordx4 v216, s[24:27], s34 offen sc1 lds
    s_mov_b32 m0, 23552
    s_add_u32 s34, s28, 134144
    buffer_load_dwordx4 v216, s[24:27], s34 offen sc1 lds
    s_mov_b32 m0, 24576
    s_add_u32 s34, s29, 0
    buffer_load_dwordx4 v216, s[24:27], s34 offen sc1 lds
    s_mov_b32 m0, 25600
    s_add_u32 s34, s29, 1024
    buffer_load_dwordx4 v216, s[24:27], s34 offen sc1 lds
    s_mov_b32 m0, 26624
    s_add_u32 s34, s29, 2048
    buffer_load_dwordx4 v216, s[24:27], s34 offen sc1 lds
    s_mov_b32 m0, 27648
    s_add_u32 s34, s29, 3072
    buffer_load_dwordx4 v216, s[24:27], s34 offen sc1 lds
    s_mov_b32 m0, 28672
    s_add_u32 s34, s29, 4096
    buffer_load_dwordx4 v216, s[24:27], s34 offen sc1 lds
    s_mov_b32 m0, 29696
    s_add_u32 s34, s29, 5120
    buffer_load_dwordx4 v216, s[24:27], s34 offen sc1 lds
    s_mov_b32 m0, 30720
    s_add_u32 s34, s29, 6144
    buffer_load_dwordx4 v216, s[24:27], s34 offen sc1 lds
    s_mov_b32 m0, 31744
    s_add_u32 s34, s29, 7168
    buffer_load_dwordx4 v216, s[24:27], s34 offen sc1 lds
    s_mov_b32 m0, 32768
    s_add_u32 s34, s28, 4096
    buffer_load_dwordx4 v216, s[24:27], s34 offen sc1 lds
    s_mov_b32 m0, 33792
    s_add_u32 s34, s28, 5120
    buffer_load_dwordx4 v216, s[24:27], s34 offen sc1 lds
    s_mov_b32 m0, 34816
    s_add_u32 s34, s28, 6144
    buffer_load_dwordx4 v216, s[24:27], s34 offen sc1 lds
    s_mov_b32 m0, 35840
    s_add_u32 s34, s28, 7168
    buffer_load_dwordx4 v216, s[24:27], s34 offen sc1 lds
    s_mov_b32 m0, 36864
    s_add_u32 s34, s28, 135168
    buffer_load_dwordx4 v216, s[24:27], s34 offen sc1 lds
    s_mov_b32 m0, 37888
    s_add_u32 s34, s28, 136192
    buffer_load_dwordx4 v216, s[24:27], s34 offen sc1 lds
    s_branch C_dmaeQ
C_dmaQ1:
    s_mov_b32 m0, 38912
    s_add_u32 s34, s28, 137216
    buffer_load_dwordx4 v216, s[24:27], s34 offen sc1 lds
    s_mov_b32 m0, 39936
    s_add_u32 s34, s28, 138240
    buffer_load_dwordx4 v216, s[24:27], s34 offen sc1 lds
    s_mov_b32 m0, 40960
    s_add_u32 s34, s29, 8192
    buffer_load_dwordx4 v216, s[24:27], s34 offen sc1 lds
    s_mov_b32 m0, 41984
    s_add_u32 s34, s29, 9216
    buffer_load_dwordx4 v216, s[24:27], s34 offen sc1 lds
    s_mov_b32 m0, 43008
    s_add_u32 s34, s29, 10240
    buffer_load_dwordx4 v216, s[24:27], s34 offen sc1 lds
    s_mov_b32 m0, 44032
    s_add_u32 s34, s29, 11264
    buffer_load_dwordx4 v216, s[24:27], s34 offen sc1 lds
    s_mov_b32 m0, 45056
    s_add_u32 s34, s29, 12288
    buffer_load_dwordx4 v216, s[24:27], s34 offen sc1 lds
    s_mov_b32 m0, 46080
    s_add_u32 s34, s29, 13312
    buffer_load_dwordx4 v216, s[24:27], s34 offen sc1 lds
    s_mov_b32 m0, 47104
    s_add_u32 s34, s29, 14336
    buffer_load_dwordx4 v216, s[24:27], s34 offen sc1 lds
    s_mov_b32 m0, 48128
    s_add_u32 s34, s29, 15360
    buffer_load_dwordx4 v216, s[24:27], s34 offen sc1 lds
    s_mov_b32 m0, 49152
    s_add_u32 s34, s28, 8192
    buffer_load_dwordx4 v216, s[24:27], s34 offen sc1 lds
    s_mov_b32 m0, 50176
    s_add_u32 s34, s28, 9216
    buffer_load_dwordx4 v216, s[24:27], s34 offen sc1 lds
    s_mov_b32 m0, 51200
    s_add_u32 s34, s28, 10240
    buffer_load_dwordx4 v216, s[24:27], s34 offen sc1 lds
    s_mov_b32 m0, 52224
    s_add_u32 s34, s28, 11264
    buffer_load_dwordx4 v216, s[24:27], s34 offen sc1 lds
    s_mov_b32 m0, 53248
    s_add_u32 s34, s28, 139264
    buffer_load_dwordx4 v216, s[24:27], s34 offen sc1 lds
    s_mov_b32 m0, 54272
    s_add_u32 s34, s28, 140288
    buffer_load_dwordx4 v216, s[24:27], s34 offen sc1 lds
    s_mov_b32 m0, 55296
    s_add_u32 s34, s28, 141312
    buffer_load_dwordx4 v216, s[24:27], s34 offen sc1 lds
    s_mov_b32 m0, 56320
    s_add_u32 s34, s28, 142336
    buffer_load_dwordx4 v216, s[24:27], s34 offen sc1 lds
    s_mov_b32 m0, 57344
    s_add_u32 s34, s29, 16384
    buffer_load_dwordx4 v216, s[24:27], s34 offen sc1 lds
    s_mov_b32 m0, 58368
    s_add_u32 s34, s29, 17408
    buffer_load_dwordx4 v216, s[24:27], s34 offen sc1 lds
    s_mov_b32 m0, 59392
    s_add_u32 s34, s29, 18432
    buffer_load_dwordx4 v216, s[24:27], s34 offen sc1 lds
    s_branch C_dmaeQ
C_dmaQ2:
C_dmaeQ:
    s_add_u32 s28, s28, 262144
    s_add_u32 s29, s29, 262144
    s_cmp_lg_u32 s33, 6
    s_cbranch_scc1 C_txQ
    buffer_load_dwordx4 v[232:235], v216, s[60:63], s37 offen
    buffer_load_dwordx4 v[232:235], v216, s[60:63], s38 offen
    s_add_u32 s37, s37, 131072
    s_add_u32 s38, s38, s39
    s_cmp_gt_u32 s41, 1
    s_cbranch_scc1 C_txQ
    buffer_load_dwordx4 v[232:235], v216, s[60:63], s100 offen
    s_add_u32 s100, s100, 81920
C_txQ:
    s_cmp_eq_u32 s33, 6
    s_cbranch_scc1 C_wdQ
    s_cmp_eq_u32 s31, 0
    s_cselect_b32 s34, s28, s29
    s_add_u32 s34, s34, s30
    s_add_u32 s34, s34, 262144
    buffer_load_dwordx4 v[232:235], v216, s[24:27], s34 offen
    buffer_load_dwordx4 v[232:235], v216, s[24:27], s34 offen offset:1024
C_wdQ:
    s_setprio 2
    s_barrier
    s_add_u32 s75, s43, 1
    s_and_b32 s3, s75, 3
    s_cmp_lg_u32 s3, 0
    s_cbranch_scc1 C_kvokQ
    s_cmp_ge_u32 s75, 64
    s_cbranch_scc1 C_kvokQ
    s_lshl_b32 s74, s40, 4
    s_lshr_b32 s3, s75, 2
    s_add_u32 s74, s74, s3
    s_lshl_b32 s3, s74, 7
    v_mov_b32 v254, 0
FW_5:
    buffer_load_dword v255, v254, s[76:79], s3 offen sc1
    s_waitcnt vmcnt(0)
    v_readfirstlane_b32 s75, v255
    s_cmp_ge_u32 s75, 16
    s_cbranch_scc1 FK_6
    s_sleep 2
    s_sub_u32 s44, s44, 1
    s_cbranch_scc0 FW_5
    s_branch M_done
FK_6:
C_kvokQ:
    s_waitcnt vmcnt(0)
    s_barrier
    s_branch C_qkv_loopQ
C_qretQ0:
    s_sub_u32 s44, s44, 1
    s_cbranch_scc1 M_done
    s_waitcnt vmcnt(0)
    buffer_load_dwordx4 v[160:163], v216, s[8:11], s16 offen offset:0 sc1
    buffer_load_dwordx4 v[164:167], v216, s[8:11], s16 offen offset:1024 sc1
    buffer_load_dwordx4 v[168:171], v216, s[8:11], s16 offen offset:2048 sc1
    buffer_load_dwordx4 v[172:175], v216, s[8:11], s16 offen offset:3072 sc1
    buffer_load_dwordx4 v[176:179], v218, s[8:11], s16 offen offset:0 sc1
    buffer_load_dwordx4 v[180:183], v218, s[8:11], s16 offen offset:1024 sc1
    buffer_load_dwordx4 v[184:187], v218, s[8:11], s16 offen offset:2048 sc1
    buffer_load_dwordx4 v[188:191], v218, s[8:11], s16 offen offset:3072 sc1
    buffer_load_dwordx4 v[192:195], v219, s[8:11], s16 offen offset:0 sc1
    buffer_load_dwordx4 v[196:199], v219, s[8:11], s16 offen offset:1024 sc1
    s_branch C_qchkQ0
C_qretQ1:
    s_sub_u32 s44, s44, 1
    s_cbranch_scc1 M_done
    s_waitcnt vmcnt(0)
    buffer_load_dwordx4 v[168:171], v216, s[8:11], s16 offen offset:2048 sc1
    buffer_load_dwordx4 v[172:175], v216, s[8:11], s16 offen offset:3072 sc1
    buffer_load_dwordx4 v[176:179], v218, s[8:11], s16 offen offset:0 sc1
    buffer_load_dwordx4 v[180:183], v218, s[8:11], s16 offen offset:1024 sc1
    buffer_load_dwordx4 v[184:187], v218, s[8:11], s16 offen offset:2048 sc1
    buffer_load_dwordx4 v[188:191], v218, s[8:11], s16 offen offset:3072 sc1
    buffer_load_dwordx4 v[192:195], v219, s[8:11], s16 offen offset:0 sc1
    buffer_load_dwordx4 v[196:199], v219, s[8:11], s16 offen offset:1024 sc1
    s_waitcnt vmcnt(6)
    v_max3_u32 v222, v168, v169, v170
    v_max3_u32 v222, v222, v171, v172
    v_max3_u32 v222, v222, v173, v174
    v_max_u32 v222, v222, v175
    v_cmp_eq_u32 vcc, -1, v222
    s_cbranch_vccz C_qmmQ1
    s_branch C_qretQ1
C_qretQ2:
    s_sub_u32 s44, s44, 1
    s_cbranch_scc1 M_done
    s_waitcnt vmcnt(0)
    buffer_load_dwordx4 v[176:179], v218, s[8:11], s16 offen offset:0 sc1
    buffer_load_dwordx4 v[180:183], v218, s[8:11], s16 offen offset:1024 sc1
    buffer_load_dwordx4 v[184:187], v218, s[8:11], s16 offen offset:2048 sc1
    buffer_load_dwordx4 v[188:191], v218, s[8:11], s16 offen offset:3072 sc1
    buffer_load_dwordx4 v[192:195], v219, s[8:11], s16 offen offset:0 sc1
    buffer_load_dwordx4 v[196:199], v219, s[8:11], s16 offen offset:1024 sc1
    s_waitcnt vmcnt(4)
    v_max3_u32 v222, v176, v177, v178
    v_max3_u32 v222, v222, v179, v180
    v_max3_u32 v222, v222, v181, v182
    v_max_u32 v222, v222, v183
    v_cmp_eq_u32 vcc, -1, v222
    s_cbranch_vccz C_qmmQ2
    s_branch C_qretQ2
C_qretQ3:
    s_sub_u32 s44, s44, 1
    s_cbranch_scc1 M_done
    s_waitcnt vmcnt(0)
    buffer_load_dwordx4 v[184:187], v218, s[8:11], s16 offen offset:2048 sc1
    buffer_load_dwordx4 v[188:191], v218, s[8:11], s16 offen offset:3072 sc1
    buffer_load_dwordx4 v[192:195], v219, s[8:11], s16 offen offset:0 sc1
    buffer_load_dwordx4 v[196:199], v219, s[8:11], s16 offen offset:1024 sc1
    s_waitcnt vmcnt(2)
    v_max3_u32 v222, v184, v185, v186
    v_max3_u32 v222, v222, v187, v188
    v_max3_u32 v222, v222, v189, v190
    v_max_u32 v222, v222, v191
    v_cmp_eq_u32 vcc, -1, v222
    s_cbranch_vccz C_qmmQ3
    s_branch C_qretQ3
C_qretQ4:
    s_sub_u32 s44, s44, 1
    s_cbranch_scc1 M_done
    s_waitcnt vmcnt(0)
    buffer_load_dwordx4 v[192:195], v219, s[8:11], s16 offen offset:0 sc1
    buffer_load_dwordx4 v[196:199], v219, s[8:11], s16 offen offset:1024 sc1
    s_waitcnt vmcnt(0)
    v_max3_u32 v222, v192, v193, v194
    v_max3_u32 v222, v222, v195, v196
    v_max3_u32 v222, v222, v197, v198
    v_max_u32 v222, v222, v199
    v_cmp_eq_u32 vcc, -1, v222
    s_cbranch_vccz C_qmmQ4
    s_branch C_qretQ4
C_qkv_loopV:
    s_sleep 3
    buffer_load_dwordx4 v[160:163], v216, s[8:11], s16 offen offset:0 sc1
    buffer_load_dwordx4 v[164:167], v216, s[8:11], s16 offen offset:1024 sc1
    buffer_load_dwordx4 v[168:171], v216, s[8:11], s16 offen offset:2048 sc1
    buffer_load_dwordx4 v[172:175], v216, s[8:11], s16 offen offset:3072 sc1
    buffer_load_dwordx4 v[176:179], v218, s[8:11], s16 offen offset:0 sc1
    buffer_load_dwordx4 v[180:183], v218, s[8:11], s16 offen offset:1024 sc1
    buffer_load_dwordx4 v[184:187], v218, s[8:11], s16 offen offset:2048 sc1
    buffer_load_dwordx4 v[188:191], v218, s[8:11], s16 offen offset:3072 sc1
    buffer_load_dwordx4 v[192:195], v219, s[8:11], s16 offen offset:0 sc1
    buffer_load_dwordx4 v[196:199], v219, s[8:11], s16 offen offset:1024 sc1
C_qchkV0:
    s_waitcnt vmcnt(8)
    v_max3_u32 v222, v160, v161, v162
    v_max3_u32 v222, v222, v163, v164
    v_max3_u32 v222, v222, v165, v166
    v_max_u32 v222, v222, v167
    v_cmp_eq_u32 vcc, -1, v222
    s_cbranch_vccnz C_qretV0
C_qmmV0:
    v_mfma_f32_16x16x32_bf16 v[200:203], v[160:163], v[0:3], 0
    v_mfma_f32_16x16x32_bf16 v[208:211], v[160:163], v[4:7], 0
    v_mfma_f32_16x16x32_bf16 v[204:207], v[160:163], v[8:11], 0
    v_mfma_f32_16x16x32_bf16 v[212:215], v[160:163], v[12:15], 0
    s_waitcnt vmcnt(6)
    v_mfma_f32_16x16x32_bf16 v[200:203], v[164:167], v[16:19], v[200:203]
    v_max3_u32 v222, v168, v169, v170
    v_max3_u32 v222, v222, v171, v172
    v_mfma_f32_16x16x32_bf16 v[208:211], v[164:167], v[20:23], v[208:211]
    v_max3_u32 v222, v222, v173, v174
    v_max_u32 v222, v222, v175
    v_mfma_f32_16x16x32_bf16 v[204:207], v[164:167], v[24:27], v[204:207]
    v_cmp_eq_u32 vcc, -1, v222
    v_mfma_f32_16x16x32_bf16 v[212:215], v[164:167], v[28:31], v[212:215]
    s_cbranch_vccnz C_qretV1
C_qmmV1:
    v_mfma_f32_16x16x32_bf16 v[200:203], v[168:171], v[32:35], v[200:203]
    v_mfma_f32_16x16x32_bf16 v[208:211], v[168:171], v[36:39], v[208:211]
    v_mfma_f32_16x16x32_bf16 v[204:207], v[168:171], v[40:43], v[204:207]
    v_mfma_f32_16x16x32_bf16 v[212:215], v[168:171], v[44:47], v[212:215]
    s_waitcnt vmcnt(4)
    v_mfma_f32_16x16x32_bf16 v[200:203], v[172:175], v[48:51], v[200:203]
    v_max3_u32 v222, v176, v177, v178
    v_max3_u32 v222, v222, v179, v180
    v_mfma_f32_16x16x32_bf16 v[208:211], v[172:175], v[52:55], v[208:211]
    v_max3_u32 v222, v222, v181, v182
    v_max_u32 v222, v222, v183
    v_mfma_f32_16x16x32_bf16 v[204:207], v[172:175], v[56:59], v[204:207]
    v_cmp_eq_u32 vcc, -1, v222
    v_mfma_f32_16x16x32_bf16 v[212:215], v[172:175], v[60:63], v[212:215]
    s_cbranch_vccnz C_qretV2
C_qmmV2:
    v_mfma_f32_16x16x32_bf16 v[200:203], v[176:179], v[64:67], v[200:203]
    v_mfma_f32_16x16x32_bf16 v[208:211], v[176:179], v[68:71], v[208:211]
    v_mfma_f32_16x16x32_bf16 v[204:207], v[176:179], v[72:75], v[204:207]
    v_mfma_f32_16x16x32_bf16 v[212:215], v[176:179], v[76:79], v[212:215]
    s_waitcnt vmcnt(2)
    v_mfma_f32_16x16x32_bf16 v[200:203], v[180:183], v[80:83], v[200:203]
    v_max3_u32 v222, v184, v185, v186
    v_max3_u32 v222, v222, v187, v188
    v_mfma_f32_16x16x32_bf16 v[208:211], v[180:183], v[84:87], v[208:211]
    v_max3_u32 v222, v222, v189, v190
    v_max_u32 v222, v222, v191
    v_mfma_f32_16x16x32_bf16 v[204:207], v[180:183], v[88:91], v[204:207]
    v_cmp_eq_u32 vcc, -1, v222
    v_mfma_f32_16x16x32_bf16 v[212:215], v[180:183], v[92:95], v[212:215]
    s_cbranch_vccnz C_qretV3
C_qmmV3:
    v_mfma_f32_16x16x32_bf16 v[200:203], v[184:187], v[96:99], v[200:203]
    v_mfma_f32_16x16x32_bf16 v[208:211], v[184:187], v[100:103], v[208:211]
    v_mfma_f32_16x16x32_bf16 v[204:207], v[184:187], v[104:107], v[204:207]
    v_mfma_f32_16x16x32_bf16 v[212:215], v[184:187], v[108:111], v[212:215]
    s_waitcnt vmcnt(0)
    v_mfma_f32_16x16x32_bf16 v[200:203], v[188:191], v[112:115], v[200:203]
    v_max3_u32 v222, v192, v193, v194
    v_max3_u32 v222, v222, v195, v196
    v_mfma_f32_16x16x32_bf16 v[208:211], v[188:191], v[116:119], v[208:211]
    v_max3_u32 v222, v222, v197, v198
    v_max_u32 v222, v222, v199
    v_mfma_f32_16x16x32_bf16 v[204:207], v[188:191], v[120:123], v[204:207]
    v_cmp_eq_u32 vcc, -1, v222
    v_mfma_f32_16x16x32_bf16 v[212:215], v[188:191], v[124:127], v[212:215]
    s_cbranch_vccnz C_qretV4
C_qmmV4:
    v_mfma_f32_16x16x32_bf16 v[200:203], v[192:195], v[128:131], v[200:203]
    v_mfma_f32_16x16x32_bf16 v[208:211], v[192:195], v[132:135], v[208:211]
    v_mfma_f32_16x16x32_bf16 v[204:207], v[192:195], v[136:139], v[204:207]
    v_mfma_f32_16x16x32_bf16 v[212:215], v[192:195], v[140:143], v[212:215]
    v_mfma_f32_16x16x32_bf16 v[200:203], v[196:199], v[144:147], v[200:203]
    v_mfma_f32_16x16x32_bf16 v[208:211], v[196:199], v[148:151], v[208:211]
    v_mfma_f32_16x16x32_bf16 v[204:207], v[196:199], v[152:155], v[204:207]
    v_mfma_f32_16x16x32_bf16 v[212:215], v[196:199], v[156:159], v[212:215]
    s_nop 6
    v_permlane32_swap_b32 v204, v224
    v_permlane32_swap_b32 v205, v225
    v_permlane32_swap_b32 v206, v226
    v_permlane32_swap_b32 v207, v227
    v_add_f32 v200, v200, v224
    v_add_f32 v201, v201, v225
    v_add_f32 v202, v202, v226
    v_add_f32 v203, v203, v227
    v_permlane32_swap_b32 v212, v224
    v_permlane32_swap_b32 v213, v225
    v_permlane32_swap_b32 v214, v226
    v_permlane32_swap_b32 v215, v227
    v_add_f32 v208, v208, v224
    v_add_f32 v209, v209, v225
    v_add_f32 v210, v210, v226
    v_add_f32 v211, v211, v227
    v_cvt_pk_bf16_f32 v224, v200, v201
    v_cvt_pk_bf16_f32 v225, v202, v203
    v_cvt_pk_bf16_f32 v226, v208, v209
    v_cvt_pk_bf16_f32 v227, v210, v211
    v_min_u32 v224, -2, v224
    v_min_u32 v225, -2, v225
    v_min_u32 v226, -2, v226
    v_min_u32 v227, -2, v227
    s_mov_b64 exec, s[20:21]
    s_cmp_lg_u32 s42, 0
    s_cbranch_scc1 XS_7
    buffer_store_dwordx4 v[224:227], v217, s[12:15], s17 offen
    s_branch XD_8
XS_7:
    buffer_store_dwordx4 v[224:227], v217, s[12:15], s17 offen sc1
XD_8:
    s_mov_b64 exec, -1
    s_add_u32 s43, s43, 1
    s_cmp_ge_u32 s43, 64
    s_cbranch_scc1 M_done
    s_add_u32 s17, s17, s18
    s_add_u32 s16, s16, 81920
    s_barrier
    s_setprio 0
    s_sleep 11
    s_mov_b32 m0, 60416
    s_add_u32 s34, s29, 19456
    buffer_load_dwordx4 v216, s[24:27], s34 offen sc1 lds
    s_mov_b32 m0, 61440
    s_add_u32 s34, s29, 20480
    buffer_load_dwordx4 v216, s[24:27], s34 offen sc1 lds
    s_mov_b32 m0, 62464
    s_add_u32 s34, s29, 21504
    buffer_load_dwordx4 v216, s[24:27], s34 offen sc1 lds
    s_mov_b32 m0, 63488
    s_add_u32 s34, s29, 22528
    buffer_load_dwordx4 v216, s[24:27], s34 offen sc1 lds
    s_mov_b32 m0, 64512
    s_add_u32 s34, s29, 23552
    buffer_load_dwordx4 v216, s[24:27], s34 offen sc1 lds
    s_mov_b32 m0, 65536
    s_add_u32 s34, s28, 12288
    buffer_load_dwordx4 v216, s[24:27], s34 offen sc1 lds
    s_mov_b32 m0, 66560
    s_add_u32 s34, s28, 13312
    buffer_load_dwordx4 v216, s[24:27], s34 offen sc1 lds
    s_mov_b32 m0, 67584
    s_add_u32 s34, s28, 14336
    buffer_load_dwordx4 v216, s[24:27], s34 offen sc1 lds
    s_mov_b32 m0, 68608
    s_add_u32 s34, s28, 15360
    buffer_load_dwordx4 v216, s[24:27], s34 offen sc1 lds
    s_mov_b32 m0, 69632
    s_add_u32 s34, s28, 143360
    buffer_load_dwordx4 v216, s[24:27], s34 offen sc1 lds
    s_mov_b32 m0, 70656
    s_add_u32 s34, s28, 144384
    buffer_load_dwordx4 v216, s[24:27], s34 offen sc1 lds
    s_mov_b32 m0, 71680
    s_add_u32 s34, s28, 145408
    buffer_load_dwordx4 v216, s[24:27], s34 offen sc1 lds
    s_mov_b32 m0, 72704
    s_add_u32 s34, s28, 146432
    buffer_load_dwordx4 v216, s[24:27], s34 offen sc1 lds
    s_mov_b32 m0, 73728
    s_add_u32 s34, s29, 24576
    buffer_load_dwordx4 v216, s[24:27], s34 offen sc1 lds
    s_mov_b32 m0, 74752
    s_add_u32 s34, s29, 25600
    buffer_load_dwordx4 v216, s[24:27], s34 offen sc1 lds
    s_mov_b32 m0, 75776
    s_add_u32 s34, s29, 26624
    buffer_load_dwordx4 v216, s[24:27], s34 offen sc1 lds
    s_mov_b32 m0, 76800
    s_add_u32 s34, s29, 27648
    buffer_load_dwordx4 v216, s[24:27], s34 offen sc1 lds
    s_mov_b32 m0, 77824
    s_add_u32 s34, s29, 28672
    buffer_load_dwordx4 v216, s[24:27], s34 offen sc1 lds
    s_mov_b32 m0, 78848
    s_add_u32 s34, s29, 29696
    buffer_load_dwordx4 v216, s[24:27], s34 offen sc1 lds
    s_mov_b32 m0, 79872
    s_add_u32 s34, s29, 30720
    buffer_load_dwordx4 v216, s[24:27], s34 offen sc1 lds
    s_mov_b32 m0, 80896
    s_add_u32 s34, s29, 31744
    buffer_load_dwordx4 v216, s[24:27], s34 offen sc1 lds
    s_branch C_dmaeV
C_dmaV3:
C_dmaeV:
    s_add_u32 s28, s28, 262144
    s_add_u32 s29, s29, 262144
    s_cmp_lg_u32 s33, 6
    s_cbranch_scc1 C_txV
    buffer_load_dwordx4 v[232:235], v216, s[60:63], s37 offen
    buffer_load_dwordx4 v[232:235], v216, s[60:63], s38 offen
    s_add_u32 s37, s37, 131072
    s_add_u32 s38, s38, s39
    s_cmp_gt_u32 s41, 1
    s_cbranch_scc1 C_txV
    buffer_load_dwordx4 v[232:235], v216, s[60:63], s100 offen
    s_add_u32 s100, s100, 81920
C_txV:
    s_cmp_eq_u32 s33, 6
    s_cbranch_scc1 C_wdV
    s_cmp_eq_u32 s31, 0
    s_cselect_b32 s34, s28, s29
    s_add_u32 s34, s34, s30
    s_add_u32 s34, s34, 262144
    buffer_load_dwordx4 v[232:235], v216, s[24:27], s34 offen
    buffer_load_dwordx4 v[232:235], v216, s[24:27], s34 offen offset:1024
C_wdV:
    s_setprio 2
    s_barrier
    s_add_u32 s75, s43, 1
    s_and_b32 s3, s75, 3
    s_cmp_lg_u32 s3, 0
    s_cbranch_scc1 C_kvokV
    s_cmp_ge_u32 s75, 64
    s_cbranch_scc1 C_kvokV
    s_lshl_b32 s74, s40, 4
    s_lshr_b32 s3, s75, 2
    s_add_u32 s74, s74, s3
    s_lshl_b32 s3, s74, 7
    v_mov_b32 v254, 0
FW_9:
    buffer_load_dword v255, v254, s[76:79], s3 offen sc1
    s_waitcnt vmcnt(0)
    v_readfirstlane_b32 s75, v255
    s_cmp_ge_u32 s75, 16
    s_cbranch_scc1 FK_10
    s_sleep 2
    s_sub_u32 s44, s44, 1
    s_cbranch_scc0 FW_9
    s_branch M_done
FK_10:
C_kvokV:
    s_waitcnt vmcnt(0)
    s_barrier
    s_branch C_qkv_loopV
C_qretV0:
    s_sub_u32 s44, s44, 1
    s_cbranch_scc1 M_done
    s_waitcnt vmcnt(0)
    buffer_load_dwordx4 v[160:163], v216, s[8:11], s16 offen offset:0 sc1
    buffer_load_dwordx4 v[164:167], v216, s[8:11], s16 offen offset:1024 sc1
    buffer_load_dwordx4 v[168:171], v216, s[8:11], s16 offen offset:2048 sc1
    buffer_load_dwordx4 v[172:175], v216, s[8:11], s16 offen offset:3072 sc1
    buffer_load_dwordx4 v[176:179], v218, s[8:11], s16 offen offset:0 sc1
    buffer_load_dwordx4 v[180:183], v218, s[8:11], s16 offen offset:1024 sc1
    buffer_load_dwordx4 v[184:187], v218, s[8:11], s16 offen offset:2048 sc1
    buffer_load_dwordx4 v[188:191], v218, s[8:11], s16 offen offset:3072 sc1
    buffer_load_dwordx4 v[192:195], v219, s[8:11], s16 offen offset:0 sc1
    buffer_load_dwordx4 v[196:199], v219, s[8:11], s16 offen offset:1024 sc1
    s_branch C_qchkV0
C_qretV1:
    s_sub_u32 s44, s44, 1
    s_cbranch_scc1 M_done
    s_waitcnt vmcnt(0)
    buffer_load_dwordx4 v[168:171], v216, s[8:11], s16 offen offset:2048 sc1
    buffer_load_dwordx4 v[172:175], v216, s[8:11], s16 offen offset:3072 sc1
    buffer_load_dwordx4 v[176:179], v218, s[8:11], s16 offen offset:0 sc1
    buffer_load_dwordx4 v[180:183], v218, s[8:11], s16 offen offset:1024 sc1
    buffer_load_dwordx4 v[184:187], v218, s[8:11], s16 offen offset:2048 sc1
    buffer_load_dwordx4 v[188:191], v218, s[8:11], s16 offen offset:3072 sc1
    buffer_load_dwordx4 v[192:195], v219, s[8:11], s16 offen offset:0 sc1
    buffer_load_dwordx4 v[196:199], v219, s[8:11], s16 offen offset:1024 sc1
    s_waitcnt vmcnt(6)
    v_max3_u32 v222, v168, v169, v170
    v_max3_u32 v222, v222, v171, v172
    v_max3_u32 v222, v222, v173, v174
    v_max_u32 v222, v222, v175
    v_cmp_eq_u32 vcc, -1, v222
    s_cbranch_vccz C_qmmV1
    s_branch C_qretV1
C_qretV2:
    s_sub_u32 s44, s44, 1
    s_cbranch_scc1 M_done
    s_waitcnt vmcnt(0)
    buffer_load_dwordx4 v[176:179], v218, s[8:11], s16 offen offset:0 sc1
    buffer_load_dwordx4 v[180:183], v218, s[8:11], s16 offen offset:1024 sc1
    buffer_load_dwordx4 v[184:187], v218, s[8:11], s16 offen offset:2048 sc1
    buffer_load_dwordx4 v[188:191], v218, s[8:11], s16 offen offset:3072 sc1
    buffer_load_dwordx4 v[192:195], v219, s[8:11], s16 offen offset:0 sc1
    buffer_load_dwordx4 v[196:199], v219, s[8:11], s16 offen offset:1024 sc1
    s_waitcnt vmcnt(4)
    v_max3_u32 v222, v176, v177, v178
    v_max3_u32 v222, v222, v179, v180
    v_max3_u32 v222, v222, v181, v182
    v_max_u32 v222, v222, v183
    v_cmp_eq_u32 vcc, -1, v222
    s_cbranch_vccz C_qmmV2
    s_branch C_qretV2
C_qretV3:
    s_sub_u32 s44, s44, 1
    s_cbranch_scc1 M_done
    s_waitcnt vmcnt(0)
    buffer_load_dwordx4 v[184:187], v218, s[8:11], s16 offen offset:2048 sc1
    buffer_load_dwordx4 v[188:191], v218, s[8:11], s16 offen offset:3072 sc1
    buffer_load_dwordx4 v[192:195], v219, s[8:11], s16 offen offset:0 sc1
    buffer_load_dwordx4 v[196:199], v219, s[8:11], s16 offen offset:1024 sc1
    s_waitcnt vmcnt(2)
    v_max3_u32 v222, v184, v185, v186
    v_max3_u32 v222, v222, v187, v188
    v_max3_u32 v222, v222, v189, v190
    v_max_u32 v222, v222, v191
    v_cmp_eq_u32 vcc, -1, v222
    s_cbranch_vccz C_qmmV3
    s_branch C_qretV3
C_qretV4:
    s_sub_u32 s44, s44, 1
    s_cbranch_scc1 M_done
    s_waitcnt vmcnt(0)
    buffer_load_dwordx4 v[192:195], v219, s[8:11], s16 offen offset:0 sc1
    buffer_load_dwordx4 v[196:199], v219, s[8:11], s16 offen offset:1024 sc1
    s_waitcnt vmcnt(0)
    v_max3_u32 v222, v192, v193, v194
    v_max3_u32 v222, v222, v195, v196
    v_max3_u32 v222, v222, v197, v198
    v_max_u32 v222, v222, v199
    v_cmp_eq_u32 vcc, -1, v222
    s_cbranch_vccz C_qmmV4
    s_branch C_qretV4
C_red:
    s_add_u32 s8, s58, 0x5e00000
    s_addc_u32 s9, s59, 0
    s_mov_b32 s10, 0xa00000
    s_mov_b32 s11, 0x20000
    s_add_u32 s12, s58, 0x4cec000
    s_addc_u32 s13, s59, 0
    s_mov_b32 s14, 0x500000
    s_mov_b32 s15, 0x20000
    v_lshlrev_b32 v1, 4, v0
    v_lshlrev_b32 v2, 3, v0
    s_lshl_b32 s3, s40, 4
    s_add_u32 s3, s3, s41
    s_mul_i32 s3, s3, 640
    v_add_u32 v3, s3, v2
    s_mul_i32 s3, s40, 640
    s_add_u32 s3, s3, 5120
    v_add_u32 v7, s3, v2
    s_mul_i32 s16, s40, 10240
    v_lshrrev_b32 v8, 3, v0
    s_mul_i32 s3, s41, 40
    v_lshl_add_u32 v8, v8, 2, s3
    v_and_b32 v4, 7, v0
    v_lshlrev_b32 v4, 4, v4
    v_lshrrev_b32 v6, 6, v8
    v_lshl_add_u32 v4, v6, 10, v4
    v_bfe_u32 v6, v8, 3, 2
    v_lshl_add_u32 v4, v6, 8, v4
    v_bfe_u32 v6, v8, 5, 1
    v_lshl_add_u32 v4, v6, 7, v4
    v_bfe_u32 v6, v8, 2, 1
    v_lshl_add_u32 v4, v6, 3, v4
    v_add_u32 v4, s16, v4
    v_lshrrev_b32 v8, 3, v0
    v_add_u32 v8, 8, v8
    s_mul_i32 s3, s41, 40
    v_lshl_add_u32 v8, v8, 2, s3
    v_and_b32 v5, 7, v0
    v_lshlrev_b32 v5, 4, v5
    v_lshrrev_b32 v6, 6, v8
    v_lshl_add_u32 v5, v6, 10, v5
    v_bfe_u32 v6, v8, 3, 2
    v_lshl_add_u32 v5, v6, 8, v5
    v_bfe_u32 v6, v8, 5, 1
    v_lshl_add_u32 v5, v6, 7, v5
    v_bfe_u32 v6, v8, 2, 1
    v_lshl_add_u32 v5, v6, 3, v5
    v_add_u32 v5, s16, v5
    s_add_u32 s92, s58, 0x5e00000
    s_addc_u32 s93, s59, 0
    s_mov_b32 s94, 0xa00000
    s_mov_b32 s95, 0x20000
    s_mov_b32 s96, 0
    s_mul_i32 s3, s41, 640
    v_add_u32 v140, s3, v1
    v_add_u32 v141, 10240, v140
    v_add_u32 v142, 20480, v140
    v_add_u32 v143, 30720, v140
    v_add_u32 v144, 40960, v140
    v_add_u32 v145, 51200, v140
    v_add_u32 v146, 61440, v140
    v_add_u32 v147, 71680, v140
    v_lshrrev_b32 v8, 2, v0
    s_mul_i32 s3, s41, 40
    v_lshl_add_u32 v8, v8, 2, s3
    v_and_b32 v148, 3, v0
    v_lshlrev_b32 v148, 5, v148
    v_lshrrev_b32 v6, 6, v8
    v_lshl_add_u32 v148, v6, 10, v148
    v_bfe_u32 v6, v8, 3, 2
    v_lshl_add_u32 v148, v6, 8, v148
    v_bfe_u32 v6, v8, 5, 1
    v_lshl_add_u32 v148, v6, 7, v148
    v_bfe_u32 v6, v8, 2, 1
    v_lshl_add_u32 v148, v6, 3, v148
    s_mul_i32 s3, s40, 10240
    v_add_u32 v148, s3, v148
    s_mov_b32 s22, 0x00003f80
    s_mov_b32 s23, 0x3f800000
    s_mov_b32 s3, 6
    s_add_u32 s97, s40, s3
    s_add_u32 s97, s97, 1
    s_and_b32 s97, s97, 7
    s_lshl_b32 s98, s97, 4
    s_add_u32 s98, s98, s41
    s_mul_i32 s98, s98, 640
    v_add_u32 v112, s98, v1
    s_mul_i32 s98, s97, 640
    s_add_u32 s98, s98, 5120
    v_add_u32 v113, s98, v1
    v_mov_b32 v120, 0
    v_mov_b32 v121, 0
    v_mov_b32 v122, 0
    v_mov_b32 v123, 0
    s_mov_b32 s16, 0
    s_mov_b32 s17, 81920
    s_setprio 3
    s_barrier
    s_barrier
C_red_loop:
    s_barrier
    s_barrier
    ds_read_b128 v[16:19], v1 offset:0
    ds_read_b128 v[20:23], v1 offset:1280
    ds_read_b128 v[24:27], v1 offset:2560
    ds_read_b128 v[28:31], v1 offset:3840
    ds_read_b128 v[32:35], v1 offset:1024
    ds_read_b128 v[36:39], v1 offset:2304
    ds_read_b128 v[40:43], v1 offset:3584
    ds_read_b128 v[44:47], v1 offset:4864
    s_waitcnt lgkmcnt(4)
    v_add_f32 v16, v16, v20
    v_add_f32 v24, v24, v28
    v_add_f32 v17, v17, v21
    v_add_f32 v25, v25, v29
    v_add_f32 v18, v18, v22
    v_add_f32 v26, v26, v30
    v_add_f32 v19, v19, v23
    v_add_f32 v27, v27, v31
    v_add_f32 v16, v16, v24
    v_add_f32 v17, v17, v25
    v_add_f32 v18, v18, v26
    v_add_f32 v19, v19, v27
    v_cvt_pk_bf16_f32 v16, v16, v17
    v_cvt_pk_bf16_f32 v17, v18, v19
    v_min_u32 v16, -2, v16
    v_min_u32 v17, -2, v17
    buffer_store_dwordx2 v[16:17], v3, s[8:11], s16 offen offset:0 sc1
    s_waitcnt lgkmcnt(0)
    v_add_f32 v32, v32, v36
    v_add_f32 v40, v40, v44
    v_add_f32 v33, v33, v37
    v_add_f32 v41, v41, v45
    v_add_f32 v34, v34, v38
    v_add_f32 v42, v42, v46
    v_add_f32 v35, v35, v39
    v_add_f32 v43, v43, v47
    v_add_f32 v32, v32, v40
    v_add_f32 v33, v33, v41
    v_add_f32 v34, v34, v42
    v_add_f32 v35, v35, v43
    v_cvt_pk_bf16_f32 v32, v32, v33
    v_cvt_pk_bf16_f32 v33, v34, v35
    v_min_u32 v32, -2, v32
    v_min_u32 v33, -2, v33
    s_mov_b64 exec, 0xffff
    buffer_store_dwordx2 v[32:33], v3, s[8:11], s16 offen offset:512 sc1
    s_mov_b32 exec_lo, -1
    s_mov_b32 exec_hi, 0xff
    s_sleep 12
C_sp:
    buffer_load_dwordx4 v[48:51], v140, s[8:11], s16 offen sc1
    buffer_load_dwordx4 v[52:55], v141, s[8:11], s16 offen sc1
    buffer_load_dwordx4 v[56:59], v142, s[8:11], s16 offen sc1
    buffer_load_dwordx4 v[60:63], v143, s[8:11], s16 offen sc1
    buffer_load_dwordx4 v[64:67], v144, s[8:11], s16 offen sc1
    buffer_load_dwordx4 v[68:71], v145, s[8:11], s16 offen sc1
    buffer_load_dwordx4 v[72:75], v146, s[8:11], s16 offen sc1
    buffer_load_dwordx4 v[76:79], v147, s[8:11], s16 offen sc1
    s_waitcnt vmcnt(0)
    v_max3_u32 v114, v48, v49, v50
    v_max3_u32 v114, v114, v51, v52
    v_max3_u32 v114, v114, v53, v54
    v_max3_u32 v114, v114, v55, v56
    v_max3_u32 v114, v114, v57, v58
    v_max3_u32 v114, v114, v59, v60
    v_max3_u32 v114, v114, v61, v62
    v_max3_u32 v114, v114, v63, v64
    v_max3_u32 v114, v114, v65, v66
    v_max3_u32 v114, v114, v67, v68
    v_max3_u32 v114, v114, v69, v70
    v_max3_u32 v114, v114, v71, v72
    v_max3_u32 v114, v114, v73, v74
    v_max3_u32 v114, v114, v75, v76
    v_max3_u32 v114, v114, v77, v78
    v_max_u32 v114, v114, v79
    v_cmp_eq_u32 vcc, -1, v114
    s_cbranch_vccz C_spk
    s_sub_u32 s44, s44, 1
    s_cbranch_scc0 C_sp
    s_branch M_done
C_spk:
    v_lshlrev_b32 v20, 16, v48
    v_and_b32 v21, 0xffff0000, v48
    v_lshlrev_b32 v22, 16, v49
    v_and_b32 v23, 0xffff0000, v49
    v_lshlrev_b32 v24, 16, v50
    v_and_b32 v25, 0xffff0000, v50
    v_lshlrev_b32 v26, 16, v51
    v_and_b32 v27, 0xffff0000, v51
    v_dot2c_f32_bf16 v20, s22, v52
    v_dot2c_f32_bf16 v21, s23, v52
    v_dot2c_f32_bf16 v22, s22, v53
    v_dot2c_f32_bf16 v23, s23, v53
    v_dot2c_f32_bf16 v24, s22, v54
    v_dot2c_f32_bf16 v25, s23, v54
    v_dot2c_f32_bf16 v26, s22, v55
    v_dot2c_f32_bf16 v27, s23, v55
    v_dot2c_f32_bf16 v20, s22, v56
    v_dot2c_f32_bf16 v21, s23, v56
    v_dot2c_f32_bf16 v22, s22, v57
    v_dot2c_f32_bf16 v23, s23, v57
    v_dot2c_f32_bf16 v24, s22, v58
    v_dot2c_f32_bf16 v25, s23, v58
    v_dot2c_f32_bf16 v26, s22, v59
    v_dot2c_f32_bf16 v27, s23, v59
    v_dot2c_f32_bf16 v20, s22, v60
    v_dot2c_f32_bf16 v21, s23, v60
    v_dot2c_f32_bf16 v22, s22, v61
    v_dot2c_f32_bf16 v23, s23, v61
    v_dot2c_f32_bf16 v24, s22, v62
    v_dot2c_f32_bf16 v25, s23, v62
    v_dot2c_f32_bf16 v26, s22, v63
    v_dot2c_f32_bf16 v27, s23, v63
    v_dot2c_f32_bf16 v20, s22, v64
    v_dot2c_f32_bf16 v21, s23, v64
    v_dot2c_f32_bf16 v22, s22, v65
    v_dot2c_f32_bf16 v23, s23, v65
    v_dot2c_f32_bf16 v24, s22, v66
    v_dot2c_f32_bf16 v25, s23, v66
    v_dot2c_f32_bf16 v26, s22, v67
    v_dot2c_f32_bf16 v27, s23, v67
    v_dot2c_f32_bf16 v20, s22, v68
    v_dot2c_f32_bf16 v21, s23, v68
    v_dot2c_f32_bf16 v22, s22, v69
    v_dot2c_f32_bf16 v23, s23, v69
    v_dot2c_f32_bf16 v24, s22, v70
    v_dot2c_f32_bf16 v25, s23, v70
    v_dot2c_f32_bf16 v26, s22, v71
    v_dot2c_f32_bf16 v27, s23, v71
    v_dot2c_f32_bf16 v20, s22, v72
    v_dot2c_f32_bf16 v21, s23, v72
    v_dot2c_f32_bf16 v22, s22, v73
    v_dot2c_f32_bf16 v23, s23, v73
    v_dot2c_f32_bf16 v24, s22, v74
    v_dot2c_f32_bf16 v25, s23, v74
    v_dot2c_f32_bf16 v26, s22, v75
    v_dot2c_f32_bf16 v27, s23, v75
    v_dot2c_f32_bf16 v20, s22, v76
    v_dot2c_f32_bf16 v21, s23, v76
    v_dot2c_f32_bf16 v22, s22, v77
    v_dot2c_f32_bf16 v23, s23, v77
    v_dot2c_f32_bf16 v24, s22, v78
    v_dot2c_f32_bf16 v25, s23, v78
    v_dot2c_f32_bf16 v26, s22, v79
    v_dot2c_f32_bf16 v27, s23, v79
    s_nop 2
    v_cvt_pk_bf16_f32 v28, v20, v21
    v_cvt_pk_bf16_f32 v29, v22, v23
    v_cvt_pk_bf16_f32 v30, v24, v25
    v_cvt_pk_bf16_f32 v31, v26, v27
    v_min_u32 v28, -2, v28
    v_min_u32 v29, -2, v29
    v_min_u32 v30, -2, v30
    v_min_u32 v31, -2, v31
    s_cmp_lg_u32 s42, 0
    s_cbranch_scc1 XS_11
    buffer_store_dwordx2 v[28:29], v148, s[12:15], s17 offen
    s_branch XD_12
XS_11:
    buffer_store_dwordx2 v[28:29], v148, s[12:15], s17 offen sc1
XD_12:
    s_cmp_lg_u32 s42, 0
    s_cbranch_scc1 XS_13
    buffer_store_dwordx2 v[30:31], v148, s[12:15], s17 offen offset:16
    s_branch XD_14
XS_13:
    buffer_store_dwordx2 v[30:31], v148, s[12:15], s17 offen offset:16 sc1
XD_14:
    s_mov_b64 exec, -1
    s_barrier
    s_add_u32 s43, s43, 1
    s_cmp_ge_u32 s43, 63
    s_cbranch_scc1 M_done
    s_add_u32 s16, s16, 81920
    s_add_u32 s17, s17, 81920
    s_branch C_red_loop
C_attn:
    s_lshl_b32 s46, s40, 2
    s_add_u32 s46, s46, s33
    v_lshlrev_b32 v228, 4, v0
    s_mov_b32 s4, s54
    s_mov_b32 s5, s55
    s_mov_b32 s6, 0x500000
    s_mov_b32 s7, 0x20000
    s_mul_i32 s3, s46, 163840
    s_mul_i32 s8, s41, 80
    s_add_u32 s3, s3, s8
    s_mul_i32 s8, s33, 12288
    s_add_u32 s8, s8, 81920
    s_mov_b32 s9, 0x2aaaaaab
    v_add_u32 v240, 0, v0
    v_mul_hi_u32 v241, v240, s9
    v_mul_u32_u24 v242, 6, v241
    v_sub_u32 v242, v240, v242
    v_mul_u32_u24 v241, 1280, v241
    v_lshl_add_u32 v241, v242, 4, v241
    s_add_u32 m0, s8, 0
    s_nop 0
    buffer_load_dwordx4 v241, s[4:7], s3 offen lds
    v_add_u32 v240, 64, v0
    v_mul_hi_u32 v241, v240, s9
    v_mul_u32_u24 v242, 6, v241
    v_sub_u32 v242, v240, v242
    v_mul_u32_u24 v241, 1280, v241
    v_lshl_add_u32 v241, v242, 4, v241
    s_add_u32 m0, s8, 1024
    s_nop 0
    buffer_load_dwordx4 v241, s[4:7], s3 offen lds
    v_add_u32 v240, 128, v0
    v_mul_hi_u32 v241, v240, s9
    v_mul_u32_u24 v242, 6, v241
    v_sub_u32 v242, v240, v242
    v_mul_u32_u24 v241, 1280, v241
    v_lshl_add_u32 v241, v242, 4, v241
    s_add_u32 m0, s8, 2048
    s_nop 0
    buffer_load_dwordx4 v241, s[4:7], s3 offen lds
    v_add_u32 v240, 192, v0
    v_mul_hi_u32 v241, v240, s9
    v_mul_u32_u24 v242, 6, v241
    v_sub_u32 v242, v240, v242
    v_mul_u32_u24 v241, 1280, v241
    v_lshl_add_u32 v241, v242, 4, v241
    s_add_u32 m0, s8, 3072
    s_nop 0
    buffer_load_dwordx4 v241, s[4:7], s3 offen lds
    v_add_u32 v240, 256, v0
    v_mul_hi_u32 v241, v240, s9
    v_mul_u32_u24 v242, 6, v241
    v_sub_u32 v242, v240, v242
    v_mul_u32_u24 v241, 1280, v241
    v_lshl_add_u32 v241, v242, 4, v241
    s_add_u32 m0, s8, 4096
    s_nop 0
    buffer_load_dwordx4 v241, s[4:7], s3 offen lds
    v_add_u32 v240, 320, v0
    v_mul_hi_u32 v241, v240, s9
    v_mul_u32_u24 v242, 6, v241
    v_sub_u32 v242, v240, v242
    v_mul_u32_u24 v241, 1280, v241
    v_lshl_add_u32 v241, v242, 4, v241
    s_add_u32 m0, s8, 5120
    s_nop 0
    buffer_load_dwordx4 v241, s[4:7], s3 offen lds
    v_add_u32 v240, 384, v0
    v_mul_hi_u32 v241, v240, s9
    v_mul_u32_u24 v242, 6, v241
    v_sub_u32 v242, v240, v242
    v_mul_u32_u24 v241, 1280, v241
    v_lshl_add_u32 v241, v242, 4, v241
    s_add_u32 m0, s8, 6144
    s_nop 0
    buffer_load_dwordx4 v241, s[4:7], s3 offen lds
    v_add_u32 v240, 448, v0
    v_mul_hi_u32 v241, v240, s9
    v_mul_u32_u24 v242, 6, v241
    v_sub_u32 v242, v240, v242
    v_mul_u32_u24 v241, 1280, v241
    v_lshl_add_u32 v241, v242, 4, v241
    s_add_u32 m0, s8, 7168
    s_nop 0
    buffer_load_dwordx4 v241, s[4:7], s3 offen lds
    v_add_u32 v240, 512, v0
    v_mul_hi_u32 v241, v240, s9
    v_mul_u32_u24 v242, 6, v241
    v_sub_u32 v242, v240, v242
    v_mul_u32_u24 v241, 1280, v241
    v_lshl_add_u32 v241, v242, 4, v241
    s_add_u32 m0, s8, 8192
    s_nop 0
    buffer_load_dwordx4 v241, s[4:7], s3 offen lds
    v_add_u32 v240, 576, v0
    v_mul_hi_u32 v241, v240, s9
    v_mul_u32_u24 v242, 6, v241
    v_sub_u32 v242, v240, v242
    v_mul_u32_u24 v241, 1280, v241
    v_lshl_add_u32 v241, v242, 4, v241
    s_add_u32 m0, s8, 9216
    s_nop 0
    buffer_load_dwordx4 v241, s[4:7], s3 offen lds
    v_add_u32 v240, 640, v0
    v_mul_hi_u32 v241, v240, s9
    v_mul_u32_u24 v242, 6, v241
    v_sub_u32 v242, v240, v242
    v_mul_u32_u24 v241, 1280, v241
    v_lshl_add_u32 v241, v242, 4, v241
    s_add_u32 m0, s8, 10240
    s_nop 0
    buffer_load_dwordx4 v241, s[4:7], s3 offen lds
    v_add_u32 v240, 704, v0
    v_mul_hi_u32 v241, v240, s9
    v_mul_u32_u24 v242, 6, v241
    v_sub_u32 v242, v240, v242
    v_mul_u32_u24 v241, 1280, v241
    v_lshl_add_u32 v241, v242, 4, v241
    s_add_u32 m0, s8, 11264
    s_nop 0
    buffer_load_dwordx4 v241, s[4:7], s3 offen lds
    v_lshrrev_b32 v238, 2, v0
    v_mul_u32_u24 v238, 96, v238
    v_and_b32 v239, 3, v0
    v_lshl_add_u32 v238, v239, 3, v238
    v_add_u32 v238, s8, v238
    s_waitcnt vmcnt(0)
    ds_read_b64_tr_b16 v[64:65], v238 offset:0
    ds_read_b64_tr_b16 v[66:67], v238 offset:1536
    ds_read_b64_tr_b16 v[68:69], v238 offset:3072
    ds_read_b64_tr_b16 v[70:71], v238 offset:4608
    ds_read_b64_tr_b16 v[72:73], v238 offset:6144
    ds_read_b64_tr_b16 v[74:75], v238 offset:7680
    ds_read_b64_tr_b16 v[76:77], v238 offset:9216
    ds_read_b64_tr_b16 v[78:79], v238 offset:10752
    ds_read_b64_tr_b16 v[80:81], v238 offset:32
    ds_read_b64_tr_b16 v[82:83], v238 offset:1568
    ds_read_b64_tr_b16 v[84:85], v238 offset:3104
    ds_read_b64_tr_b16 v[86:87], v238 offset:4640
    ds_read_b64_tr_b16 v[88:89], v238 offset:6176
    ds_read_b64_tr_b16 v[90:91], v238 offset:7712
    ds_read_b64_tr_b16 v[92:93], v238 offset:9248
    ds_read_b64_tr_b16 v[94:95], v238 offset:10784
    ds_read_b64_tr_b16 v[96:97], v238 offset:64
    ds_read_b64_tr_b16 v[98:99], v238 offset:1600
    ds_read_b64_tr_b16 v[100:101], v238 offset:3136
    ds_read_b64_tr_b16 v[102:103], v238 offset:4672
    ds_read_b64_tr_b16 v[104:105], v238 offset:6208
    ds_read_b64_tr_b16 v[106:107], v238 offset:7744
    ds_read_b64_tr_b16 v[108:109], v238 offset:9280
    ds_read_b64_tr_b16 v[110:111], v238 offset:10816
    s_waitcnt lgkmcnt(0)
    s_barrier
    s_add_u32 s16, s58, 0x5200000
    s_addc_u32 s17, s59, 0
    s_mov_b32 s18, 0x800000
    s_mov_b32 s19, 0x20000
    s_add_u32 s20, s58, 0x5a00000
    s_addc_u32 s21, s59, 0
    s_mov_b32 s22, 0x400000
    s_mov_b32 s23, 0x20000
    s_lshl_b32 s3, s33, 14
    s_add_u32 s3, s3, 16384
    v_add_u32 v229, s3, v228
    v_and_b32 v230, 31, v0
    v_lshlrev_b32 v230, 4, v230
    v_and_b32 v240, 7, v0
    v_lshlrev_b32 v240, 4, v240
    v_lshrrev_b32 v241, 4, v0
    v_lshl_add_u32 v240, v241, 7, v240
    s_mul_i32 s3, s33, 1280
    v_add_u32 v240, s3, v240
    v_add_u32 v242, 15360, v228
    v_and_b32 v241, 15, v0
    v_cmp_gt_u32 vcc, 8, v241
    v_cmp_gt_u32 s[10:11], 32, v0
    s_and_b64 s[10:11], s[10:11], vcc
    v_add_u32 v241, 512, v240
    v_add_u32 v243, 1024, v240
    v_cndmask_b32 v231, v242, v240, vcc
    v_cndmask_b32 v232, v242, v241, vcc
    v_cndmask_b32 v233, v242, v243, s[10:11]
    v_mov_b32 v234, 0xf149f2ca
    v_cmp_gt_u32 vcc, 32, v0
    s_nop 1
    v_cndmask_b32 v156, 0, v234, vcc
    v_cndmask_b32 v157, 0, v234, vcc
    v_cndmask_b32 v158, 0, v234, vcc
    v_cndmask_b32 v159, 0, v234, vcc
    v_mov_b32 v128, 0
    v_mov_b32 v129, 0
    v_mov_b32 v130, 0
    v_mov_b32 v131, 0
    v_mov_b32 v132, 0
    v_mov_b32 v133, 0
    v_mov_b32 v134, 0
    v_mov_b32 v135, 0
    v_mov_b32 v136, 0
    v_mov_b32 v137, 0
    v_mov_b32 v138, 0
    v_mov_b32 v139, 0
    v_mov_b32 v140, 0
    v_mov_b32 v141, 0
    v_mov_b32 v142, 0
    v_mov_b32 v143, 0
    s_lshl_b32 s26, s46, 12
    s_lshl_b32 s27, s46, 11
    s_mov_b32 s28, 0x3e0293ee
    s_add_u32 s92, s58, 0x5e00000
    s_addc_u32 s93, s59, 0
    s_mov_b32 s94, 0xa00000
    s_mov_b32 s95, 0x20000
    s_mov_b32 s96, 0
    s_add_u32 s97, s40, s33
    s_add_u32 s97, s97, 1
    s_and_b32 s97, s97, 7
    s_lshl_b32 s98, s97, 4
    s_add_u32 s98, s98, s41
    s_mul_i32 s98, s98, 640
    v_add_u32 v237, s98, v228
    s_mul_i32 s98, s97, 640
    s_add_u32 s98, s98, 5120
    v_add_u32 v238, s98, v228
    s_add_u32 s3, s33, 4
    s_add_u32 s97, s40, s3
    s_add_u32 s97, s97, 1
    s_and_b32 s97, s97, 7
    s_lshl_b32 s98, s97, 4
    s_add_u32 s98, s98, s41
    s_mul_i32 s98, s98, 640
    v_add_u32 v166, s98, v228
    s_mul_i32 s98, s97, 640
    s_add_u32 s98, s98, 5120
    v_add_u32 v167, s98, v228
    v_mov_b32 v244, 0
    v_mov_b32 v245, 0
    v_mov_b32 v246, 0
    v_mov_b32 v247, 0
    s_setprio 1
    s_barrier
    ds_read_b128 v[0:3], v229 offset:0
    ds_read_b128 v[4:7], v229 offset:1024
    ds_read_b128 v[8:11], v229 offset:2048
    ds_read_b128 v[12:15], v229 offset:3072
    ds_read_b128 v[16:19], v229 offset:4096
    ds_read_b128 v[20:23], v229 offset:5120
    ds_read_b128 v[24:27], v229 offset:6144
    ds_read_b128 v[28:31], v229 offset:7168
    ds_read_b128 v[32:35], v229 offset:8192
    ds_read_b128 v[36:39], v229 offset:9216
    ds_read_b128 v[40:43], v229 offset:10240
    ds_read_b128 v[44:47], v229 offset:11264
    ds_read_b128 v[48:51], v229 offset:12288
    ds_read_b128 v[52:55], v229 offset:13312
    ds_read_b128 v[56:59], v229 offset:14336
    ds_read_b128 v[60:63], v229 offset:15360
    s_waitcnt lgkmcnt(0)
C_at_loop:
    s_barrier
    buffer_load_dwordx4 v[112:115], v228, s[16:19], s26 offen offset:0 sc1
    buffer_load_dwordx4 v[116:119], v228, s[16:19], s26 offen offset:1024 sc1
    buffer_load_dwordx4 v[120:123], v228, s[16:19], s26 offen offset:2048 sc1
    buffer_load_dwordx4 v[124:127], v228, s[16:19], s26 offen offset:3072 sc1
    s_mov_b32 exec_lo, 0
    buffer_load_dwordx4 v[128:131], v230, s[20:23], s27 offen offset:0 sc1
    buffer_load_dwordx4 v[132:135], v230, s[20:23], s27 offen offset:512 sc1
    buffer_load_dwordx4 v[136:139], v230, s[20:23], s27 offen offset:1024 sc1
    buffer_load_dwordx4 v[140:143], v230, s[20:23], s27 offen offset:1536 sc1
    s_mov_b32 exec_lo, -1
C_at_chk:
    s_waitcnt vmcnt(4)
    v_max3_u32 v234, v112, v113, v114
    v_max3_u32 v234, v234, v115, v116
    v_max3_u32 v234, v234, v117, v118
    v_max3_u32 v234, v234, v119, v120
    v_max3_u32 v234, v234, v121, v122
    v_max3_u32 v234, v234, v123, v124
    v_max3_u32 v234, v234, v125, v126
    v_max_u32 v234, v234, v127
    v_cmp_eq_u32 vcc, -1, v234
    s_cbranch_vccnz C_at_ret
    v_mfma_f32_16x16x32_bf16 v[144:147], v[0:3], v[112:115], 0
    v_mfma_f32_16x16x32_bf16 v[144:147], v[4:7], v[116:119], v[144:147]
    v_mfma_f32_16x16x32_bf16 v[144:147], v[8:11], v[120:123], v[144:147]
    v_mfma_f32_16x16x32_bf16 v[144:147], v[12:15], v[124:127], v[144:147]
    s_waitcnt vmcnt(0)
    v_mfma_f32_16x16x32_bf16 v[148:151], v[16:19], v[112:115], 0
    v_max3_u32 v235, v128, v129, v130
    v_max3_u32 v235, v235, v131, v132
    v_mfma_f32_16x16x32_bf16 v[148:151], v[20:23], v[116:119], v[148:151]
    v_max3_u32 v235, v235, v133, v134
    v_max3_u32 v235, v235, v135, v136
    v_mfma_f32_16x16x32_bf16 v[148:151], v[24:27], v[120:123], v[148:151]
    v_max3_u32 v235, v235, v137, v138
    v_max3_u32 v235, v235, v139, v140
    v_mfma_f32_16x16x32_bf16 v[148:151], v[28:31], v[124:127], v[148:151]
    v_max3_u32 v235, v235, v141, v142
    v_max_u32 v235, v235, v143
    v_cmp_eq_u32 vcc, -1, v235
    s_cbranch_vccnz C_at_vret
C_at_vok:
    v_mfma_f32_16x16x32_bf16 v[152:155], v[112:115], v[112:115], v[156:159]
    v_max3_f32 v234, v144, v145, v146
    v_mfma_f32_16x16x32_bf16 v[152:155], v[116:119], v[116:119], v[152:155]
    v_max_f32 v234, v234, v147
    v_mfma_f32_16x16x32_bf16 v[152:155], v[120:123], v[120:123], v[152:155]
    v_mfma_f32_16x16x32_bf16 v[152:155], v[124:127], v[124:127], v[152:155]
    s_nop 3
    v_max3_f32 v234, v234, v148, v149
    v_max3_f32 v234, v234, v150, v151
    s_nop 1
    v_max3_f32 v234, v234, v152, v153
    v_max3_f32 v234, v234, v154, v155
    v_mov_b32 v235, v234
    s_nop 1
    v_permlane32_swap_b32 v234, v235
    v_max_f32 v234, v234, v235
    v_mov_b32 v235, v234
    s_nop 1
    v_permlane16_swap_b32 v234, v235
    v_max_f32 v234, v234, v235
    v_mul_f32 v234, s28, v234
    v_fma_f32 v144, v144, s28, -v234
    v_fma_f32 v145, v145, s28, -v234
    v_fma_f32 v146, v146, s28, -v234
    v_fma_f32 v147, v147, s28, -v234
    v_fma_f32 v148, v148, s28, -v234
    v_fma_f32 v149, v149, s28, -v234
    v_fma_f32 v150, v150, s28, -v234
    v_fma_f32 v151, v151, s28, -v234
    v_exp_f32 v144, v144
    v_exp_f32 v145, v145
    v_exp_f32 v146, v146
    v_exp_f32 v147, v147
    v_exp_f32 v148, v148
    v_exp_f32 v149, v149
    v_exp_f32 v150, v150
    v_exp_f32 v151, v151
    v_fma_f32 v152, v152, s28, -v234
    v_fma_f32 v153, v153, s28, -v234
    v_fma_f32 v154, v154, s28, -v234
    v_fma_f32 v155, v155, s28, -v234
    v_cvt_pk_bf16_f32 v160, v144, v145
    v_cvt_pk_bf16_f32 v161, v146, v147
    v_cvt_pk_bf16_f32 v162, v148, v149
    v_cvt_pk_bf16_f32 v163, v150, v151
    v_exp_f32 v152, v152
    v_exp_f32 v153, v153
    v_mfma_f32_16x16x32_bf16 v[168:171], v[32:35], v[160:163], 0
    v_exp_f32 v154, v154
    v_mfma_f32_16x16x32_bf16 v[172:175], v[36:39], v[160:163], 0
    v_exp_f32 v155, v155
    v_mfma_f32_16x16x32_bf16 v[176:179], v[40:43], v[160:163], 0
    v_cvt_pk_bf16_f32 v164, v152, v153
    v_cvt_pk_bf16_f32 v165, v154, v155
    v_mfma_f32_16x16x32_bf16 v[180:183], v[44:47], v[160:163], 0
    v_add_f32 v236, v144, v145
    v_add_f32 v236, v236, v146
    v_add_f32 v236, v236, v147
    v_mfma_f32_16x16x16_bf16 v[168:171], v[128:129], v[164:165], v[168:171]
    v_add_f32 v236, v236, v148
    v_add_f32 v236, v236, v149
    v_mfma_f32_16x16x16_bf16 v[172:175], v[130:131], v[164:165], v[172:175]
    v_add_f32 v236, v236, v150
    v_add_f32 v236, v236, v151
    v_mfma_f32_16x16x16_bf16 v[176:179], v[132:133], v[164:165], v[176:179]
    v_add_f32 v236, v236, v152
    v_add_f32 v236, v236, v153
    v_mfma_f32_16x16x16_bf16 v[180:183], v[134:135], v[164:165], v[180:183]
    v_add_f32 v236, v236, v154
    v_add_f32 v236, v236, v155
    v_mfma_f32_16x16x32_bf16 v[184:187], v[48:51], v[160:163], 0
    v_mov_b32 v235, v236
    v_mfma_f32_16x16x32_bf16 v[188:191], v[52:55], v[160:163], 0
    v_cvt_pk_bf16_f32 v200, v168, v169
    v_cvt_pk_bf16_f32 v201, v170, v171
    v_cvt_pk_bf16_f32 v202, v172, v173
    v_cvt_pk_bf16_f32 v203, v174, v175
    v_mfma_f32_16x16x32_bf16 v[192:195], v[56:59], v[160:163], 0
    v_permlane32_swap_b32 v236, v235
    v_mfma_f32_16x16x32_bf16 v[196:199], v[60:63], v[160:163], 0
    v_cvt_pk_bf16_f32 v204, v176, v177
    v_cvt_pk_bf16_f32 v205, v178, v179
    v_cvt_pk_bf16_f32 v206, v180, v181
    v_cvt_pk_bf16_f32 v207, v182, v183
    v_mfma_f32_16x16x16_bf16 v[184:187], v[136:137], v[164:165], v[184:187]
    v_add_f32 v236, v236, v235
    v_mfma_f32_16x16x16_bf16 v[188:191], v[138:139], v[164:165], v[188:191]
    v_mov_b32 v235, v236
    v_mfma_f32_16x16x16_bf16 v[192:195], v[140:141], v[164:165], v[192:195]
    v_mfma_f32_16x16x16_bf16 v[196:199], v[142:143], v[164:165], v[196:199]
    v_mfma_f32_16x16x32_bf16 v[216:219], v[64:67], v[200:203], 0
    v_mfma_f32_16x16x32_bf16 v[220:223], v[80:83], v[200:203], 0
    v_mfma_f32_16x16x32_bf16 v[224:227], v[96:99], v[200:203], 0
    v_permlane16_swap_b32 v236, v235
    v_add_f32 v236, v236, v235
    v_mfma_f32_16x16x32_bf16 v[216:219], v[68:71], v[204:207], v[216:219]
    v_mfma_f32_16x16x32_bf16 v[220:223], v[84:87], v[204:207], v[220:223]
    v_mfma_f32_16x16x32_bf16 v[224:227], v[100:103], v[204:207], v[224:227]
    v_rcp_f32 v236, v236
    v_cvt_pk_bf16_f32 v208, v184, v185
    v_cvt_pk_bf16_f32 v209, v186, v187
    v_cvt_pk_bf16_f32 v210, v188, v189
    v_cvt_pk_bf16_f32 v211, v190, v191
    v_cvt_pk_bf16_f32 v212, v192, v193
    v_cvt_pk_bf16_f32 v213, v194, v195
    v_cvt_pk_bf16_f32 v214, v196, v197
    v_cvt_pk_bf16_f32 v215, v198, v199
    v_mfma_f32_16x16x32_bf16 v[216:219], v[72:75], v[208:211], v[216:219]
    v_mfma_f32_16x16x32_bf16 v[220:223], v[88:91], v[208:211], v[220:223]
    v_mfma_f32_16x16x32_bf16 v[224:227], v[104:107], v[208:211], v[224:227]
    v_mfma_f32_16x16x32_bf16 v[216:219], v[76:79], v[212:215], v[216:219]
    v_mfma_f32_16x16x32_bf16 v[220:223], v[92:95], v[212:215], v[220:223]
    v_mfma_f32_16x16x32_bf16 v[224:227], v[108:111], v[212:215], v[224:227]
    s_nop 5
    v_mul_f32 v216, v216, v236
    v_mul_f32 v217, v217, v236
    v_mul_f32 v218, v218, v236
    v_mul_f32 v219, v219, v236
    v_mul_f32 v220, v220, v236
    v_mul_f32 v221, v221, v236
    v_mul_f32 v222, v222, v236
    v_mul_f32 v223, v223, v236
    v_mul_f32 v224, v224, v236
    v_mul_f32 v225, v225, v236
    v_mul_f32 v226, v226, v236
    v_mul_f32 v227, v227, v236
    ds_write_b128 v231, v[216:219]
    ds_write_b128 v232, v[220:223]
    ds_write_b128 v233, v[224:227]
    s_waitcnt lgkmcnt(0)
    s_barrier
    s_add_u32 s43, s43, 1
    s_cmp_ge_u32 s43, 63
    s_cbranch_scc1 M_done
    s_add_u32 s26, s26, 131072
    s_add_u32 s27, s27, 65536
    s_barrier
    ds_read_b128 v[0:3], v229 offset:0
    ds_read_b128 v[4:7], v229 offset:1024
    ds_read_b128 v[8:11], v229 offset:2048
    ds_read_b128 v[12:15], v229 offset:3072
    ds_read_b128 v[16:19], v229 offset:4096
    ds_read_b128 v[20:23], v229 offset:5120
    ds_read_b128 v[24:27], v229 offset:6144
    ds_read_b128 v[28:31], v229 offset:7168
    ds_read_b128 v[32:35], v229 offset:8192
    ds_read_b128 v[36:39], v229 offset:9216
    ds_read_b128 v[40:43], v229 offset:10240
    ds_read_b128 v[44:47], v229 offset:11264
    ds_read_b128 v[48:51], v229 offset:12288
    ds_read_b128 v[52:55], v229 offset:13312
    ds_read_b128 v[56:59], v229 offset:14336
    ds_read_b128 v[60:63], v229 offset:15360
    s_waitcnt lgkmcnt(0)
    s_branch C_at_loop
C_at_ret:
    s_sub_u32 s44, s44, 1
    s_cbranch_scc1 M_done
    s_waitcnt vmcnt(0)
    buffer_load_dwordx4 v[112:115], v228, s[16:19], s26 offen offset:0 sc1
    buffer_load_dwordx4 v[116:119], v228, s[16:19], s26 offen offset:1024 sc1
    buffer_load_dwordx4 v[120:123], v228, s[16:19], s26 offen offset:2048 sc1
    buffer_load_dwordx4 v[124:127], v228, s[16:19], s26 offen offset:3072 sc1
    s_mov_b32 exec_lo, 0
    buffer_load_dwordx4 v[128:131], v230, s[20:23], s27 offen offset:0 sc1
    buffer_load_dwordx4 v[132:135], v230, s[20:23], s27 offen offset:512 sc1
    buffer_load_dwordx4 v[136:139], v230, s[20:23], s27 offen offset:1024 sc1
    buffer_load_dwordx4 v[140:143], v230, s[20:23], s27 offen offset:1536 sc1
    s_mov_b32 exec_lo, -1
    s_branch C_at_chk
C_at_vret:
    s_sub_u32 s44, s44, 1
    s_cbranch_scc1 M_done
    s_mov_b32 exec_lo, 0
    buffer_load_dwordx4 v[128:131], v230, s[20:23], s27 offen offset:0 sc1
    buffer_load_dwordx4 v[132:135], v230, s[20:23], s27 offen offset:512 sc1
    buffer_load_dwordx4 v[136:139], v230, s[20:23], s27 offen offset:1024 sc1
    buffer_load_dwordx4 v[140:143], v230, s[20:23], s27 offen offset:1536 sc1
    s_mov_b32 exec_lo, -1
    s_waitcnt vmcnt(0)
    v_max3_u32 v235, v128, v129, v130
    v_max3_u32 v235, v235, v131, v132
    v_max3_u32 v235, v235, v133, v134
    v_max3_u32 v235, v235, v135, v136
    v_max3_u32 v235, v235, v137, v138
    v_max3_u32 v235, v235, v139, v140
    v_max3_u32 v235, v235, v141, v142
    v_max_u32 v235, v235, v143
    v_cmp_eq_u32 vcc, -1, v235
    s_cbranch_vccz C_at_vok
    s_branch C_at_vret
M_done0:
M_done:
    s_endpgm
M_worker:
    s_barrier
    s_mov_b32 s70, s40
    s_sub_u32 s71, s41, 16
    s_load_dwordx4 s[40:43], s[0:1], 16
    s_load_dwordx2 s[80:81], s[0:1], 32
    s_load_dwordx4 s[48:51], s[0:1], 64
    s_load_dwordx2 s[6:7], s[0:1], 112
    s_load_dwordx2 s[60:61], s[0:1], 40
    s_load_dwordx4 s[64:67], s[0:1], 80
    s_load_dwordx2 s[68:69], s[0:1], 0
    s_load_dwordx2 s[82:83], s[0:1], 96
    s_lshl_b32 s34, s33, 11
    s_add_u32 s35, s34, 16384
    v_mov_b32 v1, v0
    v_lshlrev_b32 v197, 4, v1
    v_lshrrev_b32 v2, 5, v1
    s_lshl_b32 s47, s33, 2
    v_add_u32 v198, s47, v2
    v_and_b32 v4, 7, v198
    v_lshlrev_b32 v4, 1, v4
    v_and_b32 v5, 31, v1
    v_xor_b32 v4, v4, v5
    v_lshlrev_b32 v252, 4, v4
    v_add_u32 v199, s47, v2
    v_add_u32 v199, 2, v199
    v_and_b32 v4, 7, v199
    v_lshlrev_b32 v4, 1, v4
    v_and_b32 v5, 31, v1
    v_xor_b32 v4, v4, v5
    v_lshlrev_b32 v253, 4, v4
    s_mul_i32 s47, s33, 40960
    v_add_u32 v196, s47, v197
    s_lshr_b32 s52, s33, 1
    s_and_b32 s53, s33, 1
    s_lshl_b32 s47, s52, 12
    s_add_u32 s47, s47, 16384
    v_add_u32 v192, s47, v197
    v_add_u32 v193, 0x10000, v192
    v_lshrrev_b32 v2, 4, v1
    v_bfe_u32 v3, v1, 2, 2
    v_lshl_add_u32 v4, v2, 2, v3
    v_and_b32 v5, 7, v4
    v_lshlrev_b32 v4, 9, v4
    v_and_b32 v6, 3, v1
    v_lshl_add_u32 v4, v6, 3, v4
    s_lshl_b32 s47, s53, 8
    v_add_u32 v4, s47, v4
    v_xor_b32 v6, 0, v5
    v_lshl_add_u32 v176, v6, 5, v4
    v_add_u32 v184, 0x10000, v176
    v_xor_b32 v6, 1, v5
    v_lshl_add_u32 v177, v6, 5, v4
    v_add_u32 v185, 0x10000, v177
    v_xor_b32 v6, 2, v5
    v_lshl_add_u32 v178, v6, 5, v4
    v_add_u32 v186, 0x10000, v178
    v_xor_b32 v6, 3, v5
    v_lshl_add_u32 v179, v6, 5, v4
    v_add_u32 v187, 0x10000, v179
    v_xor_b32 v6, 4, v5
    v_lshl_add_u32 v180, v6, 5, v4
    v_add_u32 v188, 0x10000, v180
    v_xor_b32 v6, 5, v5
    v_lshl_add_u32 v181, v6, 5, v4
    v_add_u32 v189, 0x10000, v181
    v_xor_b32 v6, 6, v5
    v_lshl_add_u32 v182, v6, 5, v4
    v_add_u32 v190, 0x10000, v182
    v_xor_b32 v6, 7, v5
    v_lshl_add_u32 v183, v6, 5, v4
    v_add_u32 v191, 0x10000, v183
    s_waitcnt lgkmcnt(0)
    s_mov_b32 s16, s6
    s_mov_b32 s17, s7
    s_mov_b32 s18, 0x280000
    s_mov_b32 s19, 0x20000
    s_add_u32 s76, s6, 0x7200000
    s_addc_u32 s77, s7, 0
    s_mov_b32 s78, 0xa000
    s_mov_b32 s79, 0x20000
    s_lshr_b32 s38, s71, 3
    s_cmp_eq_u32 s38, 0
    s_cselect_b32 s12, s42, s80
    s_cselect_b32 s13, s43, s81
    s_mov_b32 s14, 5242880
    s_mov_b32 s15, 0x20000
    s_bfe_u32 s39, s71, 0x20001
    s_lshl_b32 s3, s70, 2
    s_add_u32 s39, s39, s3
    s_and_b32 s54, s71, 1
    s_lshl_b32 s46, s39, 8
    s_lshl_b32 s3, s54, 7
    s_add_u32 s46, s46, s3
    v_lshrrev_b32 v2, 3, v1
    v_bfe_u32 v3, v1, 4, 2
    v_lshlrev_b32 v3, 1, v3
    v_and_b32 v4, 7, v1
    v_xor_b32 v3, v3, v4
    v_lshlrev_b32 v3, 4, v3
    v_lshl_add_u32 v3, v2, 13, v3
    v_add_u32 v3, s46, v3
    s_mul_i32 s47, s33, 10240
    s_mul_i32 s3, s33, 80*8192
    s_add_u32 m0, s47, 0
    s_nop 0
    buffer_load_dwordx4 v3, s[12:15], s3 offen lds
    s_add_u32 s3, s3, 65536
    s_add_u32 m0, s47, 1024
    s_nop 0
    buffer_load_dwordx4 v3, s[12:15], s3 offen lds
    s_add_u32 s3, s3, 65536
    s_add_u32 m0, s47, 2048
    s_nop 0
    buffer_load_dwordx4 v3, s[12:15], s3 offen lds
    s_add_u32 s3, s3, 65536
    s_add_u32 m0, s47, 3072
    s_nop 0
    buffer_load_dwordx4 v3, s[12:15], s3 offen lds
    s_add_u32 s3, s3, 65536
    s_add_u32 m0, s47, 4096
    s_nop 0
    buffer_load_dwordx4 v3, s[12:15], s3 offen lds
    s_add_u32 s3, s3, 65536
    s_add_u32 m0, s47, 5120
    s_nop 0
    buffer_load_dwordx4 v3, s[12:15], s3 offen lds
    s_add_u32 s3, s3, 65536
    s_add_u32 m0, s47, 6144
    s_nop 0
    buffer_load_dwordx4 v3, s[12:15], s3 offen lds
    s_add_u32 s3, s3, 65536
    s_add_u32 m0, s47, 7168
    s_nop 0
    buffer_load_dwordx4 v3, s[12:15], s3 offen lds
    s_add_u32 s3, s3, 65536
    s_add_u32 m0, s47, 8192
    s_nop 0
    buffer_load_dwordx4 v3, s[12:15], s3 offen lds
    s_add_u32 s3, s3, 65536
    s_add_u32 m0, s47, 9216
    s_nop 0
    buffer_load_dwordx4 v3, s[12:15], s3 offen lds
    s_add_u32 s3, s3, 65536
    s_mul_i32 s3, s52, 40960
    v_add_u32 v4, 20480, v197
    buffer_load_dwordx4 v[16:19], v197, s[16:19], s3 offen offset:0
    buffer_load_dwordx4 v[20:23], v4, s[16:19], s3 offen offset:0
    buffer_load_dwordx4 v[24:27], v197, s[16:19], s3 offen offset:1024
    buffer_load_dwordx4 v[28:31], v4, s[16:19], s3 offen offset:1024
    buffer_load_dwordx4 v[32:35], v197, s[16:19], s3 offen offset:2048
    buffer_load_dwordx4 v[36:39], v4, s[16:19], s3 offen offset:2048
    buffer_load_dwordx4 v[40:43], v197, s[16:19], s3 offen offset:3072
    buffer_load_dwordx4 v[44:47], v4, s[16:19], s3 offen offset:3072
    s_add_u32 s3, s3, 4096
    buffer_load_dwordx4 v[48:51], v197, s[16:19], s3 offen offset:0
    buffer_load_dwordx4 v[52:55], v4, s[16:19], s3 offen offset:0
    buffer_load_dwordx4 v[56:59], v197, s[16:19], s3 offen offset:1024
    buffer_load_dwordx4 v[60:63], v4, s[16:19], s3 offen offset:1024
    buffer_load_dwordx4 v[64:67], v197, s[16:19], s3 offen offset:2048
    buffer_load_dwordx4 v[68:71], v4, s[16:19], s3 offen offset:2048
    buffer_load_dwordx4 v[72:75], v197, s[16:19], s3 offen offset:3072
    buffer_load_dwordx4 v[76:79], v4, s[16:19], s3 offen offset:3072
    s_add_u32 s3, s3, 4096
    buffer_load_dwordx4 v[80:83], v197, s[16:19], s3 offen offset:0
    buffer_load_dwordx4 v[84:87], v4, s[16:19], s3 offen offset:0
    buffer_load_dwordx4 v[88:91], v197, s[16:19], s3 offen offset:1024
    buffer_load_dwordx4 v[92:95], v4, s[16:19], s3 offen offset:1024
    buffer_load_dwordx4 v[96:99], v197, s[16:19], s3 offen offset:2048
    buffer_load_dwordx4 v[100:103], v4, s[16:19], s3 offen offset:2048
    buffer_load_dwordx4 v[104:107], v197, s[16:19], s3 offen offset:3072
    buffer_load_dwordx4 v[108:111], v4, s[16:19], s3 offen offset:3072
    s_add_u32 s3, s3, 4096
    buffer_load_dwordx4 v[112:115], v197, s[16:19], s3 offen offset:0
    buffer_load_dwordx4 v[116:119], v4, s[16:19], s3 offen offset:0
    buffer_load_dwordx4 v[120:123], v197, s[16:19], s3 offen offset:1024
    buffer_load_dwordx4 v[124:127], v4, s[16:19], s3 offen offset:1024
    buffer_load_dwordx4 v[128:131], v197, s[16:19], s3 offen offset:2048
    buffer_load_dwordx4 v[132:135], v4, s[16:19], s3 offen offset:2048
    buffer_load_dwordx4 v[136:139], v197, s[16:19], s3 offen offset:3072
    buffer_load_dwordx4 v[140:143], v4, s[16:19], s3 offen offset:3072
    s_add_u32 s3, s3, 4096
    buffer_load_dwordx4 v[144:147], v197, s[16:19], s3 offen offset:0
    buffer_load_dwordx4 v[148:151], v4, s[16:19], s3 offen offset:0
    buffer_load_dwordx4 v[152:155], v197, s[16:19], s3 offen offset:1024
    buffer_load_dwordx4 v[156:159], v4, s[16:19], s3 offen offset:1024
    buffer_load_dwordx4 v[160:163], v197, s[16:19], s3 offen offset:2048
    buffer_load_dwordx4 v[164:167], v4, s[16:19], s3 offen offset:2048
    buffer_load_dwordx4 v[168:171], v197, s[16:19], s3 offen offset:3072
    buffer_load_dwordx4 v[172:175], v4, s[16:19], s3 offen offset:3072
    s_add_u32 s3, s3, 4096
    v_lshrrev_b32 v5, 2, v1
    v_bfe_u32 v6, v1, 3, 2
    v_lshlrev_b32 v5, 7, v5
    v_and_b32 v7, 3, v1
    v_lshl_add_u32 v5, v7, 3, v5
    s_lshl_b32 s3, s53, 1
    v_xor_b32 v7, s3, v6
    v_lshl_add_u32 v8, v7, 5, v5
    s_add_u32 s3, s3, 1
    v_xor_b32 v7, s3, v6
    v_lshl_add_u32 v9, v7, 5, v5
    v_add_u32 v10, 0x10000, v8
    v_add_u32 v11, 0x10000, v9
    s_waitcnt vmcnt(40)
    s_barrier
    s_cmp_eq_u32 s38, 1
    s_cbranch_scc1 W_nV
    ds_read_b64_tr_b16 v[200:201], v8 offset:0
    ds_read_b64_tr_b16 v[202:203], v8 offset:2048
    ds_read_b64_tr_b16 v[204:205], v9 offset:0
    ds_read_b64_tr_b16 v[206:207], v9 offset:2048
    ds_read_b64_tr_b16 v[208:209], v8 offset:4096
    ds_read_b64_tr_b16 v[210:211], v8 offset:6144
    ds_read_b64_tr_b16 v[212:213], v9 offset:4096
    ds_read_b64_tr_b16 v[214:215], v9 offset:6144
    ds_read_b64_tr_b16 v[216:217], v8 offset:8192
    ds_read_b64_tr_b16 v[218:219], v8 offset:10240
    ds_read_b64_tr_b16 v[220:221], v9 offset:8192
    ds_read_b64_tr_b16 v[222:223], v9 offset:10240
    ds_read_b64_tr_b16 v[224:225], v8 offset:12288
    ds_read_b64_tr_b16 v[226:227], v8 offset:14336
    ds_read_b64_tr_b16 v[228:229], v9 offset:12288
    ds_read_b64_tr_b16 v[230:231], v9 offset:14336
    s_waitcnt vmcnt(38) lgkmcnt(12)
    v_mfma_f32_16x16x32_bf16 v[232:235], v[200:203], v[16:19], 0
    v_mfma_f32_16x16x32_bf16 v[236:239], v[200:203], v[20:23], 0
    v_mfma_f32_16x16x32_bf16 v[240:243], v[204:207], v[16:19], 0
    v_mfma_f32_16x16x32_bf16 v[244:247], v[204:207], v[20:23], 0
    ds_read_b64_tr_b16 v[200:201], v8 offset:16384
    ds_read_b64_tr_b16 v[202:203], v8 offset:18432
    ds_read_b64_tr_b16 v[204:205], v9 offset:16384
    ds_read_b64_tr_b16 v[206:207], v9 offset:18432
    s_waitcnt vmcnt(36) lgkmcnt(12)
    v_mfma_f32_16x16x32_bf16 v[232:235], v[208:211], v[24:27], v[232:235]
    v_mfma_f32_16x16x32_bf16 v[236:239], v[208:211], v[28:31], v[236:239]
    v_mfma_f32_16x16x32_bf16 v[240:243], v[212:215], v[24:27], v[240:243]
    v_mfma_f32_16x16x32_bf16 v[244:247], v[212:215], v[28:31], v[244:247]
    ds_read_b64_tr_b16 v[208:209], v8 offset:20480
    ds_read_b64_tr_b16 v[210:211], v8 offset:22528
    ds_read_b64_tr_b16 v[212:213], v9 offset:20480
    ds_read_b64_tr_b16 v[214:215], v9 offset:22528
    s_waitcnt vmcnt(34) lgkmcnt(12)
    v_mfma_f32_16x16x32_bf16 v[232:235], v[216:219], v[32:35], v[232:235]
    v_mfma_f32_16x16x32_bf16 v[236:239], v[216:219], v[36:39], v[236:239]
    v_mfma_f32_16x16x32_bf16 v[240:243], v[220:223], v[32:35], v[240:243]
    v_mfma_f32_16x16x32_bf16 v[244:247], v[220:223], v[36:39], v[244:247]
    ds_read_b64_tr_b16 v[216:217], v8 offset:24576
    ds_read_b64_tr_b16 v[218:219], v8 offset:26624
    ds_read_b64_tr_b16 v[220:221], v9 offset:24576
    ds_read_b64_tr_b16 v[222:223], v9 offset:26624
    s_waitcnt vmcnt(32) lgkmcnt(12)
    v_mfma_f32_16x16x32_bf16 v[232:235], v[224:227], v[40:43], v[232:235]
    v_mfma_f32_16x16x32_bf16 v[236:239], v[224:227], v[44:47], v[236:239]
    v_mfma_f32_16x16x32_bf16 v[240:243], v[228:231], v[40:43], v[240:243]
    v_mfma_f32_16x16x32_bf16 v[244:247], v[228:231], v[44:47], v[244:247]
    ds_read_b64_tr_b16 v[224:225], v8 offset:28672
    ds_read_b64_tr_b16 v[226:227], v8 offset:30720
    ds_read_b64_tr_b16 v[228:229], v9 offset:28672
    ds_read_b64_tr_b16 v[230:231], v9 offset:30720
    s_waitcnt vmcnt(30) lgkmcnt(12)
    v_mfma_f32_16x16x32_bf16 v[232:235], v[200:203], v[48:51], v[232:235]
    v_mfma_f32_16x16x32_bf16 v[236:239], v[200:203], v[52:55], v[236:239]
    v_mfma_f32_16x16x32_bf16 v[240:243], v[204:207], v[48:51], v[240:243]
    v_mfma_f32_16x16x32_bf16 v[244:247], v[204:207], v[52:55], v[244:247]
    ds_read_b64_tr_b16 v[200:201], v8 offset:32768
    ds_read_b64_tr_b16 v[202:203], v8 offset:34816
    ds_read_b64_tr_b16 v[204:205], v9 offset:32768
    ds_read_b64_tr_b16 v[206:207], v9 offset:34816
    s_waitcnt vmcnt(28) lgkmcnt(12)
    v_mfma_f32_16x16x32_bf16 v[232:235], v[208:211], v[56:59], v[232:235]
    v_mfma_f32_16x16x32_bf16 v[236:239], v[208:211], v[60:63], v[236:239]
    v_mfma_f32_16x16x32_bf16 v[240:243], v[212:215], v[56:59], v[240:243]
    v_mfma_f32_16x16x32_bf16 v[244:247], v[212:215], v[60:63], v[244:247]
    ds_read_b64_tr_b16 v[208:209], v8 offset:36864
    ds_read_b64_tr_b16 v[210:211], v8 offset:38912
    ds_read_b64_tr_b16 v[212:213], v9 offset:36864
    ds_read_b64_tr_b16 v[214:215], v9 offset:38912
    s_waitcnt vmcnt(26) lgkmcnt(12)
    v_mfma_f32_16x16x32_bf16 v[232:235], v[216:219], v[64:67], v[232:235]
    v_mfma_f32_16x16x32_bf16 v[236:239], v[216:219], v[68:71], v[236:239]
    v_mfma_f32_16x16x32_bf16 v[240:243], v[220:223], v[64:67], v[240:243]
    v_mfma_f32_16x16x32_bf16 v[244:247], v[220:223], v[68:71], v[244:247]
    ds_read_b64_tr_b16 v[216:217], v8 offset:40960
    ds_read_b64_tr_b16 v[218:219], v8 offset:43008
    ds_read_b64_tr_b16 v[220:221], v9 offset:40960
    ds_read_b64_tr_b16 v[222:223], v9 offset:43008
    s_waitcnt vmcnt(24) lgkmcnt(12)
    v_mfma_f32_16x16x32_bf16 v[232:235], v[224:227], v[72:75], v[232:235]
    v_mfma_f32_16x16x32_bf16 v[236:239], v[224:227], v[76:79], v[236:239]
    v_mfma_f32_16x16x32_bf16 v[240:243], v[228:231], v[72:75], v[240:243]
    v_mfma_f32_16x16x32_bf16 v[244:247], v[228:231], v[76:79], v[244:247]
    ds_read_b64_tr_b16 v[224:225], v8 offset:45056
    ds_read_b64_tr_b16 v[226:227], v8 offset:47104
    ds_read_b64_tr_b16 v[228:229], v9 offset:45056
    ds_read_b64_tr_b16 v[230:231], v9 offset:47104
    s_waitcnt vmcnt(22) lgkmcnt(12)
    v_mfma_f32_16x16x32_bf16 v[232:235], v[200:203], v[80:83], v[232:235]
    v_mfma_f32_16x16x32_bf16 v[236:239], v[200:203], v[84:87], v[236:239]
    v_mfma_f32_16x16x32_bf16 v[240:243], v[204:207], v[80:83], v[240:243]
    v_mfma_f32_16x16x32_bf16 v[244:247], v[204:207], v[84:87], v[244:247]
    ds_read_b64_tr_b16 v[200:201], v8 offset:49152
    ds_read_b64_tr_b16 v[202:203], v8 offset:51200
    ds_read_b64_tr_b16 v[204:205], v9 offset:49152
    ds_read_b64_tr_b16 v[206:207], v9 offset:51200
    s_waitcnt vmcnt(20) lgkmcnt(12)
    v_mfma_f32_16x16x32_bf16 v[232:235], v[208:211], v[88:91], v[232:235]
    v_mfma_f32_16x16x32_bf16 v[236:239], v[208:211], v[92:95], v[236:239]
    v_mfma_f32_16x16x32_bf16 v[240:243], v[212:215], v[88:91], v[240:243]
    v_mfma_f32_16x16x32_bf16 v[244:247], v[212:215], v[92:95], v[244:247]
    ds_read_b64_tr_b16 v[208:209], v8 offset:53248
    ds_read_b64_tr_b16 v[210:211], v8 offset:55296
    ds_read_b64_tr_b16 v[212:213], v9 offset:53248
    ds_read_b64_tr_b16 v[214:215], v9 offset:55296
    s_waitcnt vmcnt(18) lgkmcnt(12)
    v_mfma_f32_16x16x32_bf16 v[232:235], v[216:219], v[96:99], v[232:235]
    v_mfma_f32_16x16x32_bf16 v[236:239], v[216:219], v[100:103], v[236:239]
    v_mfma_f32_16x16x32_bf16 v[240:243], v[220:223], v[96:99], v[240:243]
    v_mfma_f32_16x16x32_bf16 v[244:247], v[220:223], v[100:103], v[244:247]
    ds_read_b64_tr_b16 v[216:217], v8 offset:57344
    ds_read_b64_tr_b16 v[218:219], v8 offset:59392
    ds_read_b64_tr_b16 v[220:221], v9 offset:57344
    ds_read_b64_tr_b16 v[222:223], v9 offset:59392
    s_waitcnt vmcnt(16) lgkmcnt(12)
    v_mfma_f32_16x16x32_bf16 v[232:235], v[224:227], v[104:107], v[232:235]
    v_mfma_f32_16x16x32_bf16 v[236:239], v[224:227], v[108:111], v[236:239]
    v_mfma_f32_16x16x32_bf16 v[240:243], v[228:231], v[104:107], v[240:243]
    v_mfma_f32_16x16x32_bf16 v[244:247], v[228:231], v[108:111], v[244:247]
    ds_read_b64_tr_b16 v[224:225], v8 offset:61440
    ds_read_b64_tr_b16 v[226:227], v8 offset:63488
    ds_read_b64_tr_b16 v[228:229], v9 offset:61440
    ds_read_b64_tr_b16 v[230:231], v9 offset:63488
    s_waitcnt vmcnt(14) lgkmcnt(12)
    v_mfma_f32_16x16x32_bf16 v[232:235], v[200:203], v[112:115], v[232:235]
    v_mfma_f32_16x16x32_bf16 v[236:239], v[200:203], v[116:119], v[236:239]
    v_mfma_f32_16x16x32_bf16 v[240:243], v[204:207], v[112:115], v[240:243]
    v_mfma_f32_16x16x32_bf16 v[244:247], v[204:207], v[116:119], v[244:247]
    ds_read_b64_tr_b16 v[200:201], v10 offset:0
    ds_read_b64_tr_b16 v[202:203], v10 offset:2048
    ds_read_b64_tr_b16 v[204:205], v11 offset:0
    ds_read_b64_tr_b16 v[206:207], v11 offset:2048
    s_waitcnt vmcnt(12) lgkmcnt(12)
    v_mfma_f32_16x16x32_bf16 v[232:235], v[208:211], v[120:123], v[232:235]
    v_mfma_f32_16x16x32_bf16 v[236:239], v[208:211], v[124:127], v[236:239]
    v_mfma_f32_16x16x32_bf16 v[240:243], v[212:215], v[120:123], v[240:243]
    v_mfma_f32_16x16x32_bf16 v[244:247], v[212:215], v[124:127], v[244:247]
    ds_read_b64_tr_b16 v[208:209], v10 offset:4096
    ds_read_b64_tr_b16 v[210:211], v10 offset:6144
    ds_read_b64_tr_b16 v[212:213], v11 offset:4096
    ds_read_b64_tr_b16 v[214:215], v11 offset:6144
    s_waitcnt vmcnt(10) lgkmcnt(12)
    v_mfma_f32_16x16x32_bf16 v[232:235], v[216:219], v[128:131], v[232:235]
    v_mfma_f32_16x16x32_bf16 v[236:239], v[216:219], v[132:135], v[236:239]
    v_mfma_f32_16x16x32_bf16 v[240:243], v[220:223], v[128:131], v[240:243]
    v_mfma_f32_16x16x32_bf16 v[244:247], v[220:223], v[132:135], v[244:247]
    ds_read_b64_tr_b16 v[216:217], v10 offset:8192
    ds_read_b64_tr_b16 v[218:219], v10 offset:10240
    ds_read_b64_tr_b16 v[220:221], v11 offset:8192
    ds_read_b64_tr_b16 v[222:223], v11 offset:10240
    s_waitcnt vmcnt(8) lgkmcnt(12)
    v_mfma_f32_16x16x32_bf16 v[232:235], v[224:227], v[136:139], v[232:235]
    v_mfma_f32_16x16x32_bf16 v[236:239], v[224:227], v[140:143], v[236:239]
    v_mfma_f32_16x16x32_bf16 v[240:243], v[228:231], v[136:139], v[240:243]
    v_mfma_f32_16x16x32_bf16 v[244:247], v[228:231], v[140:143], v[244:247]
    ds_read_b64_tr_b16 v[224:225], v10 offset:12288
    ds_read_b64_tr_b16 v[226:227], v10 offset:14336
    ds_read_b64_tr_b16 v[228:229], v11 offset:12288
    ds_read_b64_tr_b16 v[230:231], v11 offset:14336
    s_waitcnt vmcnt(6) lgkmcnt(12)
    v_mfma_f32_16x16x32_bf16 v[232:235], v[200:203], v[144:147], v[232:235]
    v_mfma_f32_16x16x32_bf16 v[236:239], v[200:203], v[148:151], v[236:239]
    v_mfma_f32_16x16x32_bf16 v[240:243], v[204:207], v[144:147], v[240:243]
    v_mfma_f32_16x16x32_bf16 v[244:247], v[204:207], v[148:151], v[244:247]
    s_waitcnt vmcnt(4) lgkmcnt(8)
    v_mfma_f32_16x16x32_bf16 v[232:235], v[208:211], v[152:155], v[232:235]
    v_mfma_f32_16x16x32_bf16 v[236:239], v[208:211], v[156:159], v[236:239]
    v_mfma_f32_16x16x32_bf16 v[240:243], v[212:215], v[152:155], v[240:243]
    v_mfma_f32_16x16x32_bf16 v[244:247], v[212:215], v[156:159], v[244:247]
    s_waitcnt vmcnt(2) lgkmcnt(4)
    v_mfma_f32_16x16x32_bf16 v[232:235], v[216:219], v[160:163], v[232:235]
    v_mfma_f32_16x16x32_bf16 v[236:239], v[216:219], v[164:167], v[236:239]
    v_mfma_f32_16x16x32_bf16 v[240:243], v[220:223], v[160:163], v[240:243]
    v_mfma_f32_16x16x32_bf16 v[244:247], v[220:223], v[164:167], v[244:247]
    s_waitcnt vmcnt(0) lgkmcnt(0)
    v_mfma_f32_16x16x32_bf16 v[232:235], v[224:227], v[168:171], v[232:235]
    v_mfma_f32_16x16x32_bf16 v[236:239], v[224:227], v[172:175], v[236:239]
    v_mfma_f32_16x16x32_bf16 v[240:243], v[228:231], v[168:171], v[240:243]
    v_mfma_f32_16x16x32_bf16 v[244:247], v[228:231], v[172:175], v[244:247]
    s_nop 7
    s_lshl_b32 s55, s54, 1
    s_add_u32 s55, s55, s53
    s_add_u32 s20, s6, 0x1400000
    s_addc_u32 s21, s7, 0
    s_mov_b32 s22, 0x1000000
    s_mov_b32 s23, 0x20000
    s_lshl_b32 s47, s52, 6
    s_add_u32 s47, s47, s39
    s_lshl_b32 s47, s47, 12
    s_lshl_b32 s3, s55, 10
    s_add_u32 s47, s47, s3
    v_cvt_pk_bf16_f32 v16, v232, v233
    v_cvt_pk_bf16_f32 v17, v234, v235
    v_cvt_pk_bf16_f32 v18, v240, v241
    v_cvt_pk_bf16_f32 v19, v242, v243
    buffer_store_dwordx4 v[16:19], v197, s[20:23], s47 offen sc1
    s_add_u32 s47, s47, 131072
    v_cvt_pk_bf16_f32 v20, v236, v237
    v_cvt_pk_bf16_f32 v21, v238, v239
    v_cvt_pk_bf16_f32 v22, v244, v245
    v_cvt_pk_bf16_f32 v23, v246, v247
    buffer_store_dwordx4 v[20:23], v197, s[20:23], s47 offen sc1
    s_branch W_nE
W_nV:
    ds_read_b64_tr_b16 v[200:201], v8 offset:0
    ds_read_b64_tr_b16 v[202:203], v8 offset:2048
    ds_read_b64_tr_b16 v[204:205], v9 offset:0
    ds_read_b64_tr_b16 v[206:207], v9 offset:2048
    ds_read_b64_tr_b16 v[208:209], v8 offset:4096
    ds_read_b64_tr_b16 v[210:211], v8 offset:6144
    ds_read_b64_tr_b16 v[212:213], v9 offset:4096
    ds_read_b64_tr_b16 v[214:215], v9 offset:6144
    ds_read_b64_tr_b16 v[216:217], v8 offset:8192
    ds_read_b64_tr_b16 v[218:219], v8 offset:10240
    ds_read_b64_tr_b16 v[220:221], v9 offset:8192
    ds_read_b64_tr_b16 v[222:223], v9 offset:10240
    ds_read_b64_tr_b16 v[224:225], v8 offset:12288
    ds_read_b64_tr_b16 v[226:227], v8 offset:14336
    ds_read_b64_tr_b16 v[228:229], v9 offset:12288
    ds_read_b64_tr_b16 v[230:231], v9 offset:14336
    s_waitcnt vmcnt(38) lgkmcnt(12)
    v_mfma_f32_16x16x32_bf16 v[232:235], v[16:19], v[200:203], 0
    v_mfma_f32_16x16x32_bf16 v[236:239], v[20:23], v[200:203], 0
    v_mfma_f32_16x16x32_bf16 v[240:243], v[16:19], v[204:207], 0
    v_mfma_f32_16x16x32_bf16 v[244:247], v[20:23], v[204:207], 0
    ds_read_b64_tr_b16 v[200:201], v8 offset:16384
    ds_read_b64_tr_b16 v[202:203], v8 offset:18432
    ds_read_b64_tr_b16 v[204:205], v9 offset:16384
    ds_read_b64_tr_b16 v[206:207], v9 offset:18432
    s_waitcnt vmcnt(36) lgkmcnt(12)
    v_mfma_f32_16x16x32_bf16 v[232:235], v[24:27], v[208:211], v[232:235]
    v_mfma_f32_16x16x32_bf16 v[236:239], v[28:31], v[208:211], v[236:239]
    v_mfma_f32_16x16x32_bf16 v[240:243], v[24:27], v[212:215], v[240:243]
    v_mfma_f32_16x16x32_bf16 v[244:247], v[28:31], v[212:215], v[244:247]
    ds_read_b64_tr_b16 v[208:209], v8 offset:20480
    ds_read_b64_tr_b16 v[210:211], v8 offset:22528
    ds_read_b64_tr_b16 v[212:213], v9 offset:20480
    ds_read_b64_tr_b16 v[214:215], v9 offset:22528
    s_waitcnt vmcnt(34) lgkmcnt(12)
    v_mfma_f32_16x16x32_bf16 v[232:235], v[32:35], v[216:219], v[232:235]
    v_mfma_f32_16x16x32_bf16 v[236:239], v[36:39], v[216:219], v[236:239]
    v_mfma_f32_16x16x32_bf16 v[240:243], v[32:35], v[220:223], v[240:243]
    v_mfma_f32_16x16x32_bf16 v[244:247], v[36:39], v[220:223], v[244:247]
    ds_read_b64_tr_b16 v[216:217], v8 offset:24576
    ds_read_b64_tr_b16 v[218:219], v8 offset:26624
    ds_read_b64_tr_b16 v[220:221], v9 offset:24576
    ds_read_b64_tr_b16 v[222:223], v9 offset:26624
    s_waitcnt vmcnt(32) lgkmcnt(12)
    v_mfma_f32_16x16x32_bf16 v[232:235], v[40:43], v[224:227], v[232:235]
    v_mfma_f32_16x16x32_bf16 v[236:239], v[44:47], v[224:227], v[236:239]
    v_mfma_f32_16x16x32_bf16 v[240:243], v[40:43], v[228:231], v[240:243]
    v_mfma_f32_16x16x32_bf16 v[244:247], v[44:47], v[228:231], v[244:247]
    ds_read_b64_tr_b16 v[224:225], v8 offset:28672
    ds_read_b64_tr_b16 v[226:227], v8 offset:30720
    ds_read_b64_tr_b16 v[228:229], v9 offset:28672
    ds_read_b64_tr_b16 v[230:231], v9 offset:30720
    s_waitcnt vmcnt(30) lgkmcnt(12)
    v_mfma_f32_16x16x32_bf16 v[232:235], v[48:51], v[200:203], v[232:235]
    v_mfma_f32_16x16x32_bf16 v[236:239], v[52:55], v[200:203], v[236:239]
    v_mfma_f32_16x16x32_bf16 v[240:243], v[48:51], v[204:207], v[240:243]
    v_mfma_f32_16x16x32_bf16 v[244:247], v[52:55], v[204:207], v[244:247]
    ds_read_b64_tr_b16 v[200:201], v8 offset:32768
    ds_read_b64_tr_b16 v[202:203], v8 offset:34816
    ds_read_b64_tr_b16 v[204:205], v9 offset:32768
    ds_read_b64_tr_b16 v[206:207], v9 offset:34816
    s_waitcnt vmcnt(28) lgkmcnt(12)
    v_mfma_f32_16x16x32_bf16 v[232:235], v[56:59], v[208:211], v[232:235]
    v_mfma_f32_16x16x32_bf16 v[236:239], v[60:63], v[208:211], v[236:239]
    v_mfma_f32_16x16x32_bf16 v[240:243], v[56:59], v[212:215], v[240:243]
    v_mfma_f32_16x16x32_bf16 v[244:247], v[60:63], v[212:215], v[244:247]
    ds_read_b64_tr_b16 v[208:209], v8 offset:36864
    ds_read_b64_tr_b16 v[210:211], v8 offset:38912
    ds_read_b64_tr_b16 v[212:213], v9 offset:36864
    ds_read_b64_tr_b16 v[214:215], v9 offset:38912
    s_waitcnt vmcnt(26) lgkmcnt(12)
    v_mfma_f32_16x16x32_bf16 v[232:235], v[64:67], v[216:219], v[232:235]
    v_mfma_f32_16x16x32_bf16 v[236:239], v[68:71], v[216:219], v[236:239]
    v_mfma_f32_16x16x32_bf16 v[240:243], v[64:67], v[220:223], v[240:243]
    v_mfma_f32_16x16x32_bf16 v[244:247], v[68:71], v[220:223], v[244:247]
    ds_read_b64_tr_b16 v[216:217], v8 offset:40960
    ds_read_b64_tr_b16 v[218:219], v8 offset:43008
    ds_read_b64_tr_b16 v[220:221], v9 offset:40960
    ds_read_b64_tr_b16 v[222:223], v9 offset:43008
    s_waitcnt vmcnt(24) lgkmcnt(12)
    v_mfma_f32_16x16x32_bf16 v[232:235], v[72:75], v[224:227], v[232:235]
    v_mfma_f32_16x16x32_bf16 v[236:239], v[76:79], v[224:227], v[236:239]
    v_mfma_f32_16x16x32_bf16 v[240:243], v[72:75], v[228:231], v[240:243]
    v_mfma_f32_16x16x32_bf16 v[244:247], v[76:79], v[228:231], v[244:247]
    ds_read_b64_tr_b16 v[224:225], v8 offset:45056
    ds_read_b64_tr_b16 v[226:227], v8 offset:47104
    ds_read_b64_tr_b16 v[228:229], v9 offset:45056
    ds_read_b64_tr_b16 v[230:231], v9 offset:47104
    s_waitcnt vmcnt(22) lgkmcnt(12)
    v_mfma_f32_16x16x32_bf16 v[232:235], v[80:83], v[200:203], v[232:235]
    v_mfma_f32_16x16x32_bf16 v[236:239], v[84:87], v[200:203], v[236:239]
    v_mfma_f32_16x16x32_bf16 v[240:243], v[80:83], v[204:207], v[240:243]
    v_mfma_f32_16x16x32_bf16 v[244:247], v[84:87], v[204:207], v[244:247]
    ds_read_b64_tr_b16 v[200:201], v8 offset:49152
    ds_read_b64_tr_b16 v[202:203], v8 offset:51200
    ds_read_b64_tr_b16 v[204:205], v9 offset:49152
    ds_read_b64_tr_b16 v[206:207], v9 offset:51200
    s_waitcnt vmcnt(20) lgkmcnt(12)
    v_mfma_f32_16x16x32_bf16 v[232:235], v[88:91], v[208:211], v[232:235]
    v_mfma_f32_16x16x32_bf16 v[236:239], v[92:95], v[208:211], v[236:239]
    v_mfma_f32_16x16x32_bf16 v[240:243], v[88:91], v[212:215], v[240:243]
    v_mfma_f32_16x16x32_bf16 v[244:247], v[92:95], v[212:215], v[244:247]
    ds_read_b64_tr_b16 v[208:209], v8 offset:53248
    ds_read_b64_tr_b16 v[210:211], v8 offset:55296
    ds_read_b64_tr_b16 v[212:213], v9 offset:53248
    ds_read_b64_tr_b16 v[214:215], v9 offset:55296
    s_waitcnt vmcnt(18) lgkmcnt(12)
    v_mfma_f32_16x16x32_bf16 v[232:235], v[96:99], v[216:219], v[232:235]
    v_mfma_f32_16x16x32_bf16 v[236:239], v[100:103], v[216:219], v[236:239]
    v_mfma_f32_16x16x32_bf16 v[240:243], v[96:99], v[220:223], v[240:243]
    v_mfma_f32_16x16x32_bf16 v[244:247], v[100:103], v[220:223], v[244:247]
    ds_read_b64_tr_b16 v[216:217], v8 offset:57344
    ds_read_b64_tr_b16 v[218:219], v8 offset:59392
    ds_read_b64_tr_b16 v[220:221], v9 offset:57344
    ds_read_b64_tr_b16 v[222:223], v9 offset:59392
    s_waitcnt vmcnt(16) lgkmcnt(12)
    v_mfma_f32_16x16x32_bf16 v[232:235], v[104:107], v[224:227], v[232:235]
    v_mfma_f32_16x16x32_bf16 v[236:239], v[108:111], v[224:227], v[236:239]
    v_mfma_f32_16x16x32_bf16 v[240:243], v[104:107], v[228:231], v[240:243]
    v_mfma_f32_16x16x32_bf16 v[244:247], v[108:111], v[228:231], v[244:247]
    ds_read_b64_tr_b16 v[224:225], v8 offset:61440
    ds_read_b64_tr_b16 v[226:227], v8 offset:63488
    ds_read_b64_tr_b16 v[228:229], v9 offset:61440
    ds_read_b64_tr_b16 v[230:231], v9 offset:63488
    s_waitcnt vmcnt(14) lgkmcnt(12)
    v_mfma_f32_16x16x32_bf16 v[232:235], v[112:115], v[200:203], v[232:235]
    v_mfma_f32_16x16x32_bf16 v[236:239], v[116:119], v[200:203], v[236:239]
    v_mfma_f32_16x16x32_bf16 v[240:243], v[112:115], v[204:207], v[240:243]
    v_mfma_f32_16x16x32_bf16 v[244:247], v[116:119], v[204:207], v[244:247]
    ds_read_b64_tr_b16 v[200:201], v10 offset:0
    ds_read_b64_tr_b16 v[202:203], v10 offset:2048
    ds_read_b64_tr_b16 v[204:205], v11 offset:0
    ds_read_b64_tr_b16 v[206:207], v11 offset:2048
    s_waitcnt vmcnt(12) lgkmcnt(12)
    v_mfma_f32_16x16x32_bf16 v[232:235], v[120:123], v[208:211], v[232:235]
    v_mfma_f32_16x16x32_bf16 v[236:239], v[124:127], v[208:211], v[236:239]
    v_mfma_f32_16x16x32_bf16 v[240:243], v[120:123], v[212:215], v[240:243]
    v_mfma_f32_16x16x32_bf16 v[244:247], v[124:127], v[212:215], v[244:247]
    ds_read_b64_tr_b16 v[208:209], v10 offset:4096
    ds_read_b64_tr_b16 v[210:211], v10 offset:6144
    ds_read_b64_tr_b16 v[212:213], v11 offset:4096
    ds_read_b64_tr_b16 v[214:215], v11 offset:6144
    s_waitcnt vmcnt(10) lgkmcnt(12)
    v_mfma_f32_16x16x32_bf16 v[232:235], v[128:131], v[216:219], v[232:235]
    v_mfma_f32_16x16x32_bf16 v[236:239], v[132:135], v[216:219], v[236:239]
    v_mfma_f32_16x16x32_bf16 v[240:243], v[128:131], v[220:223], v[240:243]
    v_mfma_f32_16x16x32_bf16 v[244:247], v[132:135], v[220:223], v[244:247]
    ds_read_b64_tr_b16 v[216:217], v10 offset:8192
    ds_read_b64_tr_b16 v[218:219], v10 offset:10240
    ds_read_b64_tr_b16 v[220:221], v11 offset:8192
    ds_read_b64_tr_b16 v[222:223], v11 offset:10240
    s_waitcnt vmcnt(8) lgkmcnt(12)
    v_mfma_f32_16x16x32_bf16 v[232:235], v[136:139], v[224:227], v[232:235]
    v_mfma_f32_16x16x32_bf16 v[236:239], v[140:143], v[224:227], v[236:239]
    v_mfma_f32_16x16x32_bf16 v[240:243], v[136:139], v[228:231], v[240:243]
    v_mfma_f32_16x16x32_bf16 v[244:247], v[140:143], v[228:231], v[244:247]
    ds_read_b64_tr_b16 v[224:225], v10 offset:12288
    ds_read_b64_tr_b16 v[226:227], v10 offset:14336
    ds_read_b64_tr_b16 v[228:229], v11 offset:12288
    ds_read_b64_tr_b16 v[230:231], v11 offset:14336
    s_waitcnt vmcnt(6) lgkmcnt(12)
    v_mfma_f32_16x16x32_bf16 v[232:235], v[144:147], v[200:203], v[232:235]
    v_mfma_f32_16x16x32_bf16 v[236:239], v[148:151], v[200:203], v[236:239]
    v_mfma_f32_16x16x32_bf16 v[240:243], v[144:147], v[204:207], v[240:243]
    v_mfma_f32_16x16x32_bf16 v[244:247], v[148:151], v[204:207], v[244:247]
    s_waitcnt vmcnt(4) lgkmcnt(8)
    v_mfma_f32_16x16x32_bf16 v[232:235], v[152:155], v[208:211], v[232:235]
    v_mfma_f32_16x16x32_bf16 v[236:239], v[156:159], v[208:211], v[236:239]
    v_mfma_f32_16x16x32_bf16 v[240:243], v[152:155], v[212:215], v[240:243]
    v_mfma_f32_16x16x32_bf16 v[244:247], v[156:159], v[212:215], v[244:247]
    s_waitcnt vmcnt(2) lgkmcnt(4)
    v_mfma_f32_16x16x32_bf16 v[232:235], v[160:163], v[216:219], v[232:235]
    v_mfma_f32_16x16x32_bf16 v[236:239], v[164:167], v[216:219], v[236:239]
    v_mfma_f32_16x16x32_bf16 v[240:243], v[160:163], v[220:223], v[240:243]
    v_mfma_f32_16x16x32_bf16 v[244:247], v[164:167], v[220:223], v[244:247]
    s_waitcnt vmcnt(0) lgkmcnt(0)
    v_mfma_f32_16x16x32_bf16 v[232:235], v[168:171], v[224:227], v[232:235]
    v_mfma_f32_16x16x32_bf16 v[236:239], v[172:175], v[224:227], v[236:239]
    v_mfma_f32_16x16x32_bf16 v[240:243], v[168:171], v[228:231], v[240:243]
    v_mfma_f32_16x16x32_bf16 v[244:247], v[172:175], v[228:231], v[244:247]
    s_nop 7
    s_lshl_b32 s55, s54, 1
    s_add_u32 s55, s55, s53
    s_add_u32 s20, s6, 0x2400000
    s_addc_u32 s21, s7, 0
    s_mov_b32 s22, 0x1000000
    s_mov_b32 s23, 0x20000
    s_lshl_b32 s47, s52, 5
    s_add_u32 s47, s47, s39
    s_lshl_b32 s47, s47, 13
    s_lshl_b32 s3, s55, 11
    s_add_u32 s47, s47, s3
    v_cvt_pk_bf16_f32 v16, v232, v233
    v_cvt_pk_bf16_f32 v17, v234, v235
    v_cvt_pk_bf16_f32 v18, v236, v237
    v_cvt_pk_bf16_f32 v19, v238, v239
    buffer_store_dwordx4 v[16:19], v197, s[20:23], s47 offen offset:0 sc1
    v_cvt_pk_bf16_f32 v20, v240, v241
    v_cvt_pk_bf16_f32 v21, v242, v243
    v_cvt_pk_bf16_f32 v22, v244, v245
    v_cvt_pk_bf16_f32 v23, v246, v247
    buffer_store_dwordx4 v[20:23], v197, s[20:23], s47 offen offset:1024 sc1
W_nE:
    s_lshl_b32 s73, s70, 4
    s_waitcnt vmcnt(0)
    s_barrier
    s_cmp_lg_u32 s33, 0
    s_cbranch_scc1 FA_15
    s_mov_b64 exec, 1
    s_lshl_b32 s3, s73, 7
    v_mov_b32 v254, 0
    v_mov_b32 v255, 1
    buffer_atomic_add v255, v254, s[76:79], s3 offen
    s_mov_b64 exec, -1
FA_15:
    s_mov_b32 s72, 0
W_task:
    s_cmp_ge_u32 s72, 4
    s_cbranch_scc1 W_t23
    s_lshl_b32 s3, s72, 4
    s_add_u32 s47, s3, s71
    s_add_u32 s47, s47, 4
    s_cmp_ge_u32 s47, 64
    s_cbranch_scc1 W_skip
    s_lshr_b32 s28, s47, 2
    s_bfe_u32 s3, s47, 0x10001
    s_lshl_b32 s29, s3, 4
    s_add_u32 s29, s29, 16
    s_lshl_b32 s3, s70, 1
    s_add_u32 s29, s29, s3
    s_and_b32 s3, s47, 1
    s_add_u32 s29, s29, s3
    s_mov_b32 s84, 4
    s_lshl_b32 s73, s70, 4
    s_add_u32 s73, s73, s28
    s_lshr_b32 s38, s29, 4
    s_cmp_eq_u32 s38, 0
    s_cselect_b32 s12, s40, s42
    s_cselect_b32 s13, s41, s43
    s_cmp_eq_u32 s38, 2
    s_cselect_b32 s12, s80, s12
    s_cselect_b32 s13, s81, s13
    s_cmp_eq_u32 s38, 3
    s_cselect_b32 s12, s48, s12
    s_cselect_b32 s13, s49, s13
    s_mov_b32 s30, 8192
    s_cmov_b32 s30, 3456
    s_mov_b32 s14, 5242880
    s_cmov_b32 s14, 2211840
    s_mov_b32 s15, 0x20000
    s_and_b32 s39, s29, 15
    s_lshl_b32 s46, s39, 9
    s_lshl_b32 s37, s30, 5
    s_mov_b32 s31, 0
    s_mul_i32 s32, s28, 16*20*1024
    s_add_u32 s36, s32, 20480
    v_mul_lo_u32 v194, v198, s30
    v_add_u32 v194, v194, v252
    v_add_u32 v194, s46, v194
    v_mul_lo_u32 v195, v199, s30
    v_add_u32 v195, v195, v253
    v_add_u32 v195, s46, v195
    s_lshr_b32 s32, s32, 1
    s_lshl_b32 s35, s33, 10
    s_add_u32 s35, s35, 16384
    s_mul_i32 s47, s33, 20480
    v_add_u32 v196, s47, v197
    s_lshl_b32 s47, s52, 11
    s_add_u32 s47, s47, 16384
    v_add_u32 v192, s47, v197
    v_add_u32 v193, 0x10000, v192
    s_add_u32 m0, s34, 0
    s_nop 0
    buffer_load_dwordx4 v194, s[12:15], s31 offen lds
    s_add_u32 m0, s34, 1024
    s_nop 0
    buffer_load_dwordx4 v195, s[12:15], s31 offen lds
    s_add_u32 s31, s31, s37
    s_add_u32 m0, s35, 0
    s_nop 0
    buffer_load_dwordx4 v196, s[16:19], s32 offen lds
    s_add_u32 s32, s32, 1024
    s_add_u32 m0, s34, 32768
    s_nop 0
    buffer_load_dwordx4 v194, s[12:15], s31 offen lds
    s_add_u32 m0, s34, 33792
    s_nop 0
    buffer_load_dwordx4 v195, s[12:15], s31 offen lds
    s_add_u32 s31, s31, s37
    s_add_u32 m0, s35, 32768
    s_nop 0
    buffer_load_dwordx4 v196, s[16:19], s32 offen lds
    s_add_u32 s32, s32, 1024
    s_add_u32 m0, s34, 65536
    s_nop 0
    buffer_load_dwordx4 v194, s[12:15], s31 offen lds
    s_add_u32 m0, s34, 66560
    s_nop 0
    buffer_load_dwordx4 v195, s[12:15], s31 offen lds
    s_add_u32 s31, s31, s37
    s_add_u32 m0, s35, 65536
    s_nop 0
    buffer_load_dwordx4 v196, s[16:19], s32 offen lds
    s_add_u32 s32, s32, 1024
    s_cmp_eq_u32 s38, 2
    s_cbranch_scc1 W_V
    s_waitcnt vmcnt(6)
    s_barrier
    ds_read_b128 v[160:163], v192 offset:0
    ds_read_b64_tr_b16 v[128:129], v176 offset:0
    ds_read_b64_tr_b16 v[130:131], v176 offset:8192
    ds_read_b128 v[164:167], v192 offset:1024
    ds_read_b64_tr_b16 v[132:133], v177 offset:0
    ds_read_b64_tr_b16 v[134:135], v177 offset:8192
    ds_read_b64_tr_b16 v[136:137], v178 offset:0
    ds_read_b64_tr_b16 v[138:139], v178 offset:8192
    ds_read_b64_tr_b16 v[140:141], v179 offset:0
    ds_read_b64_tr_b16 v[142:143], v179 offset:8192
    s_waitcnt lgkmcnt(7)
    v_mfma_f32_16x16x32_bf16 v[0:3], v[128:131], v[160:163], 0
    ds_read_b64_tr_b16 v[144:145], v180 offset:0
    ds_read_b64_tr_b16 v[146:147], v180 offset:8192
    s_waitcnt lgkmcnt(8)
    v_mfma_f32_16x16x32_bf16 v[4:7], v[128:131], v[164:167], 0
    s_waitcnt lgkmcnt(6)
    v_mfma_f32_16x16x32_bf16 v[16:19], v[132:135], v[160:163], 0
    ds_read_b64_tr_b16 v[148:149], v181 offset:0
    ds_read_b64_tr_b16 v[150:151], v181 offset:8192
    v_mfma_f32_16x16x32_bf16 v[20:23], v[132:135], v[164:167], 0
    s_waitcnt lgkmcnt(6)
    v_mfma_f32_16x16x32_bf16 v[32:35], v[136:139], v[160:163], 0
    ds_read_b64_tr_b16 v[152:153], v182 offset:0
    ds_read_b64_tr_b16 v[154:155], v182 offset:8192
    v_mfma_f32_16x16x32_bf16 v[36:39], v[136:139], v[164:167], 0
    s_waitcnt lgkmcnt(6)
    v_mfma_f32_16x16x32_bf16 v[48:51], v[140:143], v[160:163], 0
    ds_read_b64_tr_b16 v[156:157], v183 offset:0
    ds_read_b64_tr_b16 v[158:159], v183 offset:8192
    v_mfma_f32_16x16x32_bf16 v[52:55], v[140:143], v[164:167], 0
    s_waitcnt vmcnt(3)
    s_barrier
    s_waitcnt lgkmcnt(6)
    v_mfma_f32_16x16x32_bf16 v[64:67], v[144:147], v[160:163], 0
    ds_read_b128 v[200:203], v192 offset:32768
    v_mfma_f32_16x16x32_bf16 v[68:71], v[144:147], v[164:167], 0
    ds_read_b64_tr_b16 v[128:129], v176 offset:32768
    ds_read_b64_tr_b16 v[130:131], v176 offset:40960
    s_add_u32 m0, s34, 98304
    s_nop 0
    buffer_load_dwordx4 v194, s[12:15], s31 offen lds
    s_waitcnt lgkmcnt(7)
    v_mfma_f32_16x16x32_bf16 v[80:83], v[148:151], v[160:163], 0
    ds_read_b128 v[204:207], v192 offset:33792
    v_mfma_f32_16x16x32_bf16 v[84:87], v[148:151], v[164:167], 0
    ds_read_b64_tr_b16 v[132:133], v177 offset:32768
    ds_read_b64_tr_b16 v[134:135], v177 offset:40960
    s_add_u32 m0, s34, 99328
    s_nop 0
    buffer_load_dwordx4 v195, s[12:15], s31 offen lds
    s_add_u32 s31, s31, s37
    s_waitcnt lgkmcnt(8)
    v_mfma_f32_16x16x32_bf16 v[96:99], v[152:155], v[160:163], 0
    v_mfma_f32_16x16x32_bf16 v[100:103], v[152:155], v[164:167], 0
    ds_read_b64_tr_b16 v[136:137], v178 offset:32768
    ds_read_b64_tr_b16 v[138:139], v178 offset:40960
    s_add_u32 m0, s35, 98304
    s_nop 0
    buffer_load_dwordx4 v196, s[16:19], s32 offen lds
    s_add_u32 s32, s32, 1024
    s_waitcnt lgkmcnt(8)
    v_mfma_f32_16x16x32_bf16 v[112:115], v[156:159], v[160:163], 0
    v_mfma_f32_16x16x32_bf16 v[116:119], v[156:159], v[164:167], 0
    ds_read_b64_tr_b16 v[140:141], v179 offset:32768
    ds_read_b64_tr_b16 v[142:143], v179 offset:40960
    s_waitcnt lgkmcnt(7)
    v_mfma_f32_16x16x32_bf16 v[0:3], v[128:131], v[200:203], v[0:3]
    ds_read_b64_tr_b16 v[144:145], v180 offset:32768
    ds_read_b64_tr_b16 v[146:147], v180 offset:40960
    s_waitcnt lgkmcnt(8)
    v_mfma_f32_16x16x32_bf16 v[4:7], v[128:131], v[204:207], v[4:7]
    s_waitcnt lgkmcnt(6)
    v_mfma_f32_16x16x32_bf16 v[16:19], v[132:135], v[200:203], v[16:19]
    ds_read_b64_tr_b16 v[148:149], v181 offset:32768
    ds_read_b64_tr_b16 v[150:151], v181 offset:40960
    v_mfma_f32_16x16x32_bf16 v[20:23], v[132:135], v[204:207], v[20:23]
    s_waitcnt lgkmcnt(6)
    v_mfma_f32_16x16x32_bf16 v[32:35], v[136:139], v[200:203], v[32:35]
    ds_read_b64_tr_b16 v[152:153], v182 offset:32768
    ds_read_b64_tr_b16 v[154:155], v182 offset:40960
    v_mfma_f32_16x16x32_bf16 v[36:39], v[136:139], v[204:207], v[36:39]
    s_waitcnt lgkmcnt(6)
    v_mfma_f32_16x16x32_bf16 v[48:51], v[140:143], v[200:203], v[48:51]
    ds_read_b64_tr_b16 v[156:157], v183 offset:32768
    ds_read_b64_tr_b16 v[158:159], v183 offset:40960
    v_mfma_f32_16x16x32_bf16 v[52:55], v[140:143], v[204:207], v[52:55]
    s_waitcnt vmcnt(3)
    s_barrier
    s_waitcnt lgkmcnt(6)
    v_mfma_f32_16x16x32_bf16 v[64:67], v[144:147], v[200:203], v[64:67]
    ds_read_b128 v[160:163], v193 offset:0
    v_mfma_f32_16x16x32_bf16 v[68:71], v[144:147], v[204:207], v[68:71]
    ds_read_b64_tr_b16 v[128:129], v184 offset:0
    ds_read_b64_tr_b16 v[130:131], v184 offset:8192
    s_add_u32 m0, s34, 0
    s_nop 0
    buffer_load_dwordx4 v194, s[12:15], s31 offen lds
    s_waitcnt lgkmcnt(7)
    v_mfma_f32_16x16x32_bf16 v[80:83], v[148:151], v[200:203], v[80:83]
    ds_read_b128 v[164:167], v193 offset:1024
    v_mfma_f32_16x16x32_bf16 v[84:87], v[148:151], v[204:207], v[84:87]
    ds_read_b64_tr_b16 v[132:133], v185 offset:0
    ds_read_b64_tr_b16 v[134:135], v185 offset:8192
    s_add_u32 m0, s34, 1024
    s_nop 0
    buffer_load_dwordx4 v195, s[12:15], s31 offen lds
    s_add_u32 s31, s31, s37
    s_waitcnt lgkmcnt(8)
    v_mfma_f32_16x16x32_bf16 v[96:99], v[152:155], v[200:203], v[96:99]
    v_mfma_f32_16x16x32_bf16 v[100:103], v[152:155], v[204:207], v[100:103]
    ds_read_b64_tr_b16 v[136:137], v186 offset:0
    ds_read_b64_tr_b16 v[138:139], v186 offset:8192
    s_add_u32 m0, s35, 0
    s_nop 0
    buffer_load_dwordx4 v196, s[16:19], s32 offen lds
    s_add_u32 s32, s32, 1024
    s_waitcnt lgkmcnt(8)
    v_mfma_f32_16x16x32_bf16 v[112:115], v[156:159], v[200:203], v[112:115]
    v_mfma_f32_16x16x32_bf16 v[116:119], v[156:159], v[204:207], v[116:119]
    ds_read_b64_tr_b16 v[140:141], v187 offset:0
    ds_read_b64_tr_b16 v[142:143], v187 offset:8192
    s_waitcnt lgkmcnt(7)
    v_mfma_f32_16x16x32_bf16 v[0:3], v[128:131], v[160:163], v[0:3]
    ds_read_b64_tr_b16 v[144:145], v188 offset:0
    ds_read_b64_tr_b16 v[146:147], v188 offset:8192
    s_waitcnt lgkmcnt(8)
    v_mfma_f32_16x16x32_bf16 v[4:7], v[128:131], v[164:167], v[4:7]
    s_waitcnt lgkmcnt(6)
    v_mfma_f32_16x16x32_bf16 v[16:19], v[132:135], v[160:163], v[16:19]
    ds_read_b64_tr_b16 v[148:149], v189 offset:0
    ds_read_b64_tr_b16 v[150:151], v189 offset:8192
    v_mfma_f32_16x16x32_bf16 v[20:23], v[132:135], v[164:167], v[20:23]
    s_waitcnt lgkmcnt(6)
    v_mfma_f32_16x16x32_bf16 v[32:35], v[136:139], v[160:163], v[32:35]
    ds_read_b64_tr_b16 v[152:153], v190 offset:0
    ds_read_b64_tr_b16 v[154:155], v190 offset:8192
    v_mfma_f32_16x16x32_bf16 v[36:39], v[136:139], v[164:167], v[36:39]
    s_waitcnt lgkmcnt(6)
    v_mfma_f32_16x16x32_bf16 v[48:51], v[140:143], v[160:163], v[48:51]
    ds_read_b64_tr_b16 v[156:157], v191 offset:0
    ds_read_b64_tr_b16 v[158:159], v191 offset:8192
    v_mfma_f32_16x16x32_bf16 v[52:55], v[140:143], v[164:167], v[52:55]
    s_waitcnt vmcnt(3)
    s_barrier
    s_waitcnt lgkmcnt(6)
    v_mfma_f32_16x16x32_bf16 v[64:67], v[144:147], v[160:163], v[64:67]
    ds_read_b128 v[200:203], v193 offset:32768
    v_mfma_f32_16x16x32_bf16 v[68:71], v[144:147], v[164:167], v[68:71]
    ds_read_b64_tr_b16 v[128:129], v184 offset:32768
    ds_read_b64_tr_b16 v[130:131], v184 offset:40960
    s_add_u32 m0, s34, 32768
    s_nop 0
    buffer_load_dwordx4 v194, s[12:15], s31 offen lds
    s_waitcnt lgkmcnt(7)
    v_mfma_f32_16x16x32_bf16 v[80:83], v[148:151], v[160:163], v[80:83]
    ds_read_b128 v[204:207], v193 offset:33792
    v_mfma_f32_16x16x32_bf16 v[84:87], v[148:151], v[164:167], v[84:87]
    ds_read_b64_tr_b16 v[132:133], v185 offset:32768
    ds_read_b64_tr_b16 v[134:135], v185 offset:40960
    s_add_u32 m0, s34, 33792
    s_nop 0
    buffer_load_dwordx4 v195, s[12:15], s31 offen lds
    s_add_u32 s31, s31, s37
    s_waitcnt lgkmcnt(8)
    v_mfma_f32_16x16x32_bf16 v[96:99], v[152:155], v[160:163], v[96:99]
    v_mfma_f32_16x16x32_bf16 v[100:103], v[152:155], v[164:167], v[100:103]
    ds_read_b64_tr_b16 v[136:137], v186 offset:32768
    ds_read_b64_tr_b16 v[138:139], v186 offset:40960
    s_add_u32 m0, s35, 32768
    s_nop 0
    buffer_load_dwordx4 v196, s[16:19], s32 offen lds
    s_add_u32 s32, s32, 1024
    s_waitcnt lgkmcnt(8)
    v_mfma_f32_16x16x32_bf16 v[112:115], v[156:159], v[160:163], v[112:115]
    v_mfma_f32_16x16x32_bf16 v[116:119], v[156:159], v[164:167], v[116:119]
    ds_read_b64_tr_b16 v[140:141], v187 offset:32768
    ds_read_b64_tr_b16 v[142:143], v187 offset:40960
    s_waitcnt lgkmcnt(7)
    v_mfma_f32_16x16x32_bf16 v[0:3], v[128:131], v[200:203], v[0:3]
    ds_read_b64_tr_b16 v[144:145], v188 offset:32768
    ds_read_b64_tr_b16 v[146:147], v188 offset:40960
    s_waitcnt lgkmcnt(8)
    v_mfma_f32_16x16x32_bf16 v[4:7], v[128:131], v[204:207], v[4:7]
    s_waitcnt lgkmcnt(6)
    v_mfma_f32_16x16x32_bf16 v[16:19], v[132:135], v[200:203], v[16:19]
    ds_read_b64_tr_b16 v[148:149], v189 offset:32768
    ds_read_b64_tr_b16 v[150:151], v189 offset:40960
    v_mfma_f32_16x16x32_bf16 v[20:23], v[132:135], v[204:207], v[20:23]
    s_waitcnt lgkmcnt(6)
    v_mfma_f32_16x16x32_bf16 v[32:35], v[136:139], v[200:203], v[32:35]
    ds_read_b64_tr_b16 v[152:153], v190 offset:32768
    ds_read_b64_tr_b16 v[154:155], v190 offset:40960
    v_mfma_f32_16x16x32_bf16 v[36:39], v[136:139], v[204:207], v[36:39]
    s_waitcnt lgkmcnt(6)
    v_mfma_f32_16x16x32_bf16 v[48:51], v[140:143], v[200:203], v[48:51]
    ds_read_b64_tr_b16 v[156:157], v191 offset:32768
    ds_read_b64_tr_b16 v[158:159], v191 offset:40960
    v_mfma_f32_16x16x32_bf16 v[52:55], v[140:143], v[204:207], v[52:55]
    s_waitcnt vmcnt(3)
    s_barrier
    s_waitcnt lgkmcnt(6)
    v_mfma_f32_16x16x32_bf16 v[64:67], v[144:147], v[200:203], v[64:67]
    ds_read_b128 v[160:163], v192 offset:0
    v_mfma_f32_16x16x32_bf16 v[68:71], v[144:147], v[204:207], v[68:71]
    ds_read_b64_tr_b16 v[128:129], v176 offset:0
    ds_read_b64_tr_b16 v[130:131], v176 offset:8192
    s_add_u32 m0, s34, 65536
    s_nop 0
    buffer_load_dwordx4 v194, s[12:15], s31 offen lds
    s_waitcnt lgkmcnt(7)
    v_mfma_f32_16x16x32_bf16 v[80:83], v[148:151], v[200:203], v[80:83]
    ds_read_b128 v[164:167], v192 offset:1024
    v_mfma_f32_16x16x32_bf16 v[84:87], v[148:151], v[204:207], v[84:87]
    ds_read_b64_tr_b16 v[132:133], v177 offset:0
    ds_read_b64_tr_b16 v[134:135], v177 offset:8192
    s_add_u32 m0, s34, 66560
    s_nop 0
    buffer_load_dwordx4 v195, s[12:15], s31 offen lds
    s_add_u32 s31, s31, s37
    s_waitcnt lgkmcnt(8)
    v_mfma_f32_16x16x32_bf16 v[96:99], v[152:155], v[200:203], v[96:99]
    v_mfma_f32_16x16x32_bf16 v[100:103], v[152:155], v[204:207], v[100:103]
    ds_read_b64_tr_b16 v[136:137], v178 offset:0
    ds_read_b64_tr_b16 v[138:139], v178 offset:8192
    s_add_u32 m0, s35, 65536
    s_nop 0
    buffer_load_dwordx4 v196, s[16:19], s32 offen lds
    s_add_u32 s32, s32, 1024
    s_waitcnt lgkmcnt(8)
    v_mfma_f32_16x16x32_bf16 v[112:115], v[156:159], v[200:203], v[112:115]
    v_mfma_f32_16x16x32_bf16 v[116:119], v[156:159], v[204:207], v[116:119]
    ds_read_b64_tr_b16 v[140:141], v179 offset:0
    ds_read_b64_tr_b16 v[142:143], v179 offset:8192
    s_waitcnt lgkmcnt(7)
    v_mfma_f32_16x16x32_bf16 v[0:3], v[128:131], v[160:163], v[0:3]
    ds_read_b64_tr_b16 v[144:145], v180 offset:0
    ds_read_b64_tr_b16 v[146:147], v180 offset:8192
    s_waitcnt lgkmcnt(8)
    v_mfma_f32_16x16x32_bf16 v[4:7], v[128:131], v[164:167], v[4:7]
    s_waitcnt lgkmcnt(6)
    v_mfma_f32_16x16x32_bf16 v[16:19], v[132:135], v[160:163], v[16:19]
    ds_read_b64_tr_b16 v[148:149], v181 offset:0
    ds_read_b64_tr_b16 v[150:151], v181 offset:8192
    v_mfma_f32_16x16x32_bf16 v[20:23], v[132:135], v[164:167], v[20:23]
    s_waitcnt lgkmcnt(6)
    v_mfma_f32_16x16x32_bf16 v[32:35], v[136:139], v[160:163], v[32:35]
    ds_read_b64_tr_b16 v[152:153], v182 offset:0
    ds_read_b64_tr_b16 v[154:155], v182 offset:8192
    v_mfma_f32_16x16x32_bf16 v[36:39], v[136:139], v[164:167], v[36:39]
    s_waitcnt lgkmcnt(6)
    v_mfma_f32_16x16x32_bf16 v[48:51], v[140:143], v[160:163], v[48:51]
    ds_read_b64_tr_b16 v[156:157], v183 offset:0
    ds_read_b64_tr_b16 v[158:159], v183 offset:8192
    v_mfma_f32_16x16x32_bf16 v[52:55], v[140:143], v[164:167], v[52:55]
    s_waitcnt vmcnt(3)
    s_barrier
    s_waitcnt lgkmcnt(6)
    v_mfma_f32_16x16x32_bf16 v[64:67], v[144:147], v[160:163], v[64:67]
    ds_read_b128 v[200:203], v192 offset:32768
    v_mfma_f32_16x16x32_bf16 v[68:71], v[144:147], v[164:167], v[68:71]
    ds_read_b64_tr_b16 v[128:129], v176 offset:32768
    ds_read_b64_tr_b16 v[130:131], v176 offset:40960
    s_add_u32 m0, s34, 98304
    s_nop 0
    buffer_load_dwordx4 v194, s[12:15], s31 offen lds
    s_waitcnt lgkmcnt(7)
    v_mfma_f32_16x16x32_bf16 v[80:83], v[148:151], v[160:163], v[80:83]
    ds_read_b128 v[204:207], v192 offset:33792
    v_mfma_f32_16x16x32_bf16 v[84:87], v[148:151], v[164:167], v[84:87]
    ds_read_b64_tr_b16 v[132:133], v177 offset:32768
    ds_read_b64_tr_b16 v[134:135], v177 offset:40960
    s_add_u32 m0, s34, 99328
    s_nop 0
    buffer_load_dwordx4 v195, s[12:15], s31 offen lds
    s_add_u32 s31, s31, s37
    s_waitcnt lgkmcnt(8)
    v_mfma_f32_16x16x32_bf16 v[96:99], v[152:155], v[160:163], v[96:99]
    v_mfma_f32_16x16x32_bf16 v[100:103], v[152:155], v[164:167], v[100:103]
    ds_read_b64_tr_b16 v[136:137], v178 offset:32768
    ds_read_b64_tr_b16 v[138:139], v178 offset:40960
    s_add_u32 m0, s35, 98304
    s_nop 0
    buffer_load_dwordx4 v196, s[16:19], s32 offen lds
    s_add_u32 s32, s32, 1024
    s_waitcnt lgkmcnt(8)
    v_mfma_f32_16x16x32_bf16 v[112:115], v[156:159], v[160:163], v[112:115]
    v_mfma_f32_16x16x32_bf16 v[116:119], v[156:159], v[164:167], v[116:119]
    ds_read_b64_tr_b16 v[140:141], v179 offset:32768
    ds_read_b64_tr_b16 v[142:143], v179 offset:40960
    s_waitcnt lgkmcnt(7)
    v_mfma_f32_16x16x32_bf16 v[0:3], v[128:131], v[200:203], v[0:3]
    ds_read_b64_tr_b16 v[144:145], v180 offset:32768
    ds_read_b64_tr_b16 v[146:147], v180 offset:40960
    s_waitcnt lgkmcnt(8)
    v_mfma_f32_16x16x32_bf16 v[4:7], v[128:131], v[204:207], v[4:7]
    s_waitcnt lgkmcnt(6)
    v_mfma_f32_16x16x32_bf16 v[16:19], v[132:135], v[200:203], v[16:19]
    ds_read_b64_tr_b16 v[148:149], v181 offset:32768
    ds_read_b64_tr_b16 v[150:151], v181 offset:40960
    v_mfma_f32_16x16x32_bf16 v[20:23], v[132:135], v[204:207], v[20:23]
    s_waitcnt lgkmcnt(6)
    v_mfma_f32_16x16x32_bf16 v[32:35], v[136:139], v[200:203], v[32:35]
    ds_read_b64_tr_b16 v[152:153], v182 offset:32768
    ds_read_b64_tr_b16 v[154:155], v182 offset:40960
    v_mfma_f32_16x16x32_bf16 v[36:39], v[136:139], v[204:207], v[36:39]
    s_waitcnt lgkmcnt(6)
    v_mfma_f32_16x16x32_bf16 v[48:51], v[140:143], v[200:203], v[48:51]
    ds_read_b64_tr_b16 v[156:157], v183 offset:32768
    ds_read_b64_tr_b16 v[158:159], v183 offset:40960
    v_mfma_f32_16x16x32_bf16 v[52:55], v[140:143], v[204:207], v[52:55]
    s_waitcnt vmcnt(3)
    s_barrier
    s_waitcnt lgkmcnt(6)
    v_mfma_f32_16x16x32_bf16 v[64:67], v[144:147], v[200:203], v[64:67]
    ds_read_b128 v[160:163], v193 offset:0
    v_mfma_f32_16x16x32_bf16 v[68:71], v[144:147], v[204:207], v[68:71]
    ds_read_b64_tr_b16 v[128:129], v184 offset:0
    ds_read_b64_tr_b16 v[130:131], v184 offset:8192
    s_add_u32 m0, s34, 0
    s_nop 0
    buffer_load_dwordx4 v194, s[12:15], s31 offen lds
    s_waitcnt lgkmcnt(7)
    v_mfma_f32_16x16x32_bf16 v[80:83], v[148:151], v[200:203], v[80:83]
    ds_read_b128 v[164:167], v193 offset:1024
    v_mfma_f32_16x16x32_bf16 v[84:87], v[148:151], v[204:207], v[84:87]
    ds_read_b64_tr_b16 v[132:133], v185 offset:0
    ds_read_b64_tr_b16 v[134:135], v185 offset:8192
    s_add_u32 m0, s34, 1024
    s_nop 0
    buffer_load_dwordx4 v195, s[12:15], s31 offen lds
    s_add_u32 s31, s31, s37
    s_waitcnt lgkmcnt(8)
    v_mfma_f32_16x16x32_bf16 v[96:99], v[152:155], v[200:203], v[96:99]
    v_mfma_f32_16x16x32_bf16 v[100:103], v[152:155], v[204:207], v[100:103]
    ds_read_b64_tr_b16 v[136:137], v186 offset:0
    ds_read_b64_tr_b16 v[138:139], v186 offset:8192
    s_add_u32 m0, s35, 0
    s_nop 0
    buffer_load_dwordx4 v196, s[16:19], s32 offen lds
    s_add_u32 s32, s32, 1024
    s_waitcnt lgkmcnt(8)
    v_mfma_f32_16x16x32_bf16 v[112:115], v[156:159], v[200:203], v[112:115]
    v_mfma_f32_16x16x32_bf16 v[116:119], v[156:159], v[204:207], v[116:119]
    ds_read_b64_tr_b16 v[140:141], v187 offset:0
    ds_read_b64_tr_b16 v[142:143], v187 offset:8192
    s_waitcnt lgkmcnt(7)
    v_mfma_f32_16x16x32_bf16 v[0:3], v[128:131], v[160:163], v[0:3]
    ds_read_b64_tr_b16 v[144:145], v188 offset:0
    ds_read_b64_tr_b16 v[146:147], v188 offset:8192
    s_waitcnt lgkmcnt(8)
    v_mfma_f32_16x16x32_bf16 v[4:7], v[128:131], v[164:167], v[4:7]
    s_waitcnt lgkmcnt(6)
    v_mfma_f32_16x16x32_bf16 v[16:19], v[132:135], v[160:163], v[16:19]
    ds_read_b64_tr_b16 v[148:149], v189 offset:0
    ds_read_b64_tr_b16 v[150:151], v189 offset:8192
    v_mfma_f32_16x16x32_bf16 v[20:23], v[132:135], v[164:167], v[20:23]
    s_waitcnt lgkmcnt(6)
    v_mfma_f32_16x16x32_bf16 v[32:35], v[136:139], v[160:163], v[32:35]
    ds_read_b64_tr_b16 v[152:153], v190 offset:0
    ds_read_b64_tr_b16 v[154:155], v190 offset:8192
    v_mfma_f32_16x16x32_bf16 v[36:39], v[136:139], v[164:167], v[36:39]
    s_waitcnt lgkmcnt(6)
    v_mfma_f32_16x16x32_bf16 v[48:51], v[140:143], v[160:163], v[48:51]
    ds_read_b64_tr_b16 v[156:157], v191 offset:0
    ds_read_b64_tr_b16 v[158:159], v191 offset:8192
    v_mfma_f32_16x16x32_bf16 v[52:55], v[140:143], v[164:167], v[52:55]
    s_waitcnt vmcnt(3)
    s_barrier
    s_waitcnt lgkmcnt(6)
    v_mfma_f32_16x16x32_bf16 v[64:67], v[144:147], v[160:163], v[64:67]
    ds_read_b128 v[200:203], v193 offset:32768
    v_mfma_f32_16x16x32_bf16 v[68:71], v[144:147], v[164:167], v[68:71]
    ds_read_b64_tr_b16 v[128:129], v184 offset:32768
    ds_read_b64_tr_b16 v[130:131], v184 offset:40960
    s_add_u32 m0, s34, 32768
    s_nop 0
    buffer_load_dwordx4 v194, s[12:15], s31 offen lds
    s_waitcnt lgkmcnt(7)
    v_mfma_f32_16x16x32_bf16 v[80:83], v[148:151], v[160:163], v[80:83]
    ds_read_b128 v[204:207], v193 offset:33792
    v_mfma_f32_16x16x32_bf16 v[84:87], v[148:151], v[164:167], v[84:87]
    ds_read_b64_tr_b16 v[132:133], v185 offset:32768
    ds_read_b64_tr_b16 v[134:135], v185 offset:40960
    s_add_u32 m0, s34, 33792
    s_nop 0
    buffer_load_dwordx4 v195, s[12:15], s31 offen lds
    s_add_u32 s31, s31, s37
    s_waitcnt lgkmcnt(8)
    v_mfma_f32_16x16x32_bf16 v[96:99], v[152:155], v[160:163], v[96:99]
    v_mfma_f32_16x16x32_bf16 v[100:103], v[152:155], v[164:167], v[100:103]
    ds_read_b64_tr_b16 v[136:137], v186 offset:32768
    ds_read_b64_tr_b16 v[138:139], v186 offset:40960
    s_add_u32 m0, s35, 32768
    s_nop 0
    buffer_load_dwordx4 v196, s[16:19], s32 offen lds
    s_add_u32 s32, s32, 1024
    s_waitcnt lgkmcnt(8)
    v_mfma_f32_16x16x32_bf16 v[112:115], v[156:159], v[160:163], v[112:115]
    v_mfma_f32_16x16x32_bf16 v[116:119], v[156:159], v[164:167], v[116:119]
    ds_read_b64_tr_b16 v[140:141], v187 offset:32768
    ds_read_b64_tr_b16 v[142:143], v187 offset:40960
    s_waitcnt lgkmcnt(7)
    v_mfma_f32_16x16x32_bf16 v[0:3], v[128:131], v[200:203], v[0:3]
    ds_read_b64_tr_b16 v[144:145], v188 offset:32768
    ds_read_b64_tr_b16 v[146:147], v188 offset:40960
    s_waitcnt lgkmcnt(8)
    v_mfma_f32_16x16x32_bf16 v[4:7], v[128:131], v[204:207], v[4:7]
    s_waitcnt lgkmcnt(6)
    v_mfma_f32_16x16x32_bf16 v[16:19], v[132:135], v[200:203], v[16:19]
    ds_read_b64_tr_b16 v[148:149], v189 offset:32768
    ds_read_b64_tr_b16 v[150:151], v189 offset:40960
    v_mfma_f32_16x16x32_bf16 v[20:23], v[132:135], v[204:207], v[20:23]
    s_waitcnt lgkmcnt(6)
    v_mfma_f32_16x16x32_bf16 v[32:35], v[136:139], v[200:203], v[32:35]
    ds_read_b64_tr_b16 v[152:153], v190 offset:32768
    ds_read_b64_tr_b16 v[154:155], v190 offset:40960
    v_mfma_f32_16x16x32_bf16 v[36:39], v[136:139], v[204:207], v[36:39]
    s_waitcnt lgkmcnt(6)
    v_mfma_f32_16x16x32_bf16 v[48:51], v[140:143], v[200:203], v[48:51]
    ds_read_b64_tr_b16 v[156:157], v191 offset:32768
    ds_read_b64_tr_b16 v[158:159], v191 offset:40960
    v_mfma_f32_16x16x32_bf16 v[52:55], v[140:143], v[204:207], v[52:55]
    s_waitcnt vmcnt(3)
    s_barrier
    s_waitcnt lgkmcnt(6)
    v_mfma_f32_16x16x32_bf16 v[64:67], v[144:147], v[200:203], v[64:67]
    ds_read_b128 v[160:163], v192 offset:0
    v_mfma_f32_16x16x32_bf16 v[68:71], v[144:147], v[204:207], v[68:71]
    ds_read_b64_tr_b16 v[128:129], v176 offset:0
    ds_read_b64_tr_b16 v[130:131], v176 offset:8192
    s_add_u32 m0, s34, 65536
    s_nop 0
    buffer_load_dwordx4 v194, s[12:15], s31 offen lds
    s_waitcnt lgkmcnt(7)
    v_mfma_f32_16x16x32_bf16 v[80:83], v[148:151], v[200:203], v[80:83]
    ds_read_b128 v[164:167], v192 offset:1024
    v_mfma_f32_16x16x32_bf16 v[84:87], v[148:151], v[204:207], v[84:87]
    ds_read_b64_tr_b16 v[132:133], v177 offset:0
    ds_read_b64_tr_b16 v[134:135], v177 offset:8192
    s_add_u32 m0, s34, 66560
    s_nop 0
    buffer_load_dwordx4 v195, s[12:15], s31 offen lds
    s_add_u32 s31, s31, s37
    s_waitcnt lgkmcnt(8)
    v_mfma_f32_16x16x32_bf16 v[96:99], v[152:155], v[200:203], v[96:99]
    v_mfma_f32_16x16x32_bf16 v[100:103], v[152:155], v[204:207], v[100:103]
    ds_read_b64_tr_b16 v[136:137], v178 offset:0
    ds_read_b64_tr_b16 v[138:139], v178 offset:8192
    s_add_u32 m0, s35, 65536
    s_nop 0
    buffer_load_dwordx4 v196, s[16:19], s32 offen lds
    s_add_u32 s32, s32, 1024
    s_waitcnt lgkmcnt(8)
    v_mfma_f32_16x16x32_bf16 v[112:115], v[156:159], v[200:203], v[112:115]
    v_mfma_f32_16x16x32_bf16 v[116:119], v[156:159], v[204:207], v[116:119]
    ds_read_b64_tr_b16 v[140:141], v179 offset:0
    ds_read_b64_tr_b16 v[142:143], v179 offset:8192
    s_waitcnt lgkmcnt(7)
    v_mfma_f32_16x16x32_bf16 v[0:3], v[128:131], v[160:163], v[0:3]
    ds_read_b64_tr_b16 v[144:145], v180 offset:0
    ds_read_b64_tr_b16 v[146:147], v180 offset:8192
    s_waitcnt lgkmcnt(8)
    v_mfma_f32_16x16x32_bf16 v[4:7], v[128:131], v[164:167], v[4:7]
    s_waitcnt lgkmcnt(6)
    v_mfma_f32_16x16x32_bf16 v[16:19], v[132:135], v[160:163], v[16:19]
    ds_read_b64_tr_b16 v[148:149], v181 offset:0
    ds_read_b64_tr_b16 v[150:151], v181 offset:8192
    v_mfma_f32_16x16x32_bf16 v[20:23], v[132:135], v[164:167], v[20:23]
    s_waitcnt lgkmcnt(6)
    v_mfma_f32_16x16x32_bf16 v[32:35], v[136:139], v[160:163], v[32:35]
    ds_read_b64_tr_b16 v[152:153], v182 offset:0
    ds_read_b64_tr_b16 v[154:155], v182 offset:8192
    v_mfma_f32_16x16x32_bf16 v[36:39], v[136:139], v[164:167], v[36:39]
    s_waitcnt lgkmcnt(6)
    v_mfma_f32_16x16x32_bf16 v[48:51], v[140:143], v[160:163], v[48:51]
    ds_read_b64_tr_b16 v[156:157], v183 offset:0
    ds_read_b64_tr_b16 v[158:159], v183 offset:8192
    v_mfma_f32_16x16x32_bf16 v[52:55], v[140:143], v[164:167], v[52:55]
    s_waitcnt vmcnt(3)
    s_barrier
    s_waitcnt lgkmcnt(6)
    v_mfma_f32_16x16x32_bf16 v[64:67], v[144:147], v[160:163], v[64:67]
    ds_read_b128 v[200:203], v192 offset:32768
    v_mfma_f32_16x16x32_bf16 v[68:71], v[144:147], v[164:167], v[68:71]
    ds_read_b64_tr_b16 v[128:129], v176 offset:32768
    ds_read_b64_tr_b16 v[130:131], v176 offset:40960
    s_add_u32 m0, s34, 98304
    s_nop 0
    buffer_load_dwordx4 v194, s[12:15], s31 offen lds
    s_waitcnt lgkmcnt(7)
    v_mfma_f32_16x16x32_bf16 v[80:83], v[148:151], v[160:163], v[80:83]
    ds_read_b128 v[204:207], v192 offset:33792
    v_mfma_f32_16x16x32_bf16 v[84:87], v[148:151], v[164:167], v[84:87]
    ds_read_b64_tr_b16 v[132:133], v177 offset:32768
    ds_read_b64_tr_b16 v[134:135], v177 offset:40960
    s_add_u32 m0, s34, 99328
    s_nop 0
    buffer_load_dwordx4 v195, s[12:15], s31 offen lds
    s_add_u32 s31, s31, s37
    s_waitcnt lgkmcnt(8)
    v_mfma_f32_16x16x32_bf16 v[96:99], v[152:155], v[160:163], v[96:99]
    v_mfma_f32_16x16x32_bf16 v[100:103], v[152:155], v[164:167], v[100:103]
    ds_read_b64_tr_b16 v[136:137], v178 offset:32768
    ds_read_b64_tr_b16 v[138:139], v178 offset:40960
    s_add_u32 m0, s35, 98304
    s_nop 0
    buffer_load_dwordx4 v196, s[16:19], s32 offen lds
    s_add_u32 s32, s32, 1024
    s_waitcnt lgkmcnt(8)
    v_mfma_f32_16x16x32_bf16 v[112:115], v[156:159], v[160:163], v[112:115]
    v_mfma_f32_16x16x32_bf16 v[116:119], v[156:159], v[164:167], v[116:119]
    ds_read_b64_tr_b16 v[140:141], v179 offset:32768
    ds_read_b64_tr_b16 v[142:143], v179 offset:40960
    s_waitcnt lgkmcnt(7)
    v_mfma_f32_16x16x32_bf16 v[0:3], v[128:131], v[200:203], v[0:3]
    ds_read_b64_tr_b16 v[144:145], v180 offset:32768
    ds_read_b64_tr_b16 v[146:147], v180 offset:40960
    s_waitcnt lgkmcnt(8)
    v_mfma_f32_16x16x32_bf16 v[4:7], v[128:131], v[204:207], v[4:7]
    s_waitcnt lgkmcnt(6)
    v_mfma_f32_16x16x32_bf16 v[16:19], v[132:135], v[200:203], v[16:19]
    ds_read_b64_tr_b16 v[148:149], v181 offset:32768
    ds_read_b64_tr_b16 v[150:151], v181 offset:40960
    v_mfma_f32_16x16x32_bf16 v[20:23], v[132:135], v[204:207], v[20:23]
    s_waitcnt lgkmcnt(6)
    v_mfma_f32_16x16x32_bf16 v[32:35], v[136:139], v[200:203], v[32:35]
    ds_read_b64_tr_b16 v[152:153], v182 offset:32768
    ds_read_b64_tr_b16 v[154:155], v182 offset:40960
    v_mfma_f32_16x16x32_bf16 v[36:39], v[136:139], v[204:207], v[36:39]
    s_waitcnt lgkmcnt(6)
    v_mfma_f32_16x16x32_bf16 v[48:51], v[140:143], v[200:203], v[48:51]
    ds_read_b64_tr_b16 v[156:157], v183 offset:32768
    ds_read_b64_tr_b16 v[158:159], v183 offset:40960
    v_mfma_f32_16x16x32_bf16 v[52:55], v[140:143], v[204:207], v[52:55]
    s_waitcnt vmcnt(3)
    s_barrier
    s_waitcnt lgkmcnt(6)
    v_mfma_f32_16x16x32_bf16 v[64:67], v[144:147], v[200:203], v[64:67]
    ds_read_b128 v[160:163], v193 offset:0
    v_mfma_f32_16x16x32_bf16 v[68:71], v[144:147], v[204:207], v[68:71]
    ds_read_b64_tr_b16 v[128:129], v184 offset:0
    ds_read_b64_tr_b16 v[130:131], v184 offset:8192
    s_add_u32 m0, s34, 0
    s_nop 0
    buffer_load_dwordx4 v194, s[12:15], s31 offen lds
    s_waitcnt lgkmcnt(7)
    v_mfma_f32_16x16x32_bf16 v[80:83], v[148:151], v[200:203], v[80:83]
    ds_read_b128 v[164:167], v193 offset:1024
    v_mfma_f32_16x16x32_bf16 v[84:87], v[148:151], v[204:207], v[84:87]
    ds_read_b64_tr_b16 v[132:133], v185 offset:0
    ds_read_b64_tr_b16 v[134:135], v185 offset:8192
    s_add_u32 m0, s34, 1024
    s_nop 0
    buffer_load_dwordx4 v195, s[12:15], s31 offen lds
    s_add_u32 s31, s31, s37
    s_waitcnt lgkmcnt(8)
    v_mfma_f32_16x16x32_bf16 v[96:99], v[152:155], v[200:203], v[96:99]
    v_mfma_f32_16x16x32_bf16 v[100:103], v[152:155], v[204:207], v[100:103]
    ds_read_b64_tr_b16 v[136:137], v186 offset:0
    ds_read_b64_tr_b16 v[138:139], v186 offset:8192
    s_add_u32 m0, s35, 0
    s_nop 0
    buffer_load_dwordx4 v196, s[16:19], s32 offen lds
    s_add_u32 s32, s32, 1024
    s_waitcnt lgkmcnt(8)
    v_mfma_f32_16x16x32_bf16 v[112:115], v[156:159], v[200:203], v[112:115]
    v_mfma_f32_16x16x32_bf16 v[116:119], v[156:159], v[204:207], v[116:119]
    ds_read_b64_tr_b16 v[140:141], v187 offset:0
    ds_read_b64_tr_b16 v[142:143], v187 offset:8192
    s_waitcnt lgkmcnt(7)
    v_mfma_f32_16x16x32_bf16 v[0:3], v[128:131], v[160:163], v[0:3]
    ds_read_b64_tr_b16 v[144:145], v188 offset:0
    ds_read_b64_tr_b16 v[146:147], v188 offset:8192
    s_waitcnt lgkmcnt(8)
    v_mfma_f32_16x16x32_bf16 v[4:7], v[128:131], v[164:167], v[4:7]
    s_waitcnt lgkmcnt(6)
    v_mfma_f32_16x16x32_bf16 v[16:19], v[132:135], v[160:163], v[16:19]
    ds_read_b64_tr_b16 v[148:149], v189 offset:0
    ds_read_b64_tr_b16 v[150:151], v189 offset:8192
    v_mfma_f32_16x16x32_bf16 v[20:23], v[132:135], v[164:167], v[20:23]
    s_waitcnt lgkmcnt(6)
    v_mfma_f32_16x16x32_bf16 v[32:35], v[136:139], v[160:163], v[32:35]
    ds_read_b64_tr_b16 v[152:153], v190 offset:0
    ds_read_b64_tr_b16 v[154:155], v190 offset:8192
    v_mfma_f32_16x16x32_bf16 v[36:39], v[136:139], v[164:167], v[36:39]
    s_waitcnt lgkmcnt(6)
    v_mfma_f32_16x16x32_bf16 v[48:51], v[140:143], v[160:163], v[48:51]
    ds_read_b64_tr_b16 v[156:157], v191 offset:0
    ds_read_b64_tr_b16 v[158:159], v191 offset:8192
    v_mfma_f32_16x16x32_bf16 v[52:55], v[140:143], v[164:167], v[52:55]
    s_waitcnt vmcnt(3)
    s_barrier
    s_waitcnt lgkmcnt(6)
    v_mfma_f32_16x16x32_bf16 v[64:67], v[144:147], v[160:163], v[64:67]
    ds_read_b128 v[200:203], v193 offset:32768
    v_mfma_f32_16x16x32_bf16 v[68:71], v[144:147], v[164:167], v[68:71]
    ds_read_b64_tr_b16 v[128:129], v184 offset:32768
    ds_read_b64_tr_b16 v[130:131], v184 offset:40960
    s_add_u32 m0, s34, 32768
    s_nop 0
    buffer_load_dwordx4 v194, s[12:15], s31 offen lds
    s_waitcnt lgkmcnt(7)
    v_mfma_f32_16x16x32_bf16 v[80:83], v[148:151], v[160:163], v[80:83]
    ds_read_b128 v[204:207], v193 offset:33792
    v_mfma_f32_16x16x32_bf16 v[84:87], v[148:151], v[164:167], v[84:87]
    ds_read_b64_tr_b16 v[132:133], v185 offset:32768
    ds_read_b64_tr_b16 v[134:135], v185 offset:40960
    s_add_u32 m0, s34, 33792
    s_nop 0
    buffer_load_dwordx4 v195, s[12:15], s31 offen lds
    s_add_u32 s31, s31, s37
    s_waitcnt lgkmcnt(8)
    v_mfma_f32_16x16x32_bf16 v[96:99], v[152:155], v[160:163], v[96:99]
    v_mfma_f32_16x16x32_bf16 v[100:103], v[152:155], v[164:167], v[100:103]
    ds_read_b64_tr_b16 v[136:137], v186 offset:32768
    ds_read_b64_tr_b16 v[138:139], v186 offset:40960
    s_add_u32 m0, s35, 32768
    s_nop 0
    buffer_load_dwordx4 v196, s[16:19], s32 offen lds
    s_add_u32 s32, s32, 1024
    s_waitcnt lgkmcnt(8)
    v_mfma_f32_16x16x32_bf16 v[112:115], v[156:159], v[160:163], v[112:115]
    v_mfma_f32_16x16x32_bf16 v[116:119], v[156:159], v[164:167], v[116:119]
    ds_read_b64_tr_b16 v[140:141], v187 offset:32768
    ds_read_b64_tr_b16 v[142:143], v187 offset:40960
    s_waitcnt lgkmcnt(7)
    v_mfma_f32_16x16x32_bf16 v[0:3], v[128:131], v[200:203], v[0:3]
    ds_read_b64_tr_b16 v[144:145], v188 offset:32768
    ds_read_b64_tr_b16 v[146:147], v188 offset:40960
    s_waitcnt lgkmcnt(8)
    v_mfma_f32_16x16x32_bf16 v[4:7], v[128:131], v[204:207], v[4:7]
    s_waitcnt lgkmcnt(6)
    v_mfma_f32_16x16x32_bf16 v[16:19], v[132:135], v[200:203], v[16:19]
    ds_read_b64_tr_b16 v[148:149], v189 offset:32768
    ds_read_b64_tr_b16 v[150:151], v189 offset:40960
    v_mfma_f32_16x16x32_bf16 v[20:23], v[132:135], v[204:207], v[20:23]
    s_waitcnt lgkmcnt(6)
    v_mfma_f32_16x16x32_bf16 v[32:35], v[136:139], v[200:203], v[32:35]
    ds_read_b64_tr_b16 v[152:153], v190 offset:32768
    ds_read_b64_tr_b16 v[154:155], v190 offset:40960
    v_mfma_f32_16x16x32_bf16 v[36:39], v[136:139], v[204:207], v[36:39]
    s_waitcnt lgkmcnt(6)
    v_mfma_f32_16x16x32_bf16 v[48:51], v[140:143], v[200:203], v[48:51]
    ds_read_b64_tr_b16 v[156:157], v191 offset:32768
    ds_read_b64_tr_b16 v[158:159], v191 offset:40960
    v_mfma_f32_16x16x32_bf16 v[52:55], v[140:143], v[204:207], v[52:55]
    s_waitcnt vmcnt(3)
    s_barrier
    s_waitcnt lgkmcnt(6)
    v_mfma_f32_16x16x32_bf16 v[64:67], v[144:147], v[200:203], v[64:67]
    ds_read_b128 v[160:163], v192 offset:0
    v_mfma_f32_16x16x32_bf16 v[68:71], v[144:147], v[204:207], v[68:71]
    ds_read_b64_tr_b16 v[128:129], v176 offset:0
    ds_read_b64_tr_b16 v[130:131], v176 offset:8192
    s_add_u32 m0, s34, 65536
    s_nop 0
    buffer_load_dwordx4 v194, s[12:15], s31 offen lds
    s_waitcnt lgkmcnt(7)
    v_mfma_f32_16x16x32_bf16 v[80:83], v[148:151], v[200:203], v[80:83]
    ds_read_b128 v[164:167], v192 offset:1024
    v_mfma_f32_16x16x32_bf16 v[84:87], v[148:151], v[204:207], v[84:87]
    ds_read_b64_tr_b16 v[132:133], v177 offset:0
    ds_read_b64_tr_b16 v[134:135], v177 offset:8192
    s_add_u32 m0, s34, 66560
    s_nop 0
    buffer_load_dwordx4 v195, s[12:15], s31 offen lds
    s_add_u32 s31, s31, s37
    s_waitcnt lgkmcnt(8)
    v_mfma_f32_16x16x32_bf16 v[96:99], v[152:155], v[200:203], v[96:99]
    v_mfma_f32_16x16x32_bf16 v[100:103], v[152:155], v[204:207], v[100:103]
    ds_read_b64_tr_b16 v[136:137], v178 offset:0
    ds_read_b64_tr_b16 v[138:139], v178 offset:8192
    s_add_u32 m0, s35, 65536
    s_nop 0
    buffer_load_dwordx4 v196, s[16:19], s32 offen lds
    s_add_u32 s32, s32, 1024
    s_waitcnt lgkmcnt(8)
    v_mfma_f32_16x16x32_bf16 v[112:115], v[156:159], v[200:203], v[112:115]
    v_mfma_f32_16x16x32_bf16 v[116:119], v[156:159], v[204:207], v[116:119]
    ds_read_b64_tr_b16 v[140:141], v179 offset:0
    ds_read_b64_tr_b16 v[142:143], v179 offset:8192
    s_waitcnt lgkmcnt(7)
    v_mfma_f32_16x16x32_bf16 v[0:3], v[128:131], v[160:163], v[0:3]
    ds_read_b64_tr_b16 v[144:145], v180 offset:0
    ds_read_b64_tr_b16 v[146:147], v180 offset:8192
    s_waitcnt lgkmcnt(8)
    v_mfma_f32_16x16x32_bf16 v[4:7], v[128:131], v[164:167], v[4:7]
    s_waitcnt lgkmcnt(6)
    v_mfma_f32_16x16x32_bf16 v[16:19], v[132:135], v[160:163], v[16:19]
    ds_read_b64_tr_b16 v[148:149], v181 offset:0
    ds_read_b64_tr_b16 v[150:151], v181 offset:8192
    v_mfma_f32_16x16x32_bf16 v[20:23], v[132:135], v[164:167], v[20:23]
    s_waitcnt lgkmcnt(6)
    v_mfma_f32_16x16x32_bf16 v[32:35], v[136:139], v[160:163], v[32:35]
    ds_read_b64_tr_b16 v[152:153], v182 offset:0
    ds_read_b64_tr_b16 v[154:155], v182 offset:8192
    v_mfma_f32_16x16x32_bf16 v[36:39], v[136:139], v[164:167], v[36:39]
    s_waitcnt lgkmcnt(6)
    v_mfma_f32_16x16x32_bf16 v[48:51], v[140:143], v[160:163], v[48:51]
    ds_read_b64_tr_b16 v[156:157], v183 offset:0
    ds_read_b64_tr_b16 v[158:159], v183 offset:8192
    v_mfma_f32_16x16x32_bf16 v[52:55], v[140:143], v[164:167], v[52:55]
    s_waitcnt vmcnt(3)
    s_barrier
    s_waitcnt lgkmcnt(6)
    v_mfma_f32_16x16x32_bf16 v[64:67], v[144:147], v[160:163], v[64:67]
    ds_read_b128 v[200:203], v192 offset:32768
    v_mfma_f32_16x16x32_bf16 v[68:71], v[144:147], v[164:167], v[68:71]
    ds_read_b64_tr_b16 v[128:129], v176 offset:32768
    ds_read_b64_tr_b16 v[130:131], v176 offset:40960
    s_add_u32 m0, s34, 98304
    s_nop 0
    buffer_load_dwordx4 v194, s[12:15], s31 offen lds
    s_waitcnt lgkmcnt(7)
    v_mfma_f32_16x16x32_bf16 v[80:83], v[148:151], v[160:163], v[80:83]
    ds_read_b128 v[204:207], v192 offset:33792
    v_mfma_f32_16x16x32_bf16 v[84:87], v[148:151], v[164:167], v[84:87]
    ds_read_b64_tr_b16 v[132:133], v177 offset:32768
    ds_read_b64_tr_b16 v[134:135], v177 offset:40960
    s_add_u32 m0, s34, 99328
    s_nop 0
    buffer_load_dwordx4 v195, s[12:15], s31 offen lds
    s_add_u32 s31, s31, s37
    s_waitcnt lgkmcnt(8)
    v_mfma_f32_16x16x32_bf16 v[96:99], v[152:155], v[160:163], v[96:99]
    v_mfma_f32_16x16x32_bf16 v[100:103], v[152:155], v[164:167], v[100:103]
    ds_read_b64_tr_b16 v[136:137], v178 offset:32768
    ds_read_b64_tr_b16 v[138:139], v178 offset:40960
    s_add_u32 m0, s35, 98304
    s_nop 0
    buffer_load_dwordx4 v196, s[16:19], s32 offen lds
    s_add_u32 s32, s32, 1024
    s_waitcnt lgkmcnt(8)
    v_mfma_f32_16x16x32_bf16 v[112:115], v[156:159], v[160:163], v[112:115]
    v_mfma_f32_16x16x32_bf16 v[116:119], v[156:159], v[164:167], v[116:119]
    ds_read_b64_tr_b16 v[140:141], v179 offset:32768
    ds_read_b64_tr_b16 v[142:143], v179 offset:40960
    s_waitcnt lgkmcnt(7)
    v_mfma_f32_16x16x32_bf16 v[0:3], v[128:131], v[200:203], v[0:3]
    ds_read_b64_tr_b16 v[144:145], v180 offset:32768
    ds_read_b64_tr_b16 v[146:147], v180 offset:40960
    s_waitcnt lgkmcnt(8)
    v_mfma_f32_16x16x32_bf16 v[4:7], v[128:131], v[204:207], v[4:7]
    s_waitcnt lgkmcnt(6)
    v_mfma_f32_16x16x32_bf16 v[16:19], v[132:135], v[200:203], v[16:19]
    ds_read_b64_tr_b16 v[148:149], v181 offset:32768
    ds_read_b64_tr_b16 v[150:151], v181 offset:40960
    v_mfma_f32_16x16x32_bf16 v[20:23], v[132:135], v[204:207], v[20:23]
    s_waitcnt lgkmcnt(6)
    v_mfma_f32_16x16x32_bf16 v[32:35], v[136:139], v[200:203], v[32:35]
    ds_read_b64_tr_b16 v[152:153], v182 offset:32768
    ds_read_b64_tr_b16 v[154:155], v182 offset:40960
    v_mfma_f32_16x16x32_bf16 v[36:39], v[136:139], v[204:207], v[36:39]
    s_waitcnt lgkmcnt(6)
    v_mfma_f32_16x16x32_bf16 v[48:51], v[140:143], v[200:203], v[48:51]
    ds_read_b64_tr_b16 v[156:157], v183 offset:32768
    ds_read_b64_tr_b16 v[158:159], v183 offset:40960
    v_mfma_f32_16x16x32_bf16 v[52:55], v[140:143], v[204:207], v[52:55]
    s_waitcnt vmcnt(3)
    s_barrier
    s_waitcnt lgkmcnt(6)
    v_mfma_f32_16x16x32_bf16 v[64:67], v[144:147], v[200:203], v[64:67]
    ds_read_b128 v[160:163], v193 offset:0
    v_mfma_f32_16x16x32_bf16 v[68:71], v[144:147], v[204:207], v[68:71]
    ds_read_b64_tr_b16 v[128:129], v184 offset:0
    ds_read_b64_tr_b16 v[130:131], v184 offset:8192
    s_add_u32 m0, s34, 0
    s_nop 0
    buffer_load_dwordx4 v194, s[12:15], s31 offen lds
    s_waitcnt lgkmcnt(7)
    v_mfma_f32_16x16x32_bf16 v[80:83], v[148:151], v[200:203], v[80:83]
    ds_read_b128 v[164:167], v193 offset:1024
    v_mfma_f32_16x16x32_bf16 v[84:87], v[148:151], v[204:207], v[84:87]
    ds_read_b64_tr_b16 v[132:133], v185 offset:0
    ds_read_b64_tr_b16 v[134:135], v185 offset:8192
    s_add_u32 m0, s34, 1024
    s_nop 0
    buffer_load_dwordx4 v195, s[12:15], s31 offen lds
    s_add_u32 s31, s31, s37
    s_waitcnt lgkmcnt(8)
    v_mfma_f32_16x16x32_bf16 v[96:99], v[152:155], v[200:203], v[96:99]
    v_mfma_f32_16x16x32_bf16 v[100:103], v[152:155], v[204:207], v[100:103]
    ds_read_b64_tr_b16 v[136:137], v186 offset:0
    ds_read_b64_tr_b16 v[138:139], v186 offset:8192
    s_add_u32 m0, s35, 0
    s_nop 0
    buffer_load_dwordx4 v196, s[16:19], s32 offen lds
    s_add_u32 s32, s32, 1024
    s_waitcnt lgkmcnt(8)
    v_mfma_f32_16x16x32_bf16 v[112:115], v[156:159], v[200:203], v[112:115]
    v_mfma_f32_16x16x32_bf16 v[116:119], v[156:159], v[204:207], v[116:119]
    ds_read_b64_tr_b16 v[140:141], v187 offset:0
    ds_read_b64_tr_b16 v[142:143], v187 offset:8192
    s_waitcnt lgkmcnt(7)
    v_mfma_f32_16x16x32_bf16 v[0:3], v[128:131], v[160:163], v[0:3]
    ds_read_b64_tr_b16 v[144:145], v188 offset:0
    ds_read_b64_tr_b16 v[146:147], v188 offset:8192
    s_waitcnt lgkmcnt(8)
    v_mfma_f32_16x16x32_bf16 v[4:7], v[128:131], v[164:167], v[4:7]
    s_waitcnt lgkmcnt(6)
    v_mfma_f32_16x16x32_bf16 v[16:19], v[132:135], v[160:163], v[16:19]
    ds_read_b64_tr_b16 v[148:149], v189 offset:0
    ds_read_b64_tr_b16 v[150:151], v189 offset:8192
    v_mfma_f32_16x16x32_bf16 v[20:23], v[132:135], v[164:167], v[20:23]
    s_waitcnt lgkmcnt(6)
    v_mfma_f32_16x16x32_bf16 v[32:35], v[136:139], v[160:163], v[32:35]
    ds_read_b64_tr_b16 v[152:153], v190 offset:0
    ds_read_b64_tr_b16 v[154:155], v190 offset:8192
    v_mfma_f32_16x16x32_bf16 v[36:39], v[136:139], v[164:167], v[36:39]
    s_waitcnt lgkmcnt(6)
    v_mfma_f32_16x16x32_bf16 v[48:51], v[140:143], v[160:163], v[48:51]
    ds_read_b64_tr_b16 v[156:157], v191 offset:0
    ds_read_b64_tr_b16 v[158:159], v191 offset:8192
    v_mfma_f32_16x16x32_bf16 v[52:55], v[140:143], v[164:167], v[52:55]
    s_waitcnt vmcnt(3)
    s_barrier
    s_waitcnt lgkmcnt(6)
    v_mfma_f32_16x16x32_bf16 v[64:67], v[144:147], v[160:163], v[64:67]
    ds_read_b128 v[200:203], v193 offset:32768
    v_mfma_f32_16x16x32_bf16 v[68:71], v[144:147], v[164:167], v[68:71]
    ds_read_b64_tr_b16 v[128:129], v184 offset:32768
    ds_read_b64_tr_b16 v[130:131], v184 offset:40960
    s_add_u32 m0, s34, 32768
    s_nop 0
    buffer_load_dwordx4 v194, s[12:15], s31 offen lds
    s_waitcnt lgkmcnt(7)
    v_mfma_f32_16x16x32_bf16 v[80:83], v[148:151], v[160:163], v[80:83]
    ds_read_b128 v[204:207], v193 offset:33792
    v_mfma_f32_16x16x32_bf16 v[84:87], v[148:151], v[164:167], v[84:87]
    ds_read_b64_tr_b16 v[132:133], v185 offset:32768
    ds_read_b64_tr_b16 v[134:135], v185 offset:40960
    s_add_u32 m0, s34, 33792
    s_nop 0
    buffer_load_dwordx4 v195, s[12:15], s31 offen lds
    s_add_u32 s31, s31, s37
    s_waitcnt lgkmcnt(8)
    v_mfma_f32_16x16x32_bf16 v[96:99], v[152:155], v[160:163], v[96:99]
    v_mfma_f32_16x16x32_bf16 v[100:103], v[152:155], v[164:167], v[100:103]
    ds_read_b64_tr_b16 v[136:137], v186 offset:32768
    ds_read_b64_tr_b16 v[138:139], v186 offset:40960
    s_add_u32 m0, s35, 32768
    s_nop 0
    buffer_load_dwordx4 v196, s[16:19], s32 offen lds
    s_add_u32 s32, s32, 1024
    s_waitcnt lgkmcnt(8)
    v_mfma_f32_16x16x32_bf16 v[112:115], v[156:159], v[160:163], v[112:115]
    v_mfma_f32_16x16x32_bf16 v[116:119], v[156:159], v[164:167], v[116:119]
    ds_read_b64_tr_b16 v[140:141], v187 offset:32768
    ds_read_b64_tr_b16 v[142:143], v187 offset:40960
    s_waitcnt lgkmcnt(7)
    v_mfma_f32_16x16x32_bf16 v[0:3], v[128:131], v[200:203], v[0:3]
    ds_read_b64_tr_b16 v[144:145], v188 offset:32768
    ds_read_b64_tr_b16 v[146:147], v188 offset:40960
    s_waitcnt lgkmcnt(8)
    v_mfma_f32_16x16x32_bf16 v[4:7], v[128:131], v[204:207], v[4:7]
    s_waitcnt lgkmcnt(6)
    v_mfma_f32_16x16x32_bf16 v[16:19], v[132:135], v[200:203], v[16:19]
    ds_read_b64_tr_b16 v[148:149], v189 offset:32768
    ds_read_b64_tr_b16 v[150:151], v189 offset:40960
    v_mfma_f32_16x16x32_bf16 v[20:23], v[132:135], v[204:207], v[20:23]
    s_waitcnt lgkmcnt(6)
    v_mfma_f32_16x16x32_bf16 v[32:35], v[136:139], v[200:203], v[32:35]
    ds_read_b64_tr_b16 v[152:153], v190 offset:32768
    ds_read_b64_tr_b16 v[154:155], v190 offset:40960
    v_mfma_f32_16x16x32_bf16 v[36:39], v[136:139], v[204:207], v[36:39]
    s_waitcnt lgkmcnt(6)
    v_mfma_f32_16x16x32_bf16 v[48:51], v[140:143], v[200:203], v[48:51]
    ds_read_b64_tr_b16 v[156:157], v191 offset:32768
    ds_read_b64_tr_b16 v[158:159], v191 offset:40960
    v_mfma_f32_16x16x32_bf16 v[52:55], v[140:143], v[204:207], v[52:55]
    s_waitcnt vmcnt(3)
    s_barrier
    s_waitcnt lgkmcnt(6)
    v_mfma_f32_16x16x32_bf16 v[64:67], v[144:147], v[200:203], v[64:67]
    ds_read_b128 v[160:163], v192 offset:0
    v_mfma_f32_16x16x32_bf16 v[68:71], v[144:147], v[204:207], v[68:71]
    ds_read_b64_tr_b16 v[128:129], v176 offset:0
    ds_read_b64_tr_b16 v[130:131], v176 offset:8192
    s_add_u32 m0, s34, 65536
    s_nop 0
    buffer_load_dwordx4 v194, s[12:15], s31 offen lds
    s_waitcnt lgkmcnt(7)
    v_mfma_f32_16x16x32_bf16 v[80:83], v[148:151], v[200:203], v[80:83]
    ds_read_b128 v[164:167], v192 offset:1024
    v_mfma_f32_16x16x32_bf16 v[84:87], v[148:151], v[204:207], v[84:87]
    ds_read_b64_tr_b16 v[132:133], v177 offset:0
    ds_read_b64_tr_b16 v[134:135], v177 offset:8192
    s_add_u32 m0, s34, 66560
    s_nop 0
    buffer_load_dwordx4 v195, s[12:15], s31 offen lds
    s_add_u32 s31, s31, s37
    s_waitcnt lgkmcnt(8)
    v_mfma_f32_16x16x32_bf16 v[96:99], v[152:155], v[200:203], v[96:99]
    v_mfma_f32_16x16x32_bf16 v[100:103], v[152:155], v[204:207], v[100:103]
    ds_read_b64_tr_b16 v[136:137], v178 offset:0
    ds_read_b64_tr_b16 v[138:139], v178 offset:8192
    s_add_u32 m0, s35, 65536
    s_nop 0
    buffer_load_dwordx4 v196, s[16:19], s32 offen lds
    s_add_u32 s32, s32, 1024
    s_waitcnt lgkmcnt(8)
    v_mfma_f32_16x16x32_bf16 v[112:115], v[156:159], v[200:203], v[112:115]
    v_mfma_f32_16x16x32_bf16 v[116:119], v[156:159], v[204:207], v[116:119]
    ds_read_b64_tr_b16 v[140:141], v179 offset:0
    ds_read_b64_tr_b16 v[142:143], v179 offset:8192
    s_waitcnt lgkmcnt(7)
    v_mfma_f32_16x16x32_bf16 v[0:3], v[128:131], v[160:163], v[0:3]
    ds_read_b64_tr_b16 v[144:145], v180 offset:0
    ds_read_b64_tr_b16 v[146:147], v180 offset:8192
    s_waitcnt lgkmcnt(8)
    v_mfma_f32_16x16x32_bf16 v[4:7], v[128:131], v[164:167], v[4:7]
    s_waitcnt lgkmcnt(6)
    v_mfma_f32_16x16x32_bf16 v[16:19], v[132:135], v[160:163], v[16:19]
    ds_read_b64_tr_b16 v[148:149], v181 offset:0
    ds_read_b64_tr_b16 v[150:151], v181 offset:8192
    v_mfma_f32_16x16x32_bf16 v[20:23], v[132:135], v[164:167], v[20:23]
    s_waitcnt lgkmcnt(6)
    v_mfma_f32_16x16x32_bf16 v[32:35], v[136:139], v[160:163], v[32:35]
    ds_read_b64_tr_b16 v[152:153], v182 offset:0
    ds_read_b64_tr_b16 v[154:155], v182 offset:8192
    v_mfma_f32_16x16x32_bf16 v[36:39], v[136:139], v[164:167], v[36:39]
    s_waitcnt lgkmcnt(6)
    v_mfma_f32_16x16x32_bf16 v[48:51], v[140:143], v[160:163], v[48:51]
    ds_read_b64_tr_b16 v[156:157], v183 offset:0
    ds_read_b64_tr_b16 v[158:159], v183 offset:8192
    v_mfma_f32_16x16x32_bf16 v[52:55], v[140:143], v[164:167], v[52:55]
    s_waitcnt vmcnt(3)
    s_barrier
    s_waitcnt lgkmcnt(6)
    v_mfma_f32_16x16x32_bf16 v[64:67], v[144:147], v[160:163], v[64:67]
    ds_read_b128 v[200:203], v192 offset:32768
    v_mfma_f32_16x16x32_bf16 v[68:71], v[144:147], v[164:167], v[68:71]
    ds_read_b64_tr_b16 v[128:129], v176 offset:32768
    ds_read_b64_tr_b16 v[130:131], v176 offset:40960
    s_add_u32 m0, s34, 98304
    s_nop 0
    buffer_load_dwordx4 v194, s[12:15], s31 offen lds
    s_waitcnt lgkmcnt(7)
    v_mfma_f32_16x16x32_bf16 v[80:83], v[148:151], v[160:163], v[80:83]
    ds_read_b128 v[204:207], v192 offset:33792
    v_mfma_f32_16x16x32_bf16 v[84:87], v[148:151], v[164:167], v[84:87]
    ds_read_b64_tr_b16 v[132:133], v177 offset:32768
    ds_read_b64_tr_b16 v[134:135], v177 offset:40960
    s_add_u32 m0, s34, 99328
    s_nop 0
    buffer_load_dwordx4 v195, s[12:15], s31 offen lds
    s_add_u32 s31, s31, s37
    s_waitcnt lgkmcnt(8)
    v_mfma_f32_16x16x32_bf16 v[96:99], v[152:155], v[160:163], v[96:99]
    v_mfma_f32_16x16x32_bf16 v[100:103], v[152:155], v[164:167], v[100:103]
    ds_read_b64_tr_b16 v[136:137], v178 offset:32768
    ds_read_b64_tr_b16 v[138:139], v178 offset:40960
    s_add_u32 m0, s35, 98304
    s_nop 0
    buffer_load_dwordx4 v196, s[16:19], s32 offen lds
    s_add_u32 s32, s32, 1024
    s_waitcnt lgkmcnt(8)
    v_mfma_f32_16x16x32_bf16 v[112:115], v[156:159], v[160:163], v[112:115]
    v_mfma_f32_16x16x32_bf16 v[116:119], v[156:159], v[164:167], v[116:119]
    ds_read_b64_tr_b16 v[140:141], v179 offset:32768
    ds_read_b64_tr_b16 v[142:143], v179 offset:40960
    s_waitcnt lgkmcnt(7)
    v_mfma_f32_16x16x32_bf16 v[0:3], v[128:131], v[200:203], v[0:3]
    ds_read_b64_tr_b16 v[144:145], v180 offset:32768
    ds_read_b64_tr_b16 v[146:147], v180 offset:40960
    s_waitcnt lgkmcnt(8)
    v_mfma_f32_16x16x32_bf16 v[4:7], v[128:131], v[204:207], v[4:7]
    s_waitcnt lgkmcnt(6)
    v_mfma_f32_16x16x32_bf16 v[16:19], v[132:135], v[200:203], v[16:19]
    ds_read_b64_tr_b16 v[148:149], v181 offset:32768
    ds_read_b64_tr_b16 v[150:151], v181 offset:40960
    v_mfma_f32_16x16x32_bf16 v[20:23], v[132:135], v[204:207], v[20:23]
    s_waitcnt lgkmcnt(6)
    v_mfma_f32_16x16x32_bf16 v[32:35], v[136:139], v[200:203], v[32:35]
    ds_read_b64_tr_b16 v[152:153], v182 offset:32768
    ds_read_b64_tr_b16 v[154:155], v182 offset:40960
    v_mfma_f32_16x16x32_bf16 v[36:39], v[136:139], v[204:207], v[36:39]
    s_waitcnt lgkmcnt(6)
    v_mfma_f32_16x16x32_bf16 v[48:51], v[140:143], v[200:203], v[48:51]
    ds_read_b64_tr_b16 v[156:157], v183 offset:32768
    ds_read_b64_tr_b16 v[158:159], v183 offset:40960
    v_mfma_f32_16x16x32_bf16 v[52:55], v[140:143], v[204:207], v[52:55]
    s_waitcnt vmcnt(3)
    s_barrier
    s_waitcnt lgkmcnt(6)
    v_mfma_f32_16x16x32_bf16 v[64:67], v[144:147], v[200:203], v[64:67]
    ds_read_b128 v[160:163], v193 offset:0
    v_mfma_f32_16x16x32_bf16 v[68:71], v[144:147], v[204:207], v[68:71]
    ds_read_b64_tr_b16 v[128:129], v184 offset:0
    ds_read_b64_tr_b16 v[130:131], v184 offset:8192
    s_waitcnt lgkmcnt(7)
    v_mfma_f32_16x16x32_bf16 v[80:83], v[148:151], v[200:203], v[80:83]
    ds_read_b128 v[164:167], v193 offset:1024
    v_mfma_f32_16x16x32_bf16 v[84:87], v[148:151], v[204:207], v[84:87]
    ds_read_b64_tr_b16 v[132:133], v185 offset:0
    ds_read_b64_tr_b16 v[134:135], v185 offset:8192
    s_waitcnt lgkmcnt(8)
    v_mfma_f32_16x16x32_bf16 v[96:99], v[152:155], v[200:203], v[96:99]
    v_mfma_f32_16x16x32_bf16 v[100:103], v[152:155], v[204:207], v[100:103]
    ds_read_b64_tr_b16 v[136:137], v186 offset:0
    ds_read_b64_tr_b16 v[138:139], v186 offset:8192
    s_waitcnt lgkmcnt(8)
    v_mfma_f32_16x16x32_bf16 v[112:115], v[156:159], v[200:203], v[112:115]
    v_mfma_f32_16x16x32_bf16 v[116:119], v[156:159], v[204:207], v[116:119]
    ds_read_b64_tr_b16 v[140:141], v187 offset:0
    ds_read_b64_tr_b16 v[142:143], v187 offset:8192
    s_waitcnt lgkmcnt(7)
    v_mfma_f32_16x16x32_bf16 v[0:3], v[128:131], v[160:163], v[0:3]
    ds_read_b64_tr_b16 v[144:145], v188 offset:0
    ds_read_b64_tr_b16 v[146:147], v188 offset:8192
    s_waitcnt lgkmcnt(8)
    v_mfma_f32_16x16x32_bf16 v[4:7], v[128:131], v[164:167], v[4:7]
    s_waitcnt lgkmcnt(6)
    v_mfma_f32_16x16x32_bf16 v[16:19], v[132:135], v[160:163], v[16:19]
    ds_read_b64_tr_b16 v[148:149], v189 offset:0
    ds_read_b64_tr_b16 v[150:151], v189 offset:8192
    v_mfma_f32_16x16x32_bf16 v[20:23], v[132:135], v[164:167], v[20:23]
    s_waitcnt lgkmcnt(6)
    v_mfma_f32_16x16x32_bf16 v[32:35], v[136:139], v[160:163], v[32:35]
    ds_read_b64_tr_b16 v[152:153], v190 offset:0
    ds_read_b64_tr_b16 v[154:155], v190 offset:8192
    v_mfma_f32_16x16x32_bf16 v[36:39], v[136:139], v[164:167], v[36:39]
    s_waitcnt lgkmcnt(6)
    v_mfma_f32_16x16x32_bf16 v[48:51], v[140:143], v[160:163], v[48:51]
    ds_read_b64_tr_b16 v[156:157], v191 offset:0
    ds_read_b64_tr_b16 v[158:159], v191 offset:8192
    v_mfma_f32_16x16x32_bf16 v[52:55], v[140:143], v[164:167], v[52:55]
    s_waitcnt vmcnt(0)
    s_barrier
    s_waitcnt lgkmcnt(6)
    v_mfma_f32_16x16x32_bf16 v[64:67], v[144:147], v[160:163], v[64:67]
    ds_read_b128 v[200:203], v193 offset:32768
    v_mfma_f32_16x16x32_bf16 v[68:71], v[144:147], v[164:167], v[68:71]
    ds_read_b64_tr_b16 v[128:129], v184 offset:32768
    ds_read_b64_tr_b16 v[130:131], v184 offset:40960
    s_waitcnt lgkmcnt(7)
    v_mfma_f32_16x16x32_bf16 v[80:83], v[148:151], v[160:163], v[80:83]
    ds_read_b128 v[204:207], v193 offset:33792
    v_mfma_f32_16x16x32_bf16 v[84:87], v[148:151], v[164:167], v[84:87]
    ds_read_b64_tr_b16 v[132:133], v185 offset:32768
    ds_read_b64_tr_b16 v[134:135], v185 offset:40960
    s_waitcnt lgkmcnt(8)
    v_mfma_f32_16x16x32_bf16 v[96:99], v[152:155], v[160:163], v[96:99]
    v_mfma_f32_16x16x32_bf16 v[100:103], v[152:155], v[164:167], v[100:103]
    ds_read_b64_tr_b16 v[136:137], v186 offset:32768
    ds_read_b64_tr_b16 v[138:139], v186 offset:40960
    s_waitcnt lgkmcnt(8)
    v_mfma_f32_16x16x32_bf16 v[112:115], v[156:159], v[160:163], v[112:115]
    v_mfma_f32_16x16x32_bf16 v[116:119], v[156:159], v[164:167], v[116:119]
    ds_read_b64_tr_b16 v[140:141], v187 offset:32768
    ds_read_b64_tr_b16 v[142:143], v187 offset:40960
    s_waitcnt lgkmcnt(7)
    v_mfma_f32_16x16x32_bf16 v[0:3], v[128:131], v[200:203], v[0:3]
    ds_read_b64_tr_b16 v[144:145], v188 offset:32768
    ds_read_b64_tr_b16 v[146:147], v188 offset:40960
    s_waitcnt lgkmcnt(8)
    v_mfma_f32_16x16x32_bf16 v[4:7], v[128:131], v[204:207], v[4:7]
    s_waitcnt lgkmcnt(6)
    v_mfma_f32_16x16x32_bf16 v[16:19], v[132:135], v[200:203], v[16:19]
    ds_read_b64_tr_b16 v[148:149], v189 offset:32768
    ds_read_b64_tr_b16 v[150:151], v189 offset:40960
    v_mfma_f32_16x16x32_bf16 v[20:23], v[132:135], v[204:207], v[20:23]
    s_waitcnt lgkmcnt(6)
    v_mfma_f32_16x16x32_bf16 v[32:35], v[136:139], v[200:203], v[32:35]
    ds_read_b64_tr_b16 v[152:153], v190 offset:32768
    ds_read_b64_tr_b16 v[154:155], v190 offset:40960
    v_mfma_f32_16x16x32_bf16 v[36:39], v[136:139], v[204:207], v[36:39]
    s_waitcnt lgkmcnt(6)
    v_mfma_f32_16x16x32_bf16 v[48:51], v[140:143], v[200:203], v[48:51]
    ds_read_b64_tr_b16 v[156:157], v191 offset:32768
    ds_read_b64_tr_b16 v[158:159], v191 offset:40960
    v_mfma_f32_16x16x32_bf16 v[52:55], v[140:143], v[204:207], v[52:55]
    s_waitcnt lgkmcnt(6)
    v_mfma_f32_16x16x32_bf16 v[64:67], v[144:147], v[200:203], v[64:67]
    v_mfma_f32_16x16x32_bf16 v[68:71], v[144:147], v[204:207], v[68:71]
    s_waitcnt lgkmcnt(4)
    v_mfma_f32_16x16x32_bf16 v[80:83], v[148:151], v[200:203], v[80:83]
    v_mfma_f32_16x16x32_bf16 v[84:87], v[148:151], v[204:207], v[84:87]
    s_waitcnt lgkmcnt(2)
    v_mfma_f32_16x16x32_bf16 v[96:99], v[152:155], v[200:203], v[96:99]
    v_mfma_f32_16x16x32_bf16 v[100:103], v[152:155], v[204:207], v[100:103]
    s_waitcnt lgkmcnt(0)
    v_mfma_f32_16x16x32_bf16 v[112:115], v[156:159], v[200:203], v[112:115]
    v_mfma_f32_16x16x32_bf16 v[116:119], v[156:159], v[204:207], v[116:119]
    s_nop 7
    s_nop 1
    s_add_u32 s20, s6, 0x1400000
    s_addc_u32 s21, s7, 0
    s_mov_b32 s22, 0x1000000
    s_mov_b32 s23, 0x20000
    s_lshl_b32 s47, s28, 3
    s_lshl_b32 s54, s52, 1
    s_add_u32 s47, s47, s54
    s_lshl_b32 s47, s47, 5
    s_lshl_b32 s54, s39, 1
    s_add_u32 s54, s54, s53
    s_add_u32 s47, s47, s54
    s_lshl_b32 s47, s47, 12
    v_cvt_pk_bf16_f32 v128, v0, v1
    v_cvt_pk_bf16_f32 v129, v2, v3
    v_cvt_pk_bf16_f32 v130, v16, v17
    v_cvt_pk_bf16_f32 v131, v18, v19
    buffer_store_dwordx4 v[128:131], v197, s[20:23], s47 offen offset:0 sc1
    v_cvt_pk_bf16_f32 v132, v32, v33
    v_cvt_pk_bf16_f32 v133, v34, v35
    v_cvt_pk_bf16_f32 v134, v48, v49
    v_cvt_pk_bf16_f32 v135, v50, v51
    buffer_store_dwordx4 v[132:135], v197, s[20:23], s47 offen offset:1024 sc1
    v_cvt_pk_bf16_f32 v136, v64, v65
    v_cvt_pk_bf16_f32 v137, v66, v67
    v_cvt_pk_bf16_f32 v138, v80, v81
    v_cvt_pk_bf16_f32 v139, v82, v83
    buffer_store_dwordx4 v[136:139], v197, s[20:23], s47 offen offset:2048 sc1
    v_cvt_pk_bf16_f32 v140, v96, v97
    v_cvt_pk_bf16_f32 v141, v98, v99
    v_cvt_pk_bf16_f32 v142, v112, v113
    v_cvt_pk_bf16_f32 v143, v114, v115
    buffer_store_dwordx4 v[140:143], v197, s[20:23], s47 offen offset:3072 sc1
    s_add_u32 s47, s47, 131072
    v_cvt_pk_bf16_f32 v128, v4, v5
    v_cvt_pk_bf16_f32 v129, v6, v7
    v_cvt_pk_bf16_f32 v130, v20, v21
    v_cvt_pk_bf16_f32 v131, v22, v23
    buffer_store_dwordx4 v[128:131], v197, s[20:23], s47 offen offset:0 sc1
    v_cvt_pk_bf16_f32 v132, v36, v37
    v_cvt_pk_bf16_f32 v133, v38, v39
    v_cvt_pk_bf16_f32 v134, v52, v53
    v_cvt_pk_bf16_f32 v135, v54, v55
    buffer_store_dwordx4 v[132:135], v197, s[20:23], s47 offen offset:1024 sc1
    v_cvt_pk_bf16_f32 v136, v68, v69
    v_cvt_pk_bf16_f32 v137, v70, v71
    v_cvt_pk_bf16_f32 v138, v84, v85
    v_cvt_pk_bf16_f32 v139, v86, v87
    buffer_store_dwordx4 v[136:139], v197, s[20:23], s47 offen offset:2048 sc1
    v_cvt_pk_bf16_f32 v140, v100, v101
    v_cvt_pk_bf16_f32 v141, v102, v103
    v_cvt_pk_bf16_f32 v142, v116, v117
    v_cvt_pk_bf16_f32 v143, v118, v119
    buffer_store_dwordx4 v[140:143], v197, s[20:23], s47 offen offset:3072 sc1
    s_branch W_next
W_t23:
    s_mov_b32 s84, 1
    s_lshl_b32 s35, s33, 11
    s_add_u32 s35, s35, 16384
    s_mul_i32 s47, s33, 40960
    v_add_u32 v196, s47, v197
    s_lshl_b32 s47, s52, 12
    s_add_u32 s47, s47, 16384
    v_add_u32 v192, s47, v197
    v_add_u32 v193, 0x10000, v192
    s_cmp_eq_u32 s72, 5
    s_cbranch_scc1 W_t3
    s_lshr_b32 s28, s71, 1
    s_lshl_b32 s29, s70, 1
    s_and_b32 s3, s71, 1
    s_add_u32 s29, s29, s3
    s_lshl_b32 s73, s70, 3
    s_add_u32 s73, s73, s28
    s_add_u32 s73, s73, 128
    s_branch W_go
W_t3:
    s_lshl_b32 s3, s70, 4
    s_add_u32 s58, s3, s71
    s_cmp_ge_u32 s58, 56
    s_cbranch_scc1 W_side
    s_and_b32 s28, s58, 7
    s_lshr_b32 s29, s58, 3
    s_add_u32 s29, s29, 48
    s_add_u32 s73, s28, 192
W_go:
    s_lshr_b32 s38, s29, 4
    s_cmp_eq_u32 s38, 0
    s_cselect_b32 s12, s40, s42
    s_cselect_b32 s13, s41, s43
    s_cmp_eq_u32 s38, 2
    s_cselect_b32 s12, s80, s12
    s_cselect_b32 s13, s81, s13
    s_cmp_eq_u32 s38, 3
    s_cselect_b32 s12, s48, s12
    s_cselect_b32 s13, s49, s13
    s_mov_b32 s30, 8192
    s_cmov_b32 s30, 3456
    s_mov_b32 s14, 5242880
    s_cmov_b32 s14, 2211840
    s_mov_b32 s15, 0x20000
    s_and_b32 s39, s29, 15
    s_lshl_b32 s46, s39, 9
    s_lshl_b32 s37, s30, 5
    s_mov_b32 s31, 0
    s_mul_i32 s32, s28, 16*20*1024
    s_add_u32 s36, s32, 20480
    v_mul_lo_u32 v194, v198, s30
    v_add_u32 v194, v194, v252
    v_add_u32 v194, s46, v194
    v_mul_lo_u32 v195, v199, s30
    v_add_u32 v195, v195, v253
    v_add_u32 v195, s46, v195
    s_add_u32 m0, s34, 0
    s_nop 0
    buffer_load_dwordx4 v194, s[12:15], s31 offen lds
    s_add_u32 m0, s34, 1024
    s_nop 0
    buffer_load_dwordx4 v195, s[12:15], s31 offen lds
    s_add_u32 s31, s31, s37
    s_add_u32 m0, s35, 0
    s_nop 0
    buffer_load_dwordx4 v196, s[16:19], s32 offen lds
    s_add_u32 s32, s32, 1024
    s_add_u32 m0, s35, 1024
    s_nop 0
    buffer_load_dwordx4 v196, s[16:19], s36 offen lds
    s_add_u32 s36, s36, 1024
    s_add_u32 m0, s34, 32768
    s_nop 0
    buffer_load_dwordx4 v194, s[12:15], s31 offen lds
    s_add_u32 m0, s34, 33792
    s_nop 0
    buffer_load_dwordx4 v195, s[12:15], s31 offen lds
    s_add_u32 s31, s31, s37
    s_add_u32 m0, s35, 32768
    s_nop 0
    buffer_load_dwordx4 v196, s[16:19], s32 offen lds
    s_add_u32 s32, s32, 1024
    s_add_u32 m0, s35, 33792
    s_nop 0
    buffer_load_dwordx4 v196, s[16:19], s36 offen lds
    s_add_u32 s36, s36, 1024
    s_add_u32 m0, s34, 65536
    s_nop 0
    buffer_load_dwordx4 v194, s[12:15], s31 offen lds
    s_add_u32 m0, s34, 66560
    s_nop 0
    buffer_load_dwordx4 v195, s[12:15], s31 offen lds
    s_add_u32 s31, s31, s37
    s_add_u32 m0, s35, 65536
    s_nop 0
    buffer_load_dwordx4 v196, s[16:19], s32 offen lds
    s_add_u32 s32, s32, 1024
    s_add_u32 m0, s35, 66560
    s_nop 0
    buffer_load_dwordx4 v196, s[16:19], s36 offen lds
    s_add_u32 s36, s36, 1024
    s_waitcnt vmcnt(8)
    s_barrier
    ds_read_b128 v[160:163], v192 offset:0
    ds_read_b64_tr_b16 v[128:129], v176 offset:0
    ds_read_b64_tr_b16 v[130:131], v176 offset:8192
    ds_read_b128 v[164:167], v192 offset:1024
    ds_read_b128 v[168:171], v192 offset:2048
    ds_read_b128 v[172:175], v192 offset:3072
    ds_read_b64_tr_b16 v[132:133], v177 offset:0
    ds_read_b64_tr_b16 v[134:135], v177 offset:8192
    ds_read_b64_tr_b16 v[136:137], v178 offset:0
    ds_read_b64_tr_b16 v[138:139], v178 offset:8192
    ds_read_b64_tr_b16 v[140:141], v179 offset:0
    ds_read_b64_tr_b16 v[142:143], v179 offset:8192
    s_waitcnt lgkmcnt(9)
    v_mfma_f32_16x16x32_bf16 v[0:3], v[128:131], v[160:163], 0
    ds_read_b64_tr_b16 v[144:145], v180 offset:0
    ds_read_b64_tr_b16 v[146:147], v180 offset:8192
    s_waitcnt lgkmcnt(10)
    v_mfma_f32_16x16x32_bf16 v[4:7], v[128:131], v[164:167], 0
    s_waitcnt lgkmcnt(9)
    v_mfma_f32_16x16x32_bf16 v[8:11], v[128:131], v[168:171], 0
    s_waitcnt lgkmcnt(8)
    v_mfma_f32_16x16x32_bf16 v[12:15], v[128:131], v[172:175], 0
    s_waitcnt lgkmcnt(6)
    v_mfma_f32_16x16x32_bf16 v[16:19], v[132:135], v[160:163], 0
    ds_read_b64_tr_b16 v[148:149], v181 offset:0
    ds_read_b64_tr_b16 v[150:151], v181 offset:8192
    v_mfma_f32_16x16x32_bf16 v[20:23], v[132:135], v[164:167], 0
    v_mfma_f32_16x16x32_bf16 v[24:27], v[132:135], v[168:171], 0
    v_mfma_f32_16x16x32_bf16 v[28:31], v[132:135], v[172:175], 0
    s_waitcnt lgkmcnt(6)
    v_mfma_f32_16x16x32_bf16 v[32:35], v[136:139], v[160:163], 0
    ds_read_b64_tr_b16 v[152:153], v182 offset:0
    ds_read_b64_tr_b16 v[154:155], v182 offset:8192
    v_mfma_f32_16x16x32_bf16 v[36:39], v[136:139], v[164:167], 0
    v_mfma_f32_16x16x32_bf16 v[40:43], v[136:139], v[168:171], 0
    v_mfma_f32_16x16x32_bf16 v[44:47], v[136:139], v[172:175], 0
    s_waitcnt lgkmcnt(6)
    v_mfma_f32_16x16x32_bf16 v[48:51], v[140:143], v[160:163], 0
    ds_read_b64_tr_b16 v[156:157], v183 offset:0
    ds_read_b64_tr_b16 v[158:159], v183 offset:8192
    v_mfma_f32_16x16x32_bf16 v[52:55], v[140:143], v[164:167], 0
    v_mfma_f32_16x16x32_bf16 v[56:59], v[140:143], v[168:171], 0
    v_mfma_f32_16x16x32_bf16 v[60:63], v[140:143], v[172:175], 0
    s_waitcnt vmcnt(4)
    s_barrier
    s_waitcnt lgkmcnt(6)
    v_mfma_f32_16x16x32_bf16 v[64:67], v[144:147], v[160:163], 0
    ds_read_b128 v[200:203], v192 offset:32768
    v_mfma_f32_16x16x32_bf16 v[68:71], v[144:147], v[164:167], 0
    ds_read_b64_tr_b16 v[128:129], v176 offset:32768
    ds_read_b64_tr_b16 v[130:131], v176 offset:40960
    v_mfma_f32_16x16x32_bf16 v[72:75], v[144:147], v[168:171], 0
    v_mfma_f32_16x16x32_bf16 v[76:79], v[144:147], v[172:175], 0
    s_add_u32 m0, s34, 98304
    s_nop 0
    buffer_load_dwordx4 v194, s[12:15], s31 offen lds
    s_waitcnt lgkmcnt(7)
    v_mfma_f32_16x16x32_bf16 v[80:83], v[148:151], v[160:163], 0
    ds_read_b128 v[204:207], v192 offset:33792
    v_mfma_f32_16x16x32_bf16 v[84:87], v[148:151], v[164:167], 0
    ds_read_b64_tr_b16 v[132:133], v177 offset:32768
    ds_read_b64_tr_b16 v[134:135], v177 offset:40960
    v_mfma_f32_16x16x32_bf16 v[88:91], v[148:151], v[168:171], 0
    v_mfma_f32_16x16x32_bf16 v[92:95], v[148:151], v[172:175], 0
    s_add_u32 m0, s34, 99328
    s_nop 0
    buffer_load_dwordx4 v195, s[12:15], s31 offen lds
    s_add_u32 s31, s31, s37
    s_waitcnt lgkmcnt(8)
    v_mfma_f32_16x16x32_bf16 v[96:99], v[152:155], v[160:163], 0
    ds_read_b128 v[208:211], v192 offset:34816
    v_mfma_f32_16x16x32_bf16 v[100:103], v[152:155], v[164:167], 0
    ds_read_b64_tr_b16 v[136:137], v178 offset:32768
    ds_read_b64_tr_b16 v[138:139], v178 offset:40960
    v_mfma_f32_16x16x32_bf16 v[104:107], v[152:155], v[168:171], 0
    v_mfma_f32_16x16x32_bf16 v[108:111], v[152:155], v[172:175], 0
    s_add_u32 m0, s35, 98304
    s_nop 0
    buffer_load_dwordx4 v196, s[16:19], s32 offen lds
    s_add_u32 s32, s32, 1024
    s_waitcnt lgkmcnt(9)
    v_mfma_f32_16x16x32_bf16 v[112:115], v[156:159], v[160:163], 0
    ds_read_b128 v[212:215], v192 offset:35840
    v_mfma_f32_16x16x32_bf16 v[116:119], v[156:159], v[164:167], 0
    ds_read_b64_tr_b16 v[140:141], v179 offset:32768
    ds_read_b64_tr_b16 v[142:143], v179 offset:40960
    v_mfma_f32_16x16x32_bf16 v[120:123], v[156:159], v[168:171], 0
    v_mfma_f32_16x16x32_bf16 v[124:127], v[156:159], v[172:175], 0
    s_add_u32 m0, s35, 99328
    s_nop 0
    buffer_load_dwordx4 v196, s[16:19], s36 offen lds
    s_add_u32 s36, s36, 1024
    s_waitcnt lgkmcnt(9)
    v_mfma_f32_16x16x32_bf16 v[0:3], v[128:131], v[200:203], v[0:3]
    ds_read_b64_tr_b16 v[144:145], v180 offset:32768
    ds_read_b64_tr_b16 v[146:147], v180 offset:40960
    s_waitcnt lgkmcnt(10)
    v_mfma_f32_16x16x32_bf16 v[4:7], v[128:131], v[204:207], v[4:7]
    s_waitcnt lgkmcnt(7)
    v_mfma_f32_16x16x32_bf16 v[8:11], v[128:131], v[208:211], v[8:11]
    s_waitcnt lgkmcnt(4)
    v_mfma_f32_16x16x32_bf16 v[12:15], v[128:131], v[212:215], v[12:15]
    v_mfma_f32_16x16x32_bf16 v[16:19], v[132:135], v[200:203], v[16:19]
    ds_read_b64_tr_b16 v[148:149], v181 offset:32768
    ds_read_b64_tr_b16 v[150:151], v181 offset:40960
    v_mfma_f32_16x16x32_bf16 v[20:23], v[132:135], v[204:207], v[20:23]
    v_mfma_f32_16x16x32_bf16 v[24:27], v[132:135], v[208:211], v[24:27]
    v_mfma_f32_16x16x32_bf16 v[28:31], v[132:135], v[212:215], v[28:31]
    v_mfma_f32_16x16x32_bf16 v[32:35], v[136:139], v[200:203], v[32:35]
    ds_read_b64_tr_b16 v[152:153], v182 offset:32768
    ds_read_b64_tr_b16 v[154:155], v182 offset:40960
    v_mfma_f32_16x16x32_bf16 v[36:39], v[136:139], v[204:207], v[36:39]
    v_mfma_f32_16x16x32_bf16 v[40:43], v[136:139], v[208:211], v[40:43]
    v_mfma_f32_16x16x32_bf16 v[44:47], v[136:139], v[212:215], v[44:47]
    s_waitcnt lgkmcnt(6)
    v_mfma_f32_16x16x32_bf16 v[48:51], v[140:143], v[200:203], v[48:51]
    ds_read_b64_tr_b16 v[156:157], v183 offset:32768
    ds_read_b64_tr_b16 v[158:159], v183 offset:40960
    v_mfma_f32_16x16x32_bf16 v[52:55], v[140:143], v[204:207], v[52:55]
    v_mfma_f32_16x16x32_bf16 v[56:59], v[140:143], v[208:211], v[56:59]
    v_mfma_f32_16x16x32_bf16 v[60:63], v[140:143], v[212:215], v[60:63]
    s_waitcnt vmcnt(4)
    s_barrier
    s_waitcnt lgkmcnt(6)
    v_mfma_f32_16x16x32_bf16 v[64:67], v[144:147], v[200:203], v[64:67]
    ds_read_b128 v[160:163], v193 offset:0
    v_mfma_f32_16x16x32_bf16 v[68:71], v[144:147], v[204:207], v[68:71]
    ds_read_b64_tr_b16 v[128:129], v184 offset:0
    ds_read_b64_tr_b16 v[130:131], v184 offset:8192
    v_mfma_f32_16x16x32_bf16 v[72:75], v[144:147], v[208:211], v[72:75]
    v_mfma_f32_16x16x32_bf16 v[76:79], v[144:147], v[212:215], v[76:79]
    s_add_u32 m0, s34, 0
    s_nop 0
    buffer_load_dwordx4 v194, s[12:15], s31 offen lds
    s_waitcnt lgkmcnt(7)
    v_mfma_f32_16x16x32_bf16 v[80:83], v[148:151], v[200:203], v[80:83]
    ds_read_b128 v[164:167], v193 offset:1024
    v_mfma_f32_16x16x32_bf16 v[84:87], v[148:151], v[204:207], v[84:87]
    ds_read_b64_tr_b16 v[132:133], v185 offset:0
    ds_read_b64_tr_b16 v[134:135], v185 offset:8192
    v_mfma_f32_16x16x32_bf16 v[88:91], v[148:151], v[208:211], v[88:91]
    v_mfma_f32_16x16x32_bf16 v[92:95], v[148:151], v[212:215], v[92:95]
    s_add_u32 m0, s34, 1024
    s_nop 0
    buffer_load_dwordx4 v195, s[12:15], s31 offen lds
    s_add_u32 s31, s31, s37
    s_waitcnt lgkmcnt(8)
    v_mfma_f32_16x16x32_bf16 v[96:99], v[152:155], v[200:203], v[96:99]
    ds_read_b128 v[168:171], v193 offset:2048
    v_mfma_f32_16x16x32_bf16 v[100:103], v[152:155], v[204:207], v[100:103]
    ds_read_b64_tr_b16 v[136:137], v186 offset:0
    ds_read_b64_tr_b16 v[138:139], v186 offset:8192
    v_mfma_f32_16x16x32_bf16 v[104:107], v[152:155], v[208:211], v[104:107]
    v_mfma_f32_16x16x32_bf16 v[108:111], v[152:155], v[212:215], v[108:111]
    s_add_u32 m0, s35, 0
    s_nop 0
    buffer_load_dwordx4 v196, s[16:19], s32 offen lds
    s_add_u32 s32, s32, 1024
    s_waitcnt lgkmcnt(9)
    v_mfma_f32_16x16x32_bf16 v[112:115], v[156:159], v[200:203], v[112:115]
    ds_read_b128 v[172:175], v193 offset:3072
    v_mfma_f32_16x16x32_bf16 v[116:119], v[156:159], v[204:207], v[116:119]
    ds_read_b64_tr_b16 v[140:141], v187 offset:0
    ds_read_b64_tr_b16 v[142:143], v187 offset:8192
    v_mfma_f32_16x16x32_bf16 v[120:123], v[156:159], v[208:211], v[120:123]
    v_mfma_f32_16x16x32_bf16 v[124:127], v[156:159], v[212:215], v[124:127]
    s_add_u32 m0, s35, 1024
    s_nop 0
    buffer_load_dwordx4 v196, s[16:19], s36 offen lds
    s_add_u32 s36, s36, 1024
    s_waitcnt lgkmcnt(9)
    v_mfma_f32_16x16x32_bf16 v[0:3], v[128:131], v[160:163], v[0:3]
    ds_read_b64_tr_b16 v[144:145], v188 offset:0
    ds_read_b64_tr_b16 v[146:147], v188 offset:8192
    s_waitcnt lgkmcnt(10)
    v_mfma_f32_16x16x32_bf16 v[4:7], v[128:131], v[164:167], v[4:7]
    s_waitcnt lgkmcnt(7)
    v_mfma_f32_16x16x32_bf16 v[8:11], v[128:131], v[168:171], v[8:11]
    s_waitcnt lgkmcnt(4)
    v_mfma_f32_16x16x32_bf16 v[12:15], v[128:131], v[172:175], v[12:15]
    v_mfma_f32_16x16x32_bf16 v[16:19], v[132:135], v[160:163], v[16:19]
    ds_read_b64_tr_b16 v[148:149], v189 offset:0
    ds_read_b64_tr_b16 v[150:151], v189 offset:8192
    v_mfma_f32_16x16x32_bf16 v[20:23], v[132:135], v[164:167], v[20:23]
    v_mfma_f32_16x16x32_bf16 v[24:27], v[132:135], v[168:171], v[24:27]
    v_mfma_f32_16x16x32_bf16 v[28:31], v[132:135], v[172:175], v[28:31]
    v_mfma_f32_16x16x32_bf16 v[32:35], v[136:139], v[160:163], v[32:35]
    ds_read_b64_tr_b16 v[152:153], v190 offset:0
    ds_read_b64_tr_b16 v[154:155], v190 offset:8192
    v_mfma_f32_16x16x32_bf16 v[36:39], v[136:139], v[164:167], v[36:39]
    v_mfma_f32_16x16x32_bf16 v[40:43], v[136:139], v[168:171], v[40:43]
    v_mfma_f32_16x16x32_bf16 v[44:47], v[136:139], v[172:175], v[44:47]
    s_waitcnt lgkmcnt(6)
    v_mfma_f32_16x16x32_bf16 v[48:51], v[140:143], v[160:163], v[48:51]
    ds_read_b64_tr_b16 v[156:157], v191 offset:0
    ds_read_b64_tr_b16 v[158:159], v191 offset:8192
    v_mfma_f32_16x16x32_bf16 v[52:55], v[140:143], v[164:167], v[52:55]
    v_mfma_f32_16x16x32_bf16 v[56:59], v[140:143], v[168:171], v[56:59]
    v_mfma_f32_16x16x32_bf16 v[60:63], v[140:143], v[172:175], v[60:63]
    s_waitcnt vmcnt(4)
    s_barrier
    s_waitcnt lgkmcnt(6)
    v_mfma_f32_16x16x32_bf16 v[64:67], v[144:147], v[160:163], v[64:67]
    ds_read_b128 v[200:203], v193 offset:32768
    v_mfma_f32_16x16x32_bf16 v[68:71], v[144:147], v[164:167], v[68:71]
    ds_read_b64_tr_b16 v[128:129], v184 offset:32768
    ds_read_b64_tr_b16 v[130:131], v184 offset:40960
    v_mfma_f32_16x16x32_bf16 v[72:75], v[144:147], v[168:171], v[72:75]
    v_mfma_f32_16x16x32_bf16 v[76:79], v[144:147], v[172:175], v[76:79]
    s_add_u32 m0, s34, 32768
    s_nop 0
    buffer_load_dwordx4 v194, s[12:15], s31 offen lds
    s_waitcnt lgkmcnt(7)
    v_mfma_f32_16x16x32_bf16 v[80:83], v[148:151], v[160:163], v[80:83]
    ds_read_b128 v[204:207], v193 offset:33792
    v_mfma_f32_16x16x32_bf16 v[84:87], v[148:151], v[164:167], v[84:87]
    ds_read_b64_tr_b16 v[132:133], v185 offset:32768
    ds_read_b64_tr_b16 v[134:135], v185 offset:40960
    v_mfma_f32_16x16x32_bf16 v[88:91], v[148:151], v[168:171], v[88:91]
    v_mfma_f32_16x16x32_bf16 v[92:95], v[148:151], v[172:175], v[92:95]
    s_add_u32 m0, s34, 33792
    s_nop 0
    buffer_load_dwordx4 v195, s[12:15], s31 offen lds
    s_add_u32 s31, s31, s37
    s_waitcnt lgkmcnt(8)
    v_mfma_f32_16x16x32_bf16 v[96:99], v[152:155], v[160:163], v[96:99]
    ds_read_b128 v[208:211], v193 offset:34816
    v_mfma_f32_16x16x32_bf16 v[100:103], v[152:155], v[164:167], v[100:103]
    ds_read_b64_tr_b16 v[136:137], v186 offset:32768
    ds_read_b64_tr_b16 v[138:139], v186 offset:40960
    v_mfma_f32_16x16x32_bf16 v[104:107], v[152:155], v[168:171], v[104:107]
    v_mfma_f32_16x16x32_bf16 v[108:111], v[152:155], v[172:175], v[108:111]
    s_add_u32 m0, s35, 32768
    s_nop 0
    buffer_load_dwordx4 v196, s[16:19], s32 offen lds
    s_add_u32 s32, s32, 1024
    s_waitcnt lgkmcnt(9)
    v_mfma_f32_16x16x32_bf16 v[112:115], v[156:159], v[160:163], v[112:115]
    ds_read_b128 v[212:215], v193 offset:35840
    v_mfma_f32_16x16x32_bf16 v[116:119], v[156:159], v[164:167], v[116:119]
    ds_read_b64_tr_b16 v[140:141], v187 offset:32768
    ds_read_b64_tr_b16 v[142:143], v187 offset:40960
    v_mfma_f32_16x16x32_bf16 v[120:123], v[156:159], v[168:171], v[120:123]
    v_mfma_f32_16x16x32_bf16 v[124:127], v[156:159], v[172:175], v[124:127]
    s_add_u32 m0, s35, 33792
    s_nop 0
    buffer_load_dwordx4 v196, s[16:19], s36 offen lds
    s_add_u32 s36, s36, 1024
    s_waitcnt lgkmcnt(9)
    v_mfma_f32_16x16x32_bf16 v[0:3], v[128:131], v[200:203], v[0:3]
    ds_read_b64_tr_b16 v[144:145], v188 offset:32768
    ds_read_b64_tr_b16 v[146:147], v188 offset:40960
    s_waitcnt lgkmcnt(10)
    v_mfma_f32_16x16x32_bf16 v[4:7], v[128:131], v[204:207], v[4:7]
    s_waitcnt lgkmcnt(7)
    v_mfma_f32_16x16x32_bf16 v[8:11], v[128:131], v[208:211], v[8:11]
    s_waitcnt lgkmcnt(4)
    v_mfma_f32_16x16x32_bf16 v[12:15], v[128:131], v[212:215], v[12:15]
    v_mfma_f32_16x16x32_bf16 v[16:19], v[132:135], v[200:203], v[16:19]
    ds_read_b64_tr_b16 v[148:149], v189 offset:32768
    ds_read_b64_tr_b16 v[150:151], v189 offset:40960
    v_mfma_f32_16x16x32_bf16 v[20:23], v[132:135], v[204:207], v[20:23]
    v_mfma_f32_16x16x32_bf16 v[24:27], v[132:135], v[208:211], v[24:27]
    v_mfma_f32_16x16x32_bf16 v[28:31], v[132:135], v[212:215], v[28:31]
    v_mfma_f32_16x16x32_bf16 v[32:35], v[136:139], v[200:203], v[32:35]
    ds_read_b64_tr_b16 v[152:153], v190 offset:32768
    ds_read_b64_tr_b16 v[154:155], v190 offset:40960
    v_mfma_f32_16x16x32_bf16 v[36:39], v[136:139], v[204:207], v[36:39]
    v_mfma_f32_16x16x32_bf16 v[40:43], v[136:139], v[208:211], v[40:43]
    v_mfma_f32_16x16x32_bf16 v[44:47], v[136:139], v[212:215], v[44:47]
    s_waitcnt lgkmcnt(6)
    v_mfma_f32_16x16x32_bf16 v[48:51], v[140:143], v[200:203], v[48:51]
    ds_read_b64_tr_b16 v[156:157], v191 offset:32768
    ds_read_b64_tr_b16 v[158:159], v191 offset:40960
    v_mfma_f32_16x16x32_bf16 v[52:55], v[140:143], v[204:207], v[52:55]
    v_mfma_f32_16x16x32_bf16 v[56:59], v[140:143], v[208:211], v[56:59]
    v_mfma_f32_16x16x32_bf16 v[60:63], v[140:143], v[212:215], v[60:63]
    s_waitcnt vmcnt(4)
    s_barrier
    s_waitcnt lgkmcnt(6)
    v_mfma_f32_16x16x32_bf16 v[64:67], v[144:147], v[200:203], v[64:67]
    ds_read_b128 v[160:163], v192 offset:0
    v_mfma_f32_16x16x32_bf16 v[68:71], v[144:147], v[204:207], v[68:71]
    ds_read_b64_tr_b16 v[128:129], v176 offset:0
    ds_read_b64_tr_b16 v[130:131], v176 offset:8192
    v_mfma_f32_16x16x32_bf16 v[72:75], v[144:147], v[208:211], v[72:75]
    v_mfma_f32_16x16x32_bf16 v[76:79], v[144:147], v[212:215], v[76:79]
    s_add_u32 m0, s34, 65536
    s_nop 0
    buffer_load_dwordx4 v194, s[12:15], s31 offen lds
    s_waitcnt lgkmcnt(7)
    v_mfma_f32_16x16x32_bf16 v[80:83], v[148:151], v[200:203], v[80:83]
    ds_read_b128 v[164:167], v192 offset:1024
    v_mfma_f32_16x16x32_bf16 v[84:87], v[148:151], v[204:207], v[84:87]
    ds_read_b64_tr_b16 v[132:133], v177 offset:0
    ds_read_b64_tr_b16 v[134:135], v177 offset:8192
    v_mfma_f32_16x16x32_bf16 v[88:91], v[148:151], v[208:211], v[88:91]
    v_mfma_f32_16x16x32_bf16 v[92:95], v[148:151], v[212:215], v[92:95]
    s_add_u32 m0, s34, 66560
    s_nop 0
    buffer_load_dwordx4 v195, s[12:15], s31 offen lds
    s_add_u32 s31, s31, s37
    s_waitcnt lgkmcnt(8)
    v_mfma_f32_16x16x32_bf16 v[96:99], v[152:155], v[200:203], v[96:99]
    ds_read_b128 v[168:171], v192 offset:2048
    v_mfma_f32_16x16x32_bf16 v[100:103], v[152:155], v[204:207], v[100:103]
    ds_read_b64_tr_b16 v[136:137], v178 offset:0
    ds_read_b64_tr_b16 v[138:139], v178 offset:8192
    v_mfma_f32_16x16x32_bf16 v[104:107], v[152:155], v[208:211], v[104:107]
    v_mfma_f32_16x16x32_bf16 v[108:111], v[152:155], v[212:215], v[108:111]
    s_add_u32 m0, s35, 65536
    s_nop 0
    buffer_load_dwordx4 v196, s[16:19], s32 offen lds
    s_add_u32 s32, s32, 1024
    s_waitcnt lgkmcnt(9)
    v_mfma_f32_16x16x32_bf16 v[112:115], v[156:159], v[200:203], v[112:115]
    ds_read_b128 v[172:175], v192 offset:3072
    v_mfma_f32_16x16x32_bf16 v[116:119], v[156:159], v[204:207], v[116:119]
    ds_read_b64_tr_b16 v[140:141], v179 offset:0
    ds_read_b64_tr_b16 v[142:143], v179 offset:8192
    v_mfma_f32_16x16x32_bf16 v[120:123], v[156:159], v[208:211], v[120:123]
    v_mfma_f32_16x16x32_bf16 v[124:127], v[156:159], v[212:215], v[124:127]
    s_add_u32 m0, s35, 66560
    s_nop 0
    buffer_load_dwordx4 v196, s[16:19], s36 offen lds
    s_add_u32 s36, s36, 1024
    s_waitcnt lgkmcnt(9)
    v_mfma_f32_16x16x32_bf16 v[0:3], v[128:131], v[160:163], v[0:3]
    ds_read_b64_tr_b16 v[144:145], v180 offset:0
    ds_read_b64_tr_b16 v[146:147], v180 offset:8192
    s_waitcnt lgkmcnt(10)
    v_mfma_f32_16x16x32_bf16 v[4:7], v[128:131], v[164:167], v[4:7]
    s_waitcnt lgkmcnt(7)
    v_mfma_f32_16x16x32_bf16 v[8:11], v[128:131], v[168:171], v[8:11]
    s_waitcnt lgkmcnt(4)
    v_mfma_f32_16x16x32_bf16 v[12:15], v[128:131], v[172:175], v[12:15]
    v_mfma_f32_16x16x32_bf16 v[16:19], v[132:135], v[160:163], v[16:19]
    ds_read_b64_tr_b16 v[148:149], v181 offset:0
    ds_read_b64_tr_b16 v[150:151], v181 offset:8192
    v_mfma_f32_16x16x32_bf16 v[20:23], v[132:135], v[164:167], v[20:23]
    v_mfma_f32_16x16x32_bf16 v[24:27], v[132:135], v[168:171], v[24:27]
    v_mfma_f32_16x16x32_bf16 v[28:31], v[132:135], v[172:175], v[28:31]
    v_mfma_f32_16x16x32_bf16 v[32:35], v[136:139], v[160:163], v[32:35]
    ds_read_b64_tr_b16 v[152:153], v182 offset:0
    ds_read_b64_tr_b16 v[154:155], v182 offset:8192
    v_mfma_f32_16x16x32_bf16 v[36:39], v[136:139], v[164:167], v[36:39]
    v_mfma_f32_16x16x32_bf16 v[40:43], v[136:139], v[168:171], v[40:43]
    v_mfma_f32_16x16x32_bf16 v[44:47], v[136:139], v[172:175], v[44:47]
    s_waitcnt lgkmcnt(6)
    v_mfma_f32_16x16x32_bf16 v[48:51], v[140:143], v[160:163], v[48:51]
    ds_read_b64_tr_b16 v[156:157], v183 offset:0
    ds_read_b64_tr_b16 v[158:159], v183 offset:8192
    v_mfma_f32_16x16x32_bf16 v[52:55], v[140:143], v[164:167], v[52:55]
    v_mfma_f32_16x16x32_bf16 v[56:59], v[140:143], v[168:171], v[56:59]
    v_mfma_f32_16x16x32_bf16 v[60:63], v[140:143], v[172:175], v[60:63]
    s_waitcnt vmcnt(4)
    s_barrier
    s_waitcnt lgkmcnt(6)
    v_mfma_f32_16x16x32_bf16 v[64:67], v[144:147], v[160:163], v[64:67]
    ds_read_b128 v[200:203], v192 offset:32768
    v_mfma_f32_16x16x32_bf16 v[68:71], v[144:147], v[164:167], v[68:71]
    ds_read_b64_tr_b16 v[128:129], v176 offset:32768
    ds_read_b64_tr_b16 v[130:131], v176 offset:40960
    v_mfma_f32_16x16x32_bf16 v[72:75], v[144:147], v[168:171], v[72:75]
    v_mfma_f32_16x16x32_bf16 v[76:79], v[144:147], v[172:175], v[76:79]
    s_add_u32 m0, s34, 98304
    s_nop 0
    buffer_load_dwordx4 v194, s[12:15], s31 offen lds
    s_waitcnt lgkmcnt(7)
    v_mfma_f32_16x16x32_bf16 v[80:83], v[148:151], v[160:163], v[80:83]
    ds_read_b128 v[204:207], v192 offset:33792
    v_mfma_f32_16x16x32_bf16 v[84:87], v[148:151], v[164:167], v[84:87]
    ds_read_b64_tr_b16 v[132:133], v177 offset:32768
    ds_read_b64_tr_b16 v[134:135], v177 offset:40960
    v_mfma_f32_16x16x32_bf16 v[88:91], v[148:151], v[168:171], v[88:91]
    v_mfma_f32_16x16x32_bf16 v[92:95], v[148:151], v[172:175], v[92:95]
    s_add_u32 m0, s34, 99328
    s_nop 0
    buffer_load_dwordx4 v195, s[12:15], s31 offen lds
    s_add_u32 s31, s31, s37
    s_waitcnt lgkmcnt(8)
    v_mfma_f32_16x16x32_bf16 v[96:99], v[152:155], v[160:163], v[96:99]
    ds_read_b128 v[208:211], v192 offset:34816
    v_mfma_f32_16x16x32_bf16 v[100:103], v[152:155], v[164:167], v[100:103]
    ds_read_b64_tr_b16 v[136:137], v178 offset:32768
    ds_read_b64_tr_b16 v[138:139], v178 offset:40960
    v_mfma_f32_16x16x32_bf16 v[104:107], v[152:155], v[168:171], v[104:107]
    v_mfma_f32_16x16x32_bf16 v[108:111], v[152:155], v[172:175], v[108:111]
    s_add_u32 m0, s35, 98304
    s_nop 0
    buffer_load_dwordx4 v196, s[16:19], s32 offen lds
    s_add_u32 s32, s32, 1024
    s_waitcnt lgkmcnt(9)
    v_mfma_f32_16x16x32_bf16 v[112:115], v[156:159], v[160:163], v[112:115]
    ds_read_b128 v[212:215], v192 offset:35840
    v_mfma_f32_16x16x32_bf16 v[116:119], v[156:159], v[164:167], v[116:119]
    ds_read_b64_tr_b16 v[140:141], v179 offset:32768
    ds_read_b64_tr_b16 v[142:143], v179 offset:40960
    v_mfma_f32_16x16x32_bf16 v[120:123], v[156:159], v[168:171], v[120:123]
    v_mfma_f32_16x16x32_bf16 v[124:127], v[156:159], v[172:175], v[124:127]
    s_add_u32 m0, s35, 99328
    s_nop 0
    buffer_load_dwordx4 v196, s[16:19], s36 offen lds
    s_add_u32 s36, s36, 1024
    s_waitcnt lgkmcnt(9)
    v_mfma_f32_16x16x32_bf16 v[0:3], v[128:131], v[200:203], v[0:3]
    ds_read_b64_tr_b16 v[144:145], v180 offset:32768
    ds_read_b64_tr_b16 v[146:147], v180 offset:40960
    s_waitcnt lgkmcnt(10)
    v_mfma_f32_16x16x32_bf16 v[4:7], v[128:131], v[204:207], v[4:7]
    s_waitcnt lgkmcnt(7)
    v_mfma_f32_16x16x32_bf16 v[8:11], v[128:131], v[208:211], v[8:11]
    s_waitcnt lgkmcnt(4)
    v_mfma_f32_16x16x32_bf16 v[12:15], v[128:131], v[212:215], v[12:15]
    v_mfma_f32_16x16x32_bf16 v[16:19], v[132:135], v[200:203], v[16:19]
    ds_read_b64_tr_b16 v[148:149], v181 offset:32768
    ds_read_b64_tr_b16 v[150:151], v181 offset:40960
    v_mfma_f32_16x16x32_bf16 v[20:23], v[132:135], v[204:207], v[20:23]
    v_mfma_f32_16x16x32_bf16 v[24:27], v[132:135], v[208:211], v[24:27]
    v_mfma_f32_16x16x32_bf16 v[28:31], v[132:135], v[212:215], v[28:31]
    v_mfma_f32_16x16x32_bf16 v[32:35], v[136:139], v[200:203], v[32:35]
    ds_read_b64_tr_b16 v[152:153], v182 offset:32768
    ds_read_b64_tr_b16 v[154:155], v182 offset:40960
    v_mfma_f32_16x16x32_bf16 v[36:39], v[136:139], v[204:207], v[36:39]
    v_mfma_f32_16x16x32_bf16 v[40:43], v[136:139], v[208:211], v[40:43]
    v_mfma_f32_16x16x32_bf16 v[44:47], v[136:139], v[212:215], v[44:47]
    s_waitcnt lgkmcnt(6)
    v_mfma_f32_16x16x32_bf16 v[48:51], v[140:143], v[200:203], v[48:51]
    ds_read_b64_tr_b16 v[156:157], v183 offset:32768
    ds_read_b64_tr_b16 v[158:159], v183 offset:40960
    v_mfma_f32_16x16x32_bf16 v[52:55], v[140:143], v[204:207], v[52:55]
    v_mfma_f32_16x16x32_bf16 v[56:59], v[140:143], v[208:211], v[56:59]
    v_mfma_f32_16x16x32_bf16 v[60:63], v[140:143], v[212:215], v[60:63]
    s_waitcnt vmcnt(4)
    s_barrier
    s_waitcnt lgkmcnt(6)
    v_mfma_f32_16x16x32_bf16 v[64:67], v[144:147], v[200:203], v[64:67]
    ds_read_b128 v[160:163], v193 offset:0
    v_mfma_f32_16x16x32_bf16 v[68:71], v[144:147], v[204:207], v[68:71]
    ds_read_b64_tr_b16 v[128:129], v184 offset:0
    ds_read_b64_tr_b16 v[130:131], v184 offset:8192
    v_mfma_f32_16x16x32_bf16 v[72:75], v[144:147], v[208:211], v[72:75]
    v_mfma_f32_16x16x32_bf16 v[76:79], v[144:147], v[212:215], v[76:79]
    s_add_u32 m0, s34, 0
    s_nop 0
    buffer_load_dwordx4 v194, s[12:15], s31 offen lds
    s_waitcnt lgkmcnt(7)
    v_mfma_f32_16x16x32_bf16 v[80:83], v[148:151], v[200:203], v[80:83]
    ds_read_b128 v[164:167], v193 offset:1024
    v_mfma_f32_16x16x32_bf16 v[84:87], v[148:151], v[204:207], v[84:87]
    ds_read_b64_tr_b16 v[132:133], v185 offset:0
    ds_read_b64_tr_b16 v[134:135], v185 offset:8192
    v_mfma_f32_16x16x32_bf16 v[88:91], v[148:151], v[208:211], v[88:91]
    v_mfma_f32_16x16x32_bf16 v[92:95], v[148:151], v[212:215], v[92:95]
    s_add_u32 m0, s34, 1024
    s_nop 0
    buffer_load_dwordx4 v195, s[12:15], s31 offen lds
    s_add_u32 s31, s31, s37
    s_waitcnt lgkmcnt(8)
    v_mfma_f32_16x16x32_bf16 v[96:99], v[152:155], v[200:203], v[96:99]
    ds_read_b128 v[168:171], v193 offset:2048
    v_mfma_f32_16x16x32_bf16 v[100:103], v[152:155], v[204:207], v[100:103]
    ds_read_b64_tr_b16 v[136:137], v186 offset:0
    ds_read_b64_tr_b16 v[138:139], v186 offset:8192
    v_mfma_f32_16x16x32_bf16 v[104:107], v[152:155], v[208:211], v[104:107]
    v_mfma_f32_16x16x32_bf16 v[108:111], v[152:155], v[212:215], v[108:111]
    s_add_u32 m0, s35, 0
    s_nop 0
    buffer_load_dwordx4 v196, s[16:19], s32 offen lds
    s_add_u32 s32, s32, 1024
    s_waitcnt lgkmcnt(9)
    v_mfma_f32_16x16x32_bf16 v[112:115], v[156:159], v[200:203], v[112:115]
    ds_read_b128 v[172:175], v193 offset:3072
    v_mfma_f32_16x16x32_bf16 v[116:119], v[156:159], v[204:207], v[116:119]
    ds_read_b64_tr_b16 v[140:141], v187 offset:0
    ds_read_b64_tr_b16 v[142:143], v187 offset:8192
    v_mfma_f32_16x16x32_bf16 v[120:123], v[156:159], v[208:211], v[120:123]
    v_mfma_f32_16x16x32_bf16 v[124:127], v[156:159], v[212:215], v[124:127]
    s_add_u32 m0, s35, 1024
    s_nop 0
    buffer_load_dwordx4 v196, s[16:19], s36 offen lds
    s_add_u32 s36, s36, 1024
    s_waitcnt lgkmcnt(9)
    v_mfma_f32_16x16x32_bf16 v[0:3], v[128:131], v[160:163], v[0:3]
    ds_read_b64_tr_b16 v[144:145], v188 offset:0
    ds_read_b64_tr_b16 v[146:147], v188 offset:8192
    s_waitcnt lgkmcnt(10)
    v_mfma_f32_16x16x32_bf16 v[4:7], v[128:131], v[164:167], v[4:7]
    s_waitcnt lgkmcnt(7)
    v_mfma_f32_16x16x32_bf16 v[8:11], v[128:131], v[168:171], v[8:11]
    s_waitcnt lgkmcnt(4)
    v_mfma_f32_16x16x32_bf16 v[12:15], v[128:131], v[172:175], v[12:15]
    v_mfma_f32_16x16x32_bf16 v[16:19], v[132:135], v[160:163], v[16:19]
    ds_read_b64_tr_b16 v[148:149], v189 offset:0
    ds_read_b64_tr_b16 v[150:151], v189 offset:8192
    v_mfma_f32_16x16x32_bf16 v[20:23], v[132:135], v[164:167], v[20:23]
    v_mfma_f32_16x16x32_bf16 v[24:27], v[132:135], v[168:171], v[24:27]
    v_mfma_f32_16x16x32_bf16 v[28:31], v[132:135], v[172:175], v[28:31]
    v_mfma_f32_16x16x32_bf16 v[32:35], v[136:139], v[160:163], v[32:35]
    ds_read_b64_tr_b16 v[152:153], v190 offset:0
    ds_read_b64_tr_b16 v[154:155], v190 offset:8192
    v_mfma_f32_16x16x32_bf16 v[36:39], v[136:139], v[164:167], v[36:39]
    v_mfma_f32_16x16x32_bf16 v[40:43], v[136:139], v[168:171], v[40:43]
    v_mfma_f32_16x16x32_bf16 v[44:47], v[136:139], v[172:175], v[44:47]
    s_waitcnt lgkmcnt(6)
    v_mfma_f32_16x16x32_bf16 v[48:51], v[140:143], v[160:163], v[48:51]
    ds_read_b64_tr_b16 v[156:157], v191 offset:0
    ds_read_b64_tr_b16 v[158:159], v191 offset:8192
    v_mfma_f32_16x16x32_bf16 v[52:55], v[140:143], v[164:167], v[52:55]
    v_mfma_f32_16x16x32_bf16 v[56:59], v[140:143], v[168:171], v[56:59]
    v_mfma_f32_16x16x32_bf16 v[60:63], v[140:143], v[172:175], v[60:63]
    s_waitcnt vmcnt(4)
    s_barrier
    s_waitcnt lgkmcnt(6)
    v_mfma_f32_16x16x32_bf16 v[64:67], v[144:147], v[160:163], v[64:67]
    ds_read_b128 v[200:203], v193 offset:32768
    v_mfma_f32_16x16x32_bf16 v[68:71], v[144:147], v[164:167], v[68:71]
    ds_read_b64_tr_b16 v[128:129], v184 offset:32768
    ds_read_b64_tr_b16 v[130:131], v184 offset:40960
    v_mfma_f32_16x16x32_bf16 v[72:75], v[144:147], v[168:171], v[72:75]
    v_mfma_f32_16x16x32_bf16 v[76:79], v[144:147], v[172:175], v[76:79]
    s_add_u32 m0, s34, 32768
    s_nop 0
    buffer_load_dwordx4 v194, s[12:15], s31 offen lds
    s_waitcnt lgkmcnt(7)
    v_mfma_f32_16x16x32_bf16 v[80:83], v[148:151], v[160:163], v[80:83]
    ds_read_b128 v[204:207], v193 offset:33792
    v_mfma_f32_16x16x32_bf16 v[84:87], v[148:151], v[164:167], v[84:87]
    ds_read_b64_tr_b16 v[132:133], v185 offset:32768
    ds_read_b64_tr_b16 v[134:135], v185 offset:40960
    v_mfma_f32_16x16x32_bf16 v[88:91], v[148:151], v[168:171], v[88:91]
    v_mfma_f32_16x16x32_bf16 v[92:95], v[148:151], v[172:175], v[92:95]
    s_add_u32 m0, s34, 33792
    s_nop 0
    buffer_load_dwordx4 v195, s[12:15], s31 offen lds
    s_add_u32 s31, s31, s37
    s_waitcnt lgkmcnt(8)
    v_mfma_f32_16x16x32_bf16 v[96:99], v[152:155], v[160:163], v[96:99]
    ds_read_b128 v[208:211], v193 offset:34816
    v_mfma_f32_16x16x32_bf16 v[100:103], v[152:155], v[164:167], v[100:103]
    ds_read_b64_tr_b16 v[136:137], v186 offset:32768
    ds_read_b64_tr_b16 v[138:139], v186 offset:40960
    v_mfma_f32_16x16x32_bf16 v[104:107], v[152:155], v[168:171], v[104:107]
    v_mfma_f32_16x16x32_bf16 v[108:111], v[152:155], v[172:175], v[108:111]
    s_add_u32 m0, s35, 32768
    s_nop 0
    buffer_load_dwordx4 v196, s[16:19], s32 offen lds
    s_add_u32 s32, s32, 1024
    s_waitcnt lgkmcnt(9)
    v_mfma_f32_16x16x32_bf16 v[112:115], v[156:159], v[160:163], v[112:115]
    ds_read_b128 v[212:215], v193 offset:35840
    v_mfma_f32_16x16x32_bf16 v[116:119], v[156:159], v[164:167], v[116:119]
    ds_read_b64_tr_b16 v[140:141], v187 offset:32768
    ds_read_b64_tr_b16 v[142:143], v187 offset:40960
    v_mfma_f32_16x16x32_bf16 v[120:123], v[156:159], v[168:171], v[120:123]
    v_mfma_f32_16x16x32_bf16 v[124:127], v[156:159], v[172:175], v[124:127]
    s_add_u32 m0, s35, 33792
    s_nop 0
    buffer_load_dwordx4 v196, s[16:19], s36 offen lds
    s_add_u32 s36, s36, 1024
    s_waitcnt lgkmcnt(9)
    v_mfma_f32_16x16x32_bf16 v[0:3], v[128:131], v[200:203], v[0:3]
    ds_read_b64_tr_b16 v[144:145], v188 offset:32768
    ds_read_b64_tr_b16 v[146:147], v188 offset:40960
    s_waitcnt lgkmcnt(10)
    v_mfma_f32_16x16x32_bf16 v[4:7], v[128:131], v[204:207], v[4:7]
    s_waitcnt lgkmcnt(7)
    v_mfma_f32_16x16x32_bf16 v[8:11], v[128:131], v[208:211], v[8:11]
    s_waitcnt lgkmcnt(4)
    v_mfma_f32_16x16x32_bf16 v[12:15], v[128:131], v[212:215], v[12:15]
    v_mfma_f32_16x16x32_bf16 v[16:19], v[132:135], v[200:203], v[16:19]
    ds_read_b64_tr_b16 v[148:149], v189 offset:32768
    ds_read_b64_tr_b16 v[150:151], v189 offset:40960
    v_mfma_f32_16x16x32_bf16 v[20:23], v[132:135], v[204:207], v[20:23]
    v_mfma_f32_16x16x32_bf16 v[24:27], v[132:135], v[208:211], v[24:27]
    v_mfma_f32_16x16x32_bf16 v[28:31], v[132:135], v[212:215], v[28:31]
    v_mfma_f32_16x16x32_bf16 v[32:35], v[136:139], v[200:203], v[32:35]
    ds_read_b64_tr_b16 v[152:153], v190 offset:32768
    ds_read_b64_tr_b16 v[154:155], v190 offset:40960
    v_mfma_f32_16x16x32_bf16 v[36:39], v[136:139], v[204:207], v[36:39]
    v_mfma_f32_16x16x32_bf16 v[40:43], v[136:139], v[208:211], v[40:43]
    v_mfma_f32_16x16x32_bf16 v[44:47], v[136:139], v[212:215], v[44:47]
    s_waitcnt lgkmcnt(6)
    v_mfma_f32_16x16x32_bf16 v[48:51], v[140:143], v[200:203], v[48:51]
    ds_read_b64_tr_b16 v[156:157], v191 offset:32768
    ds_read_b64_tr_b16 v[158:159], v191 offset:40960
    v_mfma_f32_16x16x32_bf16 v[52:55], v[140:143], v[204:207], v[52:55]
    v_mfma_f32_16x16x32_bf16 v[56:59], v[140:143], v[208:211], v[56:59]
    v_mfma_f32_16x16x32_bf16 v[60:63], v[140:143], v[212:215], v[60:63]
    s_waitcnt vmcnt(4)
    s_barrier
    s_waitcnt lgkmcnt(6)
    v_mfma_f32_16x16x32_bf16 v[64:67], v[144:147], v[200:203], v[64:67]
    ds_read_b128 v[160:163], v192 offset:0
    v_mfma_f32_16x16x32_bf16 v[68:71], v[144:147], v[204:207], v[68:71]
    ds_read_b64_tr_b16 v[128:129], v176 offset:0
    ds_read_b64_tr_b16 v[130:131], v176 offset:8192
    v_mfma_f32_16x16x32_bf16 v[72:75], v[144:147], v[208:211], v[72:75]
    v_mfma_f32_16x16x32_bf16 v[76:79], v[144:147], v[212:215], v[76:79]
    s_add_u32 m0, s34, 65536
    s_nop 0
    buffer_load_dwordx4 v194, s[12:15], s31 offen lds
    s_waitcnt lgkmcnt(7)
    v_mfma_f32_16x16x32_bf16 v[80:83], v[148:151], v[200:203], v[80:83]
    ds_read_b128 v[164:167], v192 offset:1024
    v_mfma_f32_16x16x32_bf16 v[84:87], v[148:151], v[204:207], v[84:87]
    ds_read_b64_tr_b16 v[132:133], v177 offset:0
    ds_read_b64_tr_b16 v[134:135], v177 offset:8192
    v_mfma_f32_16x16x32_bf16 v[88:91], v[148:151], v[208:211], v[88:91]
    v_mfma_f32_16x16x32_bf16 v[92:95], v[148:151], v[212:215], v[92:95]
    s_add_u32 m0, s34, 66560
    s_nop 0
    buffer_load_dwordx4 v195, s[12:15], s31 offen lds
    s_add_u32 s31, s31, s37
    s_waitcnt lgkmcnt(8)
    v_mfma_f32_16x16x32_bf16 v[96:99], v[152:155], v[200:203], v[96:99]
    ds_read_b128 v[168:171], v192 offset:2048
    v_mfma_f32_16x16x32_bf16 v[100:103], v[152:155], v[204:207], v[100:103]
    ds_read_b64_tr_b16 v[136:137], v178 offset:0
    ds_read_b64_tr_b16 v[138:139], v178 offset:8192
    v_mfma_f32_16x16x32_bf16 v[104:107], v[152:155], v[208:211], v[104:107]
    v_mfma_f32_16x16x32_bf16 v[108:111], v[152:155], v[212:215], v[108:111]
    s_add_u32 m0, s35, 65536
    s_nop 0
    buffer_load_dwordx4 v196, s[16:19], s32 offen lds
    s_add_u32 s32, s32, 1024
    s_waitcnt lgkmcnt(9)
    v_mfma_f32_16x16x32_bf16 v[112:115], v[156:159], v[200:203], v[112:115]
    ds_read_b128 v[172:175], v192 offset:3072
    v_mfma_f32_16x16x32_bf16 v[116:119], v[156:159], v[204:207], v[116:119]
    ds_read_b64_tr_b16 v[140:141], v179 offset:0
    ds_read_b64_tr_b16 v[142:143], v179 offset:8192
    v_mfma_f32_16x16x32_bf16 v[120:123], v[156:159], v[208:211], v[120:123]
    v_mfma_f32_16x16x32_bf16 v[124:127], v[156:159], v[212:215], v[124:127]
    s_add_u32 m0, s35, 66560
    s_nop 0
    buffer_load_dwordx4 v196, s[16:19], s36 offen lds
    s_add_u32 s36, s36, 1024
    s_waitcnt lgkmcnt(9)
    v_mfma_f32_16x16x32_bf16 v[0:3], v[128:131], v[160:163], v[0:3]
    ds_read_b64_tr_b16 v[144:145], v180 offset:0
    ds_read_b64_tr_b16 v[146:147], v180 offset:8192
    s_waitcnt lgkmcnt(10)
    v_mfma_f32_16x16x32_bf16 v[4:7], v[128:131], v[164:167], v[4:7]
    s_waitcnt lgkmcnt(7)
    v_mfma_f32_16x16x32_bf16 v[8:11], v[128:131], v[168:171], v[8:11]
    s_waitcnt lgkmcnt(4)
    v_mfma_f32_16x16x32_bf16 v[12:15], v[128:131], v[172:175], v[12:15]
    v_mfma_f32_16x16x32_bf16 v[16:19], v[132:135], v[160:163], v[16:19]
    ds_read_b64_tr_b16 v[148:149], v181 offset:0
    ds_read_b64_tr_b16 v[150:151], v181 offset:8192
    v_mfma_f32_16x16x32_bf16 v[20:23], v[132:135], v[164:167], v[20:23]
    v_mfma_f32_16x16x32_bf16 v[24:27], v[132:135], v[168:171], v[24:27]
    v_mfma_f32_16x16x32_bf16 v[28:31], v[132:135], v[172:175], v[28:31]
    v_mfma_f32_16x16x32_bf16 v[32:35], v[136:139], v[160:163], v[32:35]
    ds_read_b64_tr_b16 v[152:153], v182 offset:0
    ds_read_b64_tr_b16 v[154:155], v182 offset:8192
    v_mfma_f32_16x16x32_bf16 v[36:39], v[136:139], v[164:167], v[36:39]
    v_mfma_f32_16x16x32_bf16 v[40:43], v[136:139], v[168:171], v[40:43]
    v_mfma_f32_16x16x32_bf16 v[44:47], v[136:139], v[172:175], v[44:47]
    s_waitcnt lgkmcnt(6)
    v_mfma_f32_16x16x32_bf16 v[48:51], v[140:143], v[160:163], v[48:51]
    ds_read_b64_tr_b16 v[156:157], v183 offset:0
    ds_read_b64_tr_b16 v[158:159], v183 offset:8192
    v_mfma_f32_16x16x32_bf16 v[52:55], v[140:143], v[164:167], v[52:55]
    v_mfma_f32_16x16x32_bf16 v[56:59], v[140:143], v[168:171], v[56:59]
    v_mfma_f32_16x16x32_bf16 v[60:63], v[140:143], v[172:175], v[60:63]
    s_waitcnt vmcnt(4)
    s_barrier
    s_waitcnt lgkmcnt(6)
    v_mfma_f32_16x16x32_bf16 v[64:67], v[144:147], v[160:163], v[64:67]
    ds_read_b128 v[200:203], v192 offset:32768
    v_mfma_f32_16x16x32_bf16 v[68:71], v[144:147], v[164:167], v[68:71]
    ds_read_b64_tr_b16 v[128:129], v176 offset:32768
    ds_read_b64_tr_b16 v[130:131], v176 offset:40960
    v_mfma_f32_16x16x32_bf16 v[72:75], v[144:147], v[168:171], v[72:75]
    v_mfma_f32_16x16x32_bf16 v[76:79], v[144:147], v[172:175], v[76:79]
    s_add_u32 m0, s34, 98304
    s_nop 0
    buffer_load_dwordx4 v194, s[12:15], s31 offen lds
    s_waitcnt lgkmcnt(7)
    v_mfma_f32_16x16x32_bf16 v[80:83], v[148:151], v[160:163], v[80:83]
    ds_read_b128 v[204:207], v192 offset:33792
    v_mfma_f32_16x16x32_bf16 v[84:87], v[148:151], v[164:167], v[84:87]
    ds_read_b64_tr_b16 v[132:133], v177 offset:32768
    ds_read_b64_tr_b16 v[134:135], v177 offset:40960
    v_mfma_f32_16x16x32_bf16 v[88:91], v[148:151], v[168:171], v[88:91]
    v_mfma_f32_16x16x32_bf16 v[92:95], v[148:151], v[172:175], v[92:95]
    s_add_u32 m0, s34, 99328
    s_nop 0
    buffer_load_dwordx4 v195, s[12:15], s31 offen lds
    s_add_u32 s31, s31, s37
    s_waitcnt lgkmcnt(8)
    v_mfma_f32_16x16x32_bf16 v[96:99], v[152:155], v[160:163], v[96:99]
    ds_read_b128 v[208:211], v192 offset:34816
    v_mfma_f32_16x16x32_bf16 v[100:103], v[152:155], v[164:167], v[100:103]
    ds_read_b64_tr_b16 v[136:137], v178 offset:32768
    ds_read_b64_tr_b16 v[138:139], v178 offset:40960
    v_mfma_f32_16x16x32_bf16 v[104:107], v[152:155], v[168:171], v[104:107]
    v_mfma_f32_16x16x32_bf16 v[108:111], v[152:155], v[172:175], v[108:111]
    s_add_u32 m0, s35, 98304
    s_nop 0
    buffer_load_dwordx4 v196, s[16:19], s32 offen lds
    s_add_u32 s32, s32, 1024
    s_waitcnt lgkmcnt(9)
    v_mfma_f32_16x16x32_bf16 v[112:115], v[156:159], v[160:163], v[112:115]
    ds_read_b128 v[212:215], v192 offset:35840
    v_mfma_f32_16x16x32_bf16 v[116:119], v[156:159], v[164:167], v[116:119]
    ds_read_b64_tr_b16 v[140:141], v179 offset:32768
    ds_read_b64_tr_b16 v[142:143], v179 offset:40960
    v_mfma_f32_16x16x32_bf16 v[120:123], v[156:159], v[168:171], v[120:123]
    v_mfma_f32_16x16x32_bf16 v[124:127], v[156:159], v[172:175], v[124:127]
    s_add_u32 m0, s35, 99328
    s_nop 0
    buffer_load_dwordx4 v196, s[16:19], s36 offen lds
    s_add_u32 s36, s36, 1024
    s_waitcnt lgkmcnt(9)
    v_mfma_f32_16x16x32_bf16 v[0:3], v[128:131], v[200:203], v[0:3]
    ds_read_b64_tr_b16 v[144:145], v180 offset:32768
    ds_read_b64_tr_b16 v[146:147], v180 offset:40960
    s_waitcnt lgkmcnt(10)
    v_mfma_f32_16x16x32_bf16 v[4:7], v[128:131], v[204:207], v[4:7]
    s_waitcnt lgkmcnt(7)
    v_mfma_f32_16x16x32_bf16 v[8:11], v[128:131], v[208:211], v[8:11]
    s_waitcnt lgkmcnt(4)
    v_mfma_f32_16x16x32_bf16 v[12:15], v[128:131], v[212:215], v[12:15]
    v_mfma_f32_16x16x32_bf16 v[16:19], v[132:135], v[200:203], v[16:19]
    ds_read_b64_tr_b16 v[148:149], v181 offset:32768
    ds_read_b64_tr_b16 v[150:151], v181 offset:40960
    v_mfma_f32_16x16x32_bf16 v[20:23], v[132:135], v[204:207], v[20:23]
    v_mfma_f32_16x16x32_bf16 v[24:27], v[132:135], v[208:211], v[24:27]
    v_mfma_f32_16x16x32_bf16 v[28:31], v[132:135], v[212:215], v[28:31]
    v_mfma_f32_16x16x32_bf16 v[32:35], v[136:139], v[200:203], v[32:35]
    ds_read_b64_tr_b16 v[152:153], v182 offset:32768
    ds_read_b64_tr_b16 v[154:155], v182 offset:40960
    v_mfma_f32_16x16x32_bf16 v[36:39], v[136:139], v[204:207], v[36:39]
    v_mfma_f32_16x16x32_bf16 v[40:43], v[136:139], v[208:211], v[40:43]
    v_mfma_f32_16x16x32_bf16 v[44:47], v[136:139], v[212:215], v[44:47]
    s_waitcnt lgkmcnt(6)
    v_mfma_f32_16x16x32_bf16 v[48:51], v[140:143], v[200:203], v[48:51]
    ds_read_b64_tr_b16 v[156:157], v183 offset:32768
    ds_read_b64_tr_b16 v[158:159], v183 offset:40960
    v_mfma_f32_16x16x32_bf16 v[52:55], v[140:143], v[204:207], v[52:55]
    v_mfma_f32_16x16x32_bf16 v[56:59], v[140:143], v[208:211], v[56:59]
    v_mfma_f32_16x16x32_bf16 v[60:63], v[140:143], v[212:215], v[60:63]
    s_waitcnt vmcnt(4)
    s_barrier
    s_waitcnt lgkmcnt(6)
    v_mfma_f32_16x16x32_bf16 v[64:67], v[144:147], v[200:203], v[64:67]
    ds_read_b128 v[160:163], v193 offset:0
    v_mfma_f32_16x16x32_bf16 v[68:71], v[144:147], v[204:207], v[68:71]
    ds_read_b64_tr_b16 v[128:129], v184 offset:0
    ds_read_b64_tr_b16 v[130:131], v184 offset:8192
    v_mfma_f32_16x16x32_bf16 v[72:75], v[144:147], v[208:211], v[72:75]
    v_mfma_f32_16x16x32_bf16 v[76:79], v[144:147], v[212:215], v[76:79]
    s_add_u32 m0, s34, 0
    s_nop 0
    buffer_load_dwordx4 v194, s[12:15], s31 offen lds
    s_waitcnt lgkmcnt(7)
    v_mfma_f32_16x16x32_bf16 v[80:83], v[148:151], v[200:203], v[80:83]
    ds_read_b128 v[164:167], v193 offset:1024
    v_mfma_f32_16x16x32_bf16 v[84:87], v[148:151], v[204:207], v[84:87]
    ds_read_b64_tr_b16 v[132:133], v185 offset:0
    ds_read_b64_tr_b16 v[134:135], v185 offset:8192
    v_mfma_f32_16x16x32_bf16 v[88:91], v[148:151], v[208:211], v[88:91]
    v_mfma_f32_16x16x32_bf16 v[92:95], v[148:151], v[212:215], v[92:95]
    s_add_u32 m0, s34, 1024
    s_nop 0
    buffer_load_dwordx4 v195, s[12:15], s31 offen lds
    s_add_u32 s31, s31, s37
    s_waitcnt lgkmcnt(8)
    v_mfma_f32_16x16x32_bf16 v[96:99], v[152:155], v[200:203], v[96:99]
    ds_read_b128 v[168:171], v193 offset:2048
    v_mfma_f32_16x16x32_bf16 v[100:103], v[152:155], v[204:207], v[100:103]
    ds_read_b64_tr_b16 v[136:137], v186 offset:0
    ds_read_b64_tr_b16 v[138:139], v186 offset:8192
    v_mfma_f32_16x16x32_bf16 v[104:107], v[152:155], v[208:211], v[104:107]
    v_mfma_f32_16x16x32_bf16 v[108:111], v[152:155], v[212:215], v[108:111]
    s_add_u32 m0, s35, 0
    s_nop 0
    buffer_load_dwordx4 v196, s[16:19], s32 offen lds
    s_add_u32 s32, s32, 1024
    s_waitcnt lgkmcnt(9)
    v_mfma_f32_16x16x32_bf16 v[112:115], v[156:159], v[200:203], v[112:115]
    ds_read_b128 v[172:175], v193 offset:3072
    v_mfma_f32_16x16x32_bf16 v[116:119], v[156:159], v[204:207], v[116:119]
    ds_read_b64_tr_b16 v[140:141], v187 offset:0
    ds_read_b64_tr_b16 v[142:143], v187 offset:8192
    v_mfma_f32_16x16x32_bf16 v[120:123], v[156:159], v[208:211], v[120:123]
    v_mfma_f32_16x16x32_bf16 v[124:127], v[156:159], v[212:215], v[124:127]
    s_add_u32 m0, s35, 1024
    s_nop 0
    buffer_load_dwordx4 v196, s[16:19], s36 offen lds
    s_add_u32 s36, s36, 1024
    s_waitcnt lgkmcnt(9)
    v_mfma_f32_16x16x32_bf16 v[0:3], v[128:131], v[160:163], v[0:3]
    ds_read_b64_tr_b16 v[144:145], v188 offset:0
    ds_read_b64_tr_b16 v[146:147], v188 offset:8192
    s_waitcnt lgkmcnt(10)
    v_mfma_f32_16x16x32_bf16 v[4:7], v[128:131], v[164:167], v[4:7]
    s_waitcnt lgkmcnt(7)
    v_mfma_f32_16x16x32_bf16 v[8:11], v[128:131], v[168:171], v[8:11]
    s_waitcnt lgkmcnt(4)
    v_mfma_f32_16x16x32_bf16 v[12:15], v[128:131], v[172:175], v[12:15]
    v_mfma_f32_16x16x32_bf16 v[16:19], v[132:135], v[160:163], v[16:19]
    ds_read_b64_tr_b16 v[148:149], v189 offset:0
    ds_read_b64_tr_b16 v[150:151], v189 offset:8192
    v_mfma_f32_16x16x32_bf16 v[20:23], v[132:135], v[164:167], v[20:23]
    v_mfma_f32_16x16x32_bf16 v[24:27], v[132:135], v[168:171], v[24:27]
    v_mfma_f32_16x16x32_bf16 v[28:31], v[132:135], v[172:175], v[28:31]
    v_mfma_f32_16x16x32_bf16 v[32:35], v[136:139], v[160:163], v[32:35]
    ds_read_b64_tr_b16 v[152:153], v190 offset:0
    ds_read_b64_tr_b16 v[154:155], v190 offset:8192
    v_mfma_f32_16x16x32_bf16 v[36:39], v[136:139], v[164:167], v[36:39]
    v_mfma_f32_16x16x32_bf16 v[40:43], v[136:139], v[168:171], v[40:43]
    v_mfma_f32_16x16x32_bf16 v[44:47], v[136:139], v[172:175], v[44:47]
    s_waitcnt lgkmcnt(6)
    v_mfma_f32_16x16x32_bf16 v[48:51], v[140:143], v[160:163], v[48:51]
    ds_read_b64_tr_b16 v[156:157], v191 offset:0
    ds_read_b64_tr_b16 v[158:159], v191 offset:8192
    v_mfma_f32_16x16x32_bf16 v[52:55], v[140:143], v[164:167], v[52:55]
    v_mfma_f32_16x16x32_bf16 v[56:59], v[140:143], v[168:171], v[56:59]
    v_mfma_f32_16x16x32_bf16 v[60:63], v[140:143], v[172:175], v[60:63]
    s_waitcnt vmcnt(4)
    s_barrier
    s_waitcnt lgkmcnt(6)
    v_mfma_f32_16x16x32_bf16 v[64:67], v[144:147], v[160:163], v[64:67]
    ds_read_b128 v[200:203], v193 offset:32768
    v_mfma_f32_16x16x32_bf16 v[68:71], v[144:147], v[164:167], v[68:71]
    ds_read_b64_tr_b16 v[128:129], v184 offset:32768
    ds_read_b64_tr_b16 v[130:131], v184 offset:40960
    v_mfma_f32_16x16x32_bf16 v[72:75], v[144:147], v[168:171], v[72:75]
    v_mfma_f32_16x16x32_bf16 v[76:79], v[144:147], v[172:175], v[76:79]
    s_add_u32 m0, s34, 32768
    s_nop 0
    buffer_load_dwordx4 v194, s[12:15], s31 offen lds
    s_waitcnt lgkmcnt(7)
    v_mfma_f32_16x16x32_bf16 v[80:83], v[148:151], v[160:163], v[80:83]
    ds_read_b128 v[204:207], v193 offset:33792
    v_mfma_f32_16x16x32_bf16 v[84:87], v[148:151], v[164:167], v[84:87]
    ds_read_b64_tr_b16 v[132:133], v185 offset:32768
    ds_read_b64_tr_b16 v[134:135], v185 offset:40960
    v_mfma_f32_16x16x32_bf16 v[88:91], v[148:151], v[168:171], v[88:91]
    v_mfma_f32_16x16x32_bf16 v[92:95], v[148:151], v[172:175], v[92:95]
    s_add_u32 m0, s34, 33792
    s_nop 0
    buffer_load_dwordx4 v195, s[12:15], s31 offen lds
    s_add_u32 s31, s31, s37
    s_waitcnt lgkmcnt(8)
    v_mfma_f32_16x16x32_bf16 v[96:99], v[152:155], v[160:163], v[96:99]
    ds_read_b128 v[208:211], v193 offset:34816
    v_mfma_f32_16x16x32_bf16 v[100:103], v[152:155], v[164:167], v[100:103]
    ds_read_b64_tr_b16 v[136:137], v186 offset:32768
    ds_read_b64_tr_b16 v[138:139], v186 offset:40960
    v_mfma_f32_16x16x32_bf16 v[104:107], v[152:155], v[168:171], v[104:107]
    v_mfma_f32_16x16x32_bf16 v[108:111], v[152:155], v[172:175], v[108:111]
    s_add_u32 m0, s35, 32768
    s_nop 0
    buffer_load_dwordx4 v196, s[16:19], s32 offen lds
    s_add_u32 s32, s32, 1024
    s_waitcnt lgkmcnt(9)
    v_mfma_f32_16x16x32_bf16 v[112:115], v[156:159], v[160:163], v[112:115]
    ds_read_b128 v[212:215], v193 offset:35840
    v_mfma_f32_16x16x32_bf16 v[116:119], v[156:159], v[164:167], v[116:119]
    ds_read_b64_tr_b16 v[140:141], v187 offset:32768
    ds_read_b64_tr_b16 v[142:143], v187 offset:40960
    v_mfma_f32_16x16x32_bf16 v[120:123], v[156:159], v[168:171], v[120:123]
    v_mfma_f32_16x16x32_bf16 v[124:127], v[156:159], v[172:175], v[124:127]
    s_add_u32 m0, s35, 33792
    s_nop 0
    buffer_load_dwordx4 v196, s[16:19], s36 offen lds
    s_add_u32 s36, s36, 1024
    s_waitcnt lgkmcnt(9)
    v_mfma_f32_16x16x32_bf16 v[0:3], v[128:131], v[200:203], v[0:3]
    ds_read_b64_tr_b16 v[144:145], v188 offset:32768
    ds_read_b64_tr_b16 v[146:147], v188 offset:40960
    s_waitcnt lgkmcnt(10)
    v_mfma_f32_16x16x32_bf16 v[4:7], v[128:131], v[204:207], v[4:7]
    s_waitcnt lgkmcnt(7)
    v_mfma_f32_16x16x32_bf16 v[8:11], v[128:131], v[208:211], v[8:11]
    s_waitcnt lgkmcnt(4)
    v_mfma_f32_16x16x32_bf16 v[12:15], v[128:131], v[212:215], v[12:15]
    v_mfma_f32_16x16x32_bf16 v[16:19], v[132:135], v[200:203], v[16:19]
    ds_read_b64_tr_b16 v[148:149], v189 offset:32768
    ds_read_b64_tr_b16 v[150:151], v189 offset:40960
    v_mfma_f32_16x16x32_bf16 v[20:23], v[132:135], v[204:207], v[20:23]
    v_mfma_f32_16x16x32_bf16 v[24:27], v[132:135], v[208:211], v[24:27]
    v_mfma_f32_16x16x32_bf16 v[28:31], v[132:135], v[212:215], v[28:31]
    v_mfma_f32_16x16x32_bf16 v[32:35], v[136:139], v[200:203], v[32:35]
    ds_read_b64_tr_b16 v[152:153], v190 offset:32768
    ds_read_b64_tr_b16 v[154:155], v190 offset:40960
    v_mfma_f32_16x16x32_bf16 v[36:39], v[136:139], v[204:207], v[36:39]
    v_mfma_f32_16x16x32_bf16 v[40:43], v[136:139], v[208:211], v[40:43]
    v_mfma_f32_16x16x32_bf16 v[44:47], v[136:139], v[212:215], v[44:47]
    s_waitcnt lgkmcnt(6)
    v_mfma_f32_16x16x32_bf16 v[48:51], v[140:143], v[200:203], v[48:51]
    ds_read_b64_tr_b16 v[156:157], v191 offset:32768
    ds_read_b64_tr_b16 v[158:159], v191 offset:40960
    v_mfma_f32_16x16x32_bf16 v[52:55], v[140:143], v[204:207], v[52:55]
    v_mfma_f32_16x16x32_bf16 v[56:59], v[140:143], v[208:211], v[56:59]
    v_mfma_f32_16x16x32_bf16 v[60:63], v[140:143], v[212:215], v[60:63]
    s_waitcnt vmcnt(4)
    s_barrier
    s_waitcnt lgkmcnt(6)
    v_mfma_f32_16x16x32_bf16 v[64:67], v[144:147], v[200:203], v[64:67]
    ds_read_b128 v[160:163], v192 offset:0
    v_mfma_f32_16x16x32_bf16 v[68:71], v[144:147], v[204:207], v[68:71]
    ds_read_b64_tr_b16 v[128:129], v176 offset:0
    ds_read_b64_tr_b16 v[130:131], v176 offset:8192
    v_mfma_f32_16x16x32_bf16 v[72:75], v[144:147], v[208:211], v[72:75]
    v_mfma_f32_16x16x32_bf16 v[76:79], v[144:147], v[212:215], v[76:79]
    s_add_u32 m0, s34, 65536
    s_nop 0
    buffer_load_dwordx4 v194, s[12:15], s31 offen lds
    s_waitcnt lgkmcnt(7)
    v_mfma_f32_16x16x32_bf16 v[80:83], v[148:151], v[200:203], v[80:83]
    ds_read_b128 v[164:167], v192 offset:1024
    v_mfma_f32_16x16x32_bf16 v[84:87], v[148:151], v[204:207], v[84:87]
    ds_read_b64_tr_b16 v[132:133], v177 offset:0
    ds_read_b64_tr_b16 v[134:135], v177 offset:8192
    v_mfma_f32_16x16x32_bf16 v[88:91], v[148:151], v[208:211], v[88:91]
    v_mfma_f32_16x16x32_bf16 v[92:95], v[148:151], v[212:215], v[92:95]
    s_add_u32 m0, s34, 66560
    s_nop 0
    buffer_load_dwordx4 v195, s[12:15], s31 offen lds
    s_add_u32 s31, s31, s37
    s_waitcnt lgkmcnt(8)
    v_mfma_f32_16x16x32_bf16 v[96:99], v[152:155], v[200:203], v[96:99]
    ds_read_b128 v[168:171], v192 offset:2048
    v_mfma_f32_16x16x32_bf16 v[100:103], v[152:155], v[204:207], v[100:103]
    ds_read_b64_tr_b16 v[136:137], v178 offset:0
    ds_read_b64_tr_b16 v[138:139], v178 offset:8192
    v_mfma_f32_16x16x32_bf16 v[104:107], v[152:155], v[208:211], v[104:107]
    v_mfma_f32_16x16x32_bf16 v[108:111], v[152:155], v[212:215], v[108:111]
    s_add_u32 m0, s35, 65536
    s_nop 0
    buffer_load_dwordx4 v196, s[16:19], s32 offen lds
    s_add_u32 s32, s32, 1024
    s_waitcnt lgkmcnt(9)
    v_mfma_f32_16x16x32_bf16 v[112:115], v[156:159], v[200:203], v[112:115]
    ds_read_b128 v[172:175], v192 offset:3072
    v_mfma_f32_16x16x32_bf16 v[116:119], v[156:159], v[204:207], v[116:119]
    ds_read_b64_tr_b16 v[140:141], v179 offset:0
    ds_read_b64_tr_b16 v[142:143], v179 offset:8192
    v_mfma_f32_16x16x32_bf16 v[120:123], v[156:159], v[208:211], v[120:123]
    v_mfma_f32_16x16x32_bf16 v[124:127], v[156:159], v[212:215], v[124:127]
    s_add_u32 m0, s35, 66560
    s_nop 0
    buffer_load_dwordx4 v196, s[16:19], s36 offen lds
    s_add_u32 s36, s36, 1024
    s_waitcnt lgkmcnt(9)
    v_mfma_f32_16x16x32_bf16 v[0:3], v[128:131], v[160:163], v[0:3]
    ds_read_b64_tr_b16 v[144:145], v180 offset:0
    ds_read_b64_tr_b16 v[146:147], v180 offset:8192
    s_waitcnt lgkmcnt(10)
    v_mfma_f32_16x16x32_bf16 v[4:7], v[128:131], v[164:167], v[4:7]
    s_waitcnt lgkmcnt(7)
    v_mfma_f32_16x16x32_bf16 v[8:11], v[128:131], v[168:171], v[8:11]
    s_waitcnt lgkmcnt(4)
    v_mfma_f32_16x16x32_bf16 v[12:15], v[128:131], v[172:175], v[12:15]
    v_mfma_f32_16x16x32_bf16 v[16:19], v[132:135], v[160:163], v[16:19]
    ds_read_b64_tr_b16 v[148:149], v181 offset:0
    ds_read_b64_tr_b16 v[150:151], v181 offset:8192
    v_mfma_f32_16x16x32_bf16 v[20:23], v[132:135], v[164:167], v[20:23]
    v_mfma_f32_16x16x32_bf16 v[24:27], v[132:135], v[168:171], v[24:27]
    v_mfma_f32_16x16x32_bf16 v[28:31], v[132:135], v[172:175], v[28:31]
    v_mfma_f32_16x16x32_bf16 v[32:35], v[136:139], v[160:163], v[32:35]
    ds_read_b64_tr_b16 v[152:153], v182 offset:0
    ds_read_b64_tr_b16 v[154:155], v182 offset:8192
    v_mfma_f32_16x16x32_bf16 v[36:39], v[136:139], v[164:167], v[36:39]
    v_mfma_f32_16x16x32_bf16 v[40:43], v[136:139], v[168:171], v[40:43]
    v_mfma_f32_16x16x32_bf16 v[44:47], v[136:139], v[172:175], v[44:47]
    s_waitcnt lgkmcnt(6)
    v_mfma_f32_16x16x32_bf16 v[48:51], v[140:143], v[160:163], v[48:51]
    ds_read_b64_tr_b16 v[156:157], v183 offset:0
    ds_read_b64_tr_b16 v[158:159], v183 offset:8192
    v_mfma_f32_16x16x32_bf16 v[52:55], v[140:143], v[164:167], v[52:55]
    v_mfma_f32_16x16x32_bf16 v[56:59], v[140:143], v[168:171], v[56:59]
    v_mfma_f32_16x16x32_bf16 v[60:63], v[140:143], v[172:175], v[60:63]
    s_waitcnt vmcnt(4)
    s_barrier
    s_waitcnt lgkmcnt(6)
    v_mfma_f32_16x16x32_bf16 v[64:67], v[144:147], v[160:163], v[64:67]
    ds_read_b128 v[200:203], v192 offset:32768
    v_mfma_f32_16x16x32_bf16 v[68:71], v[144:147], v[164:167], v[68:71]
    ds_read_b64_tr_b16 v[128:129], v176 offset:32768
    ds_read_b64_tr_b16 v[130:131], v176 offset:40960
    v_mfma_f32_16x16x32_bf16 v[72:75], v[144:147], v[168:171], v[72:75]
    v_mfma_f32_16x16x32_bf16 v[76:79], v[144:147], v[172:175], v[76:79]
    s_add_u32 m0, s34, 98304
    s_nop 0
    buffer_load_dwordx4 v194, s[12:15], s31 offen lds
    s_waitcnt lgkmcnt(7)
    v_mfma_f32_16x16x32_bf16 v[80:83], v[148:151], v[160:163], v[80:83]
    ds_read_b128 v[204:207], v192 offset:33792
    v_mfma_f32_16x16x32_bf16 v[84:87], v[148:151], v[164:167], v[84:87]
    ds_read_b64_tr_b16 v[132:133], v177 offset:32768
    ds_read_b64_tr_b16 v[134:135], v177 offset:40960
    v_mfma_f32_16x16x32_bf16 v[88:91], v[148:151], v[168:171], v[88:91]
    v_mfma_f32_16x16x32_bf16 v[92:95], v[148:151], v[172:175], v[92:95]
    s_add_u32 m0, s34, 99328
    s_nop 0
    buffer_load_dwordx4 v195, s[12:15], s31 offen lds
    s_add_u32 s31, s31, s37
    s_waitcnt lgkmcnt(8)
    v_mfma_f32_16x16x32_bf16 v[96:99], v[152:155], v[160:163], v[96:99]
    ds_read_b128 v[208:211], v192 offset:34816
    v_mfma_f32_16x16x32_bf16 v[100:103], v[152:155], v[164:167], v[100:103]
    ds_read_b64_tr_b16 v[136:137], v178 offset:32768
    ds_read_b64_tr_b16 v[138:139], v178 offset:40960
    v_mfma_f32_16x16x32_bf16 v[104:107], v[152:155], v[168:171], v[104:107]
    v_mfma_f32_16x16x32_bf16 v[108:111], v[152:155], v[172:175], v[108:111]
    s_add_u32 m0, s35, 98304
    s_nop 0
    buffer_load_dwordx4 v196, s[16:19], s32 offen lds
    s_add_u32 s32, s32, 1024
    s_waitcnt lgkmcnt(9)
    v_mfma_f32_16x16x32_bf16 v[112:115], v[156:159], v[160:163], v[112:115]
    ds_read_b128 v[212:215], v192 offset:35840
    v_mfma_f32_16x16x32_bf16 v[116:119], v[156:159], v[164:167], v[116:119]
    ds_read_b64_tr_b16 v[140:141], v179 offset:32768
    ds_read_b64_tr_b16 v[142:143], v179 offset:40960
    v_mfma_f32_16x16x32_bf16 v[120:123], v[156:159], v[168:171], v[120:123]
    v_mfma_f32_16x16x32_bf16 v[124:127], v[156:159], v[172:175], v[124:127]
    s_add_u32 m0, s35, 99328
    s_nop 0
    buffer_load_dwordx4 v196, s[16:19], s36 offen lds
    s_add_u32 s36, s36, 1024
    s_waitcnt lgkmcnt(9)
    v_mfma_f32_16x16x32_bf16 v[0:3], v[128:131], v[200:203], v[0:3]
    ds_read_b64_tr_b16 v[144:145], v180 offset:32768
    ds_read_b64_tr_b16 v[146:147], v180 offset:40960
    s_waitcnt lgkmcnt(10)
    v_mfma_f32_16x16x32_bf16 v[4:7], v[128:131], v[204:207], v[4:7]
    s_waitcnt lgkmcnt(7)
    v_mfma_f32_16x16x32_bf16 v[8:11], v[128:131], v[208:211], v[8:11]
    s_waitcnt lgkmcnt(4)
    v_mfma_f32_16x16x32_bf16 v[12:15], v[128:131], v[212:215], v[12:15]
    v_mfma_f32_16x16x32_bf16 v[16:19], v[132:135], v[200:203], v[16:19]
    ds_read_b64_tr_b16 v[148:149], v181 offset:32768
    ds_read_b64_tr_b16 v[150:151], v181 offset:40960
    v_mfma_f32_16x16x32_bf16 v[20:23], v[132:135], v[204:207], v[20:23]
    v_mfma_f32_16x16x32_bf16 v[24:27], v[132:135], v[208:211], v[24:27]
    v_mfma_f32_16x16x32_bf16 v[28:31], v[132:135], v[212:215], v[28:31]
    v_mfma_f32_16x16x32_bf16 v[32:35], v[136:139], v[200:203], v[32:35]
    ds_read_b64_tr_b16 v[152:153], v182 offset:32768
    ds_read_b64_tr_b16 v[154:155], v182 offset:40960
    v_mfma_f32_16x16x32_bf16 v[36:39], v[136:139], v[204:207], v[36:39]
    v_mfma_f32_16x16x32_bf16 v[40:43], v[136:139], v[208:211], v[40:43]
    v_mfma_f32_16x16x32_bf16 v[44:47], v[136:139], v[212:215], v[44:47]
    s_waitcnt lgkmcnt(6)
    v_mfma_f32_16x16x32_bf16 v[48:51], v[140:143], v[200:203], v[48:51]
    ds_read_b64_tr_b16 v[156:157], v183 offset:32768
    ds_read_b64_tr_b16 v[158:159], v183 offset:40960
    v_mfma_f32_16x16x32_bf16 v[52:55], v[140:143], v[204:207], v[52:55]
    v_mfma_f32_16x16x32_bf16 v[56:59], v[140:143], v[208:211], v[56:59]
    v_mfma_f32_16x16x32_bf16 v[60:63], v[140:143], v[212:215], v[60:63]
    s_waitcnt vmcnt(4)
    s_barrier
    s_waitcnt lgkmcnt(6)
    v_mfma_f32_16x16x32_bf16 v[64:67], v[144:147], v[200:203], v[64:67]
    ds_read_b128 v[160:163], v193 offset:0
    v_mfma_f32_16x16x32_bf16 v[68:71], v[144:147], v[204:207], v[68:71]
    ds_read_b64_tr_b16 v[128:129], v184 offset:0
    ds_read_b64_tr_b16 v[130:131], v184 offset:8192
    v_mfma_f32_16x16x32_bf16 v[72:75], v[144:147], v[208:211], v[72:75]
    v_mfma_f32_16x16x32_bf16 v[76:79], v[144:147], v[212:215], v[76:79]
    s_add_u32 m0, s34, 0
    s_nop 0
    buffer_load_dwordx4 v194, s[12:15], s31 offen lds
    s_waitcnt lgkmcnt(7)
    v_mfma_f32_16x16x32_bf16 v[80:83], v[148:151], v[200:203], v[80:83]
    ds_read_b128 v[164:167], v193 offset:1024
    v_mfma_f32_16x16x32_bf16 v[84:87], v[148:151], v[204:207], v[84:87]
    ds_read_b64_tr_b16 v[132:133], v185 offset:0
    ds_read_b64_tr_b16 v[134:135], v185 offset:8192
    v_mfma_f32_16x16x32_bf16 v[88:91], v[148:151], v[208:211], v[88:91]
    v_mfma_f32_16x16x32_bf16 v[92:95], v[148:151], v[212:215], v[92:95]
    s_add_u32 m0, s34, 1024
    s_nop 0
    buffer_load_dwordx4 v195, s[12:15], s31 offen lds
    s_add_u32 s31, s31, s37
    s_waitcnt lgkmcnt(8)
    v_mfma_f32_16x16x32_bf16 v[96:99], v[152:155], v[200:203], v[96:99]
    ds_read_b128 v[168:171], v193 offset:2048
    v_mfma_f32_16x16x32_bf16 v[100:103], v[152:155], v[204:207], v[100:103]
    ds_read_b64_tr_b16 v[136:137], v186 offset:0
    ds_read_b64_tr_b16 v[138:139], v186 offset:8192
    v_mfma_f32_16x16x32_bf16 v[104:107], v[152:155], v[208:211], v[104:107]
    v_mfma_f32_16x16x32_bf16 v[108:111], v[152:155], v[212:215], v[108:111]
    s_add_u32 m0, s35, 0
    s_nop 0
    buffer_load_dwordx4 v196, s[16:19], s32 offen lds
    s_add_u32 s32, s32, 1024
    s_waitcnt lgkmcnt(9)
    v_mfma_f32_16x16x32_bf16 v[112:115], v[156:159], v[200:203], v[112:115]
    ds_read_b128 v[172:175], v193 offset:3072
    v_mfma_f32_16x16x32_bf16 v[116:119], v[156:159], v[204:207], v[116:119]
    ds_read_b64_tr_b16 v[140:141], v187 offset:0
    ds_read_b64_tr_b16 v[142:143], v187 offset:8192
    v_mfma_f32_16x16x32_bf16 v[120:123], v[156:159], v[208:211], v[120:123]
    v_mfma_f32_16x16x32_bf16 v[124:127], v[156:159], v[212:215], v[124:127]
    s_add_u32 m0, s35, 1024
    s_nop 0
    buffer_load_dwordx4 v196, s[16:19], s36 offen lds
    s_add_u32 s36, s36, 1024
    s_waitcnt lgkmcnt(9)
    v_mfma_f32_16x16x32_bf16 v[0:3], v[128:131], v[160:163], v[0:3]
    ds_read_b64_tr_b16 v[144:145], v188 offset:0
    ds_read_b64_tr_b16 v[146:147], v188 offset:8192
    s_waitcnt lgkmcnt(10)
    v_mfma_f32_16x16x32_bf16 v[4:7], v[128:131], v[164:167], v[4:7]
    s_waitcnt lgkmcnt(7)
    v_mfma_f32_16x16x32_bf16 v[8:11], v[128:131], v[168:171], v[8:11]
    s_waitcnt lgkmcnt(4)
    v_mfma_f32_16x16x32_bf16 v[12:15], v[128:131], v[172:175], v[12:15]
    v_mfma_f32_16x16x32_bf16 v[16:19], v[132:135], v[160:163], v[16:19]
    ds_read_b64_tr_b16 v[148:149], v189 offset:0
    ds_read_b64_tr_b16 v[150:151], v189 offset:8192
    v_mfma_f32_16x16x32_bf16 v[20:23], v[132:135], v[164:167], v[20:23]
    v_mfma_f32_16x16x32_bf16 v[24:27], v[132:135], v[168:171], v[24:27]
    v_mfma_f32_16x16x32_bf16 v[28:31], v[132:135], v[172:175], v[28:31]
    v_mfma_f32_16x16x32_bf16 v[32:35], v[136:139], v[160:163], v[32:35]
    ds_read_b64_tr_b16 v[152:153], v190 offset:0
    ds_read_b64_tr_b16 v[154:155], v190 offset:8192
    v_mfma_f32_16x16x32_bf16 v[36:39], v[136:139], v[164:167], v[36:39]
    v_mfma_f32_16x16x32_bf16 v[40:43], v[136:139], v[168:171], v[40:43]
    v_mfma_f32_16x16x32_bf16 v[44:47], v[136:139], v[172:175], v[44:47]
    s_waitcnt lgkmcnt(6)
    v_mfma_f32_16x16x32_bf16 v[48:51], v[140:143], v[160:163], v[48:51]
    ds_read_b64_tr_b16 v[156:157], v191 offset:0
    ds_read_b64_tr_b16 v[158:159], v191 offset:8192
    v_mfma_f32_16x16x32_bf16 v[52:55], v[140:143], v[164:167], v[52:55]
    v_mfma_f32_16x16x32_bf16 v[56:59], v[140:143], v[168:171], v[56:59]
    v_mfma_f32_16x16x32_bf16 v[60:63], v[140:143], v[172:175], v[60:63]
    s_waitcnt vmcnt(4)
    s_barrier
    s_waitcnt lgkmcnt(6)
    v_mfma_f32_16x16x32_bf16 v[64:67], v[144:147], v[160:163], v[64:67]
    ds_read_b128 v[200:203], v193 offset:32768
    v_mfma_f32_16x16x32_bf16 v[68:71], v[144:147], v[164:167], v[68:71]
    ds_read_b64_tr_b16 v[128:129], v184 offset:32768
    ds_read_b64_tr_b16 v[130:131], v184 offset:40960
    v_mfma_f32_16x16x32_bf16 v[72:75], v[144:147], v[168:171], v[72:75]
    v_mfma_f32_16x16x32_bf16 v[76:79], v[144:147], v[172:175], v[76:79]
    s_add_u32 m0, s34, 32768
    s_nop 0
    buffer_load_dwordx4 v194, s[12:15], s31 offen lds
    s_waitcnt lgkmcnt(7)
    v_mfma_f32_16x16x32_bf16 v[80:83], v[148:151], v[160:163], v[80:83]
    ds_read_b128 v[204:207], v193 offset:33792
    v_mfma_f32_16x16x32_bf16 v[84:87], v[148:151], v[164:167], v[84:87]
    ds_read_b64_tr_b16 v[132:133], v185 offset:32768
    ds_read_b64_tr_b16 v[134:135], v185 offset:40960
    v_mfma_f32_16x16x32_bf16 v[88:91], v[148:151], v[168:171], v[88:91]
    v_mfma_f32_16x16x32_bf16 v[92:95], v[148:151], v[172:175], v[92:95]
    s_add_u32 m0, s34, 33792
    s_nop 0
    buffer_load_dwordx4 v195, s[12:15], s31 offen lds
    s_add_u32 s31, s31, s37
    s_waitcnt lgkmcnt(8)
    v_mfma_f32_16x16x32_bf16 v[96:99], v[152:155], v[160:163], v[96:99]
    ds_read_b128 v[208:211], v193 offset:34816
    v_mfma_f32_16x16x32_bf16 v[100:103], v[152:155], v[164:167], v[100:103]
    ds_read_b64_tr_b16 v[136:137], v186 offset:32768
    ds_read_b64_tr_b16 v[138:139], v186 offset:40960
    v_mfma_f32_16x16x32_bf16 v[104:107], v[152:155], v[168:171], v[104:107]
    v_mfma_f32_16x16x32_bf16 v[108:111], v[152:155], v[172:175], v[108:111]
    s_add_u32 m0, s35, 32768
    s_nop 0
    buffer_load_dwordx4 v196, s[16:19], s32 offen lds
    s_add_u32 s32, s32, 1024
    s_waitcnt lgkmcnt(9)
    v_mfma_f32_16x16x32_bf16 v[112:115], v[156:159], v[160:163], v[112:115]
    ds_read_b128 v[212:215], v193 offset:35840
    v_mfma_f32_16x16x32_bf16 v[116:119], v[156:159], v[164:167], v[116:119]
    ds_read_b64_tr_b16 v[140:141], v187 offset:32768
    ds_read_b64_tr_b16 v[142:143], v187 offset:40960
    v_mfma_f32_16x16x32_bf16 v[120:123], v[156:159], v[168:171], v[120:123]
    v_mfma_f32_16x16x32_bf16 v[124:127], v[156:159], v[172:175], v[124:127]
    s_add_u32 m0, s35, 33792
    s_nop 0
    buffer_load_dwordx4 v196, s[16:19], s36 offen lds
    s_add_u32 s36, s36, 1024
    s_waitcnt lgkmcnt(9)
    v_mfma_f32_16x16x32_bf16 v[0:3], v[128:131], v[200:203], v[0:3]
    ds_read_b64_tr_b16 v[144:145], v188 offset:32768
    ds_read_b64_tr_b16 v[146:147], v188 offset:40960
    s_waitcnt lgkmcnt(10)
    v_mfma_f32_16x16x32_bf16 v[4:7], v[128:131], v[204:207], v[4:7]
    s_waitcnt lgkmcnt(7)
    v_mfma_f32_16x16x32_bf16 v[8:11], v[128:131], v[208:211], v[8:11]
    s_waitcnt lgkmcnt(4)
    v_mfma_f32_16x16x32_bf16 v[12:15], v[128:131], v[212:215], v[12:15]
    v_mfma_f32_16x16x32_bf16 v[16:19], v[132:135], v[200:203], v[16:19]
    ds_read_b64_tr_b16 v[148:149], v189 offset:32768
    ds_read_b64_tr_b16 v[150:151], v189 offset:40960
    v_mfma_f32_16x16x32_bf16 v[20:23], v[132:135], v[204:207], v[20:23]
    v_mfma_f32_16x16x32_bf16 v[24:27], v[132:135], v[208:211], v[24:27]
    v_mfma_f32_16x16x32_bf16 v[28:31], v[132:135], v[212:215], v[28:31]
    v_mfma_f32_16x16x32_bf16 v[32:35], v[136:139], v[200:203], v[32:35]
    ds_read_b64_tr_b16 v[152:153], v190 offset:32768
    ds_read_b64_tr_b16 v[154:155], v190 offset:40960
    v_mfma_f32_16x16x32_bf16 v[36:39], v[136:139], v[204:207], v[36:39]
    v_mfma_f32_16x16x32_bf16 v[40:43], v[136:139], v[208:211], v[40:43]
    v_mfma_f32_16x16x32_bf16 v[44:47], v[136:139], v[212:215], v[44:47]
    s_waitcnt lgkmcnt(6)
    v_mfma_f32_16x16x32_bf16 v[48:51], v[140:143], v[200:203], v[48:51]
    ds_read_b64_tr_b16 v[156:157], v191 offset:32768
    ds_read_b64_tr_b16 v[158:159], v191 offset:40960
    v_mfma_f32_16x16x32_bf16 v[52:55], v[140:143], v[204:207], v[52:55]
    v_mfma_f32_16x16x32_bf16 v[56:59], v[140:143], v[208:211], v[56:59]
    v_mfma_f32_16x16x32_bf16 v[60:63], v[140:143], v[212:215], v[60:63]
    s_waitcnt vmcnt(4)
    s_barrier
    s_waitcnt lgkmcnt(6)
    v_mfma_f32_16x16x32_bf16 v[64:67], v[144:147], v[200:203], v[64:67]
    ds_read_b128 v[160:163], v192 offset:0
    v_mfma_f32_16x16x32_bf16 v[68:71], v[144:147], v[204:207], v[68:71]
    ds_read_b64_tr_b16 v[128:129], v176 offset:0
    ds_read_b64_tr_b16 v[130:131], v176 offset:8192
    v_mfma_f32_16x16x32_bf16 v[72:75], v[144:147], v[208:211], v[72:75]
    v_mfma_f32_16x16x32_bf16 v[76:79], v[144:147], v[212:215], v[76:79]
    s_add_u32 m0, s34, 65536
    s_nop 0
    buffer_load_dwordx4 v194, s[12:15], s31 offen lds
    s_waitcnt lgkmcnt(7)
    v_mfma_f32_16x16x32_bf16 v[80:83], v[148:151], v[200:203], v[80:83]
    ds_read_b128 v[164:167], v192 offset:1024
    v_mfma_f32_16x16x32_bf16 v[84:87], v[148:151], v[204:207], v[84:87]
    ds_read_b64_tr_b16 v[132:133], v177 offset:0
    ds_read_b64_tr_b16 v[134:135], v177 offset:8192
    v_mfma_f32_16x16x32_bf16 v[88:91], v[148:151], v[208:211], v[88:91]
    v_mfma_f32_16x16x32_bf16 v[92:95], v[148:151], v[212:215], v[92:95]
    s_add_u32 m0, s34, 66560
    s_nop 0
    buffer_load_dwordx4 v195, s[12:15], s31 offen lds
    s_add_u32 s31, s31, s37
    s_waitcnt lgkmcnt(8)
    v_mfma_f32_16x16x32_bf16 v[96:99], v[152:155], v[200:203], v[96:99]
    ds_read_b128 v[168:171], v192 offset:2048
    v_mfma_f32_16x16x32_bf16 v[100:103], v[152:155], v[204:207], v[100:103]
    ds_read_b64_tr_b16 v[136:137], v178 offset:0
    ds_read_b64_tr_b16 v[138:139], v178 offset:8192
    v_mfma_f32_16x16x32_bf16 v[104:107], v[152:155], v[208:211], v[104:107]
    v_mfma_f32_16x16x32_bf16 v[108:111], v[152:155], v[212:215], v[108:111]
    s_add_u32 m0, s35, 65536
    s_nop 0
    buffer_load_dwordx4 v196, s[16:19], s32 offen lds
    s_add_u32 s32, s32, 1024
    s_waitcnt lgkmcnt(9)
    v_mfma_f32_16x16x32_bf16 v[112:115], v[156:159], v[200:203], v[112:115]
    ds_read_b128 v[172:175], v192 offset:3072
    v_mfma_f32_16x16x32_bf16 v[116:119], v[156:159], v[204:207], v[116:119]
    ds_read_b64_tr_b16 v[140:141], v179 offset:0
    ds_read_b64_tr_b16 v[142:143], v179 offset:8192
    v_mfma_f32_16x16x32_bf16 v[120:123], v[156:159], v[208:211], v[120:123]
    v_mfma_f32_16x16x32_bf16 v[124:127], v[156:159], v[212:215], v[124:127]
    s_add_u32 m0, s35, 66560
    s_nop 0
    buffer_load_dwordx4 v196, s[16:19], s36 offen lds
    s_add_u32 s36, s36, 1024
    s_waitcnt lgkmcnt(9)
    v_mfma_f32_16x16x32_bf16 v[0:3], v[128:131], v[160:163], v[0:3]
    ds_read_b64_tr_b16 v[144:145], v180 offset:0
    ds_read_b64_tr_b16 v[146:147], v180 offset:8192
    s_waitcnt lgkmcnt(10)
    v_mfma_f32_16x16x32_bf16 v[4:7], v[128:131], v[164:167], v[4:7]
    s_waitcnt lgkmcnt(7)
    v_mfma_f32_16x16x32_bf16 v[8:11], v[128:131], v[168:171], v[8:11]
    s_waitcnt lgkmcnt(4)
    v_mfma_f32_16x16x32_bf16 v[12:15], v[128:131], v[172:175], v[12:15]
    v_mfma_f32_16x16x32_bf16 v[16:19], v[132:135], v[160:163], v[16:19]
    ds_read_b64_tr_b16 v[148:149], v181 offset:0
    ds_read_b64_tr_b16 v[150:151], v181 offset:8192
    v_mfma_f32_16x16x32_bf16 v[20:23], v[132:135], v[164:167], v[20:23]
    v_mfma_f32_16x16x32_bf16 v[24:27], v[132:135], v[168:171], v[24:27]
    v_mfma_f32_16x16x32_bf16 v[28:31], v[132:135], v[172:175], v[28:31]
    v_mfma_f32_16x16x32_bf16 v[32:35], v[136:139], v[160:163], v[32:35]
    ds_read_b64_tr_b16 v[152:153], v182 offset:0
    ds_read_b64_tr_b16 v[154:155], v182 offset:8192
    v_mfma_f32_16x16x32_bf16 v[36:39], v[136:139], v[164:167], v[36:39]
    v_mfma_f32_16x16x32_bf16 v[40:43], v[136:139], v[168:171], v[40:43]
    v_mfma_f32_16x16x32_bf16 v[44:47], v[136:139], v[172:175], v[44:47]
    s_waitcnt lgkmcnt(6)
    v_mfma_f32_16x16x32_bf16 v[48:51], v[140:143], v[160:163], v[48:51]
    ds_read_b64_tr_b16 v[156:157], v183 offset:0
    ds_read_b64_tr_b16 v[158:159], v183 offset:8192
    v_mfma_f32_16x16x32_bf16 v[52:55], v[140:143], v[164:167], v[52:55]
    v_mfma_f32_16x16x32_bf16 v[56:59], v[140:143], v[168:171], v[56:59]
    v_mfma_f32_16x16x32_bf16 v[60:63], v[140:143], v[172:175], v[60:63]
    s_waitcnt vmcnt(4)
    s_barrier
    s_waitcnt lgkmcnt(6)
    v_mfma_f32_16x16x32_bf16 v[64:67], v[144:147], v[160:163], v[64:67]
    ds_read_b128 v[200:203], v192 offset:32768
    v_mfma_f32_16x16x32_bf16 v[68:71], v[144:147], v[164:167], v[68:71]
    ds_read_b64_tr_b16 v[128:129], v176 offset:32768
    ds_read_b64_tr_b16 v[130:131], v176 offset:40960
    v_mfma_f32_16x16x32_bf16 v[72:75], v[144:147], v[168:171], v[72:75]
    v_mfma_f32_16x16x32_bf16 v[76:79], v[144:147], v[172:175], v[76:79]
    s_add_u32 m0, s34, 98304
    s_nop 0
    buffer_load_dwordx4 v194, s[12:15], s31 offen lds
    s_waitcnt lgkmcnt(7)
    v_mfma_f32_16x16x32_bf16 v[80:83], v[148:151], v[160:163], v[80:83]
    ds_read_b128 v[204:207], v192 offset:33792
    v_mfma_f32_16x16x32_bf16 v[84:87], v[148:151], v[164:167], v[84:87]
    ds_read_b64_tr_b16 v[132:133], v177 offset:32768
    ds_read_b64_tr_b16 v[134:135], v177 offset:40960
    v_mfma_f32_16x16x32_bf16 v[88:91], v[148:151], v[168:171], v[88:91]
    v_mfma_f32_16x16x32_bf16 v[92:95], v[148:151], v[172:175], v[92:95]
    s_add_u32 m0, s34, 99328
    s_nop 0
    buffer_load_dwordx4 v195, s[12:15], s31 offen lds
    s_add_u32 s31, s31, s37
    s_waitcnt lgkmcnt(8)
    v_mfma_f32_16x16x32_bf16 v[96:99], v[152:155], v[160:163], v[96:99]
    ds_read_b128 v[208:211], v192 offset:34816
    v_mfma_f32_16x16x32_bf16 v[100:103], v[152:155], v[164:167], v[100:103]
    ds_read_b64_tr_b16 v[136:137], v178 offset:32768
    ds_read_b64_tr_b16 v[138:139], v178 offset:40960
    v_mfma_f32_16x16x32_bf16 v[104:107], v[152:155], v[168:171], v[104:107]
    v_mfma_f32_16x16x32_bf16 v[108:111], v[152:155], v[172:175], v[108:111]
    s_add_u32 m0, s35, 98304
    s_nop 0
    buffer_load_dwordx4 v196, s[16:19], s32 offen lds
    s_add_u32 s32, s32, 1024
    s_waitcnt lgkmcnt(9)
    v_mfma_f32_16x16x32_bf16 v[112:115], v[156:159], v[160:163], v[112:115]
    ds_read_b128 v[212:215], v192 offset:35840
    v_mfma_f32_16x16x32_bf16 v[116:119], v[156:159], v[164:167], v[116:119]
    ds_read_b64_tr_b16 v[140:141], v179 offset:32768
    ds_read_b64_tr_b16 v[142:143], v179 offset:40960
    v_mfma_f32_16x16x32_bf16 v[120:123], v[156:159], v[168:171], v[120:123]
    v_mfma_f32_16x16x32_bf16 v[124:127], v[156:159], v[172:175], v[124:127]
    s_add_u32 m0, s35, 99328
    s_nop 0
    buffer_load_dwordx4 v196, s[16:19], s36 offen lds
    s_add_u32 s36, s36, 1024
    s_waitcnt lgkmcnt(9)
    v_mfma_f32_16x16x32_bf16 v[0:3], v[128:131], v[200:203], v[0:3]
    ds_read_b64_tr_b16 v[144:145], v180 offset:32768
    ds_read_b64_tr_b16 v[146:147], v180 offset:40960
    s_waitcnt lgkmcnt(10)
    v_mfma_f32_16x16x32_bf16 v[4:7], v[128:131], v[204:207], v[4:7]
    s_waitcnt lgkmcnt(7)
    v_mfma_f32_16x16x32_bf16 v[8:11], v[128:131], v[208:211], v[8:11]
    s_waitcnt lgkmcnt(4)
    v_mfma_f32_16x16x32_bf16 v[12:15], v[128:131], v[212:215], v[12:15]
    v_mfma_f32_16x16x32_bf16 v[16:19], v[132:135], v[200:203], v[16:19]
    ds_read_b64_tr_b16 v[148:149], v181 offset:32768
    ds_read_b64_tr_b16 v[150:151], v181 offset:40960
    v_mfma_f32_16x16x32_bf16 v[20:23], v[132:135], v[204:207], v[20:23]
    v_mfma_f32_16x16x32_bf16 v[24:27], v[132:135], v[208:211], v[24:27]
    v_mfma_f32_16x16x32_bf16 v[28:31], v[132:135], v[212:215], v[28:31]
    v_mfma_f32_16x16x32_bf16 v[32:35], v[136:139], v[200:203], v[32:35]
    ds_read_b64_tr_b16 v[152:153], v182 offset:32768
    ds_read_b64_tr_b16 v[154:155], v182 offset:40960
    v_mfma_f32_16x16x32_bf16 v[36:39], v[136:139], v[204:207], v[36:39]
    v_mfma_f32_16x16x32_bf16 v[40:43], v[136:139], v[208:211], v[40:43]
    v_mfma_f32_16x16x32_bf16 v[44:47], v[136:139], v[212:215], v[44:47]
    s_waitcnt lgkmcnt(6)
    v_mfma_f32_16x16x32_bf16 v[48:51], v[140:143], v[200:203], v[48:51]
    ds_read_b64_tr_b16 v[156:157], v183 offset:32768
    ds_read_b64_tr_b16 v[158:159], v183 offset:40960
    v_mfma_f32_16x16x32_bf16 v[52:55], v[140:143], v[204:207], v[52:55]
    v_mfma_f32_16x16x32_bf16 v[56:59], v[140:143], v[208:211], v[56:59]
    v_mfma_f32_16x16x32_bf16 v[60:63], v[140:143], v[212:215], v[60:63]
    s_waitcnt vmcnt(4)
    s_barrier
    s_waitcnt lgkmcnt(6)
    v_mfma_f32_16x16x32_bf16 v[64:67], v[144:147], v[200:203], v[64:67]
    ds_read_b128 v[160:163], v193 offset:0
    v_mfma_f32_16x16x32_bf16 v[68:71], v[144:147], v[204:207], v[68:71]
    ds_read_b64_tr_b16 v[128:129], v184 offset:0
    ds_read_b64_tr_b16 v[130:131], v184 offset:8192
    v_mfma_f32_16x16x32_bf16 v[72:75], v[144:147], v[208:211], v[72:75]
    v_mfma_f32_16x16x32_bf16 v[76:79], v[144:147], v[212:215], v[76:79]
    s_waitcnt lgkmcnt(7)
    v_mfma_f32_16x16x32_bf16 v[80:83], v[148:151], v[200:203], v[80:83]
    ds_read_b128 v[164:167], v193 offset:1024
    v_mfma_f32_16x16x32_bf16 v[84:87], v[148:151], v[204:207], v[84:87]
    ds_read_b64_tr_b16 v[132:133], v185 offset:0
    ds_read_b64_tr_b16 v[134:135], v185 offset:8192
    v_mfma_f32_16x16x32_bf16 v[88:91], v[148:151], v[208:211], v[88:91]
    v_mfma_f32_16x16x32_bf16 v[92:95], v[148:151], v[212:215], v[92:95]
    s_waitcnt lgkmcnt(8)
    v_mfma_f32_16x16x32_bf16 v[96:99], v[152:155], v[200:203], v[96:99]
    ds_read_b128 v[168:171], v193 offset:2048
    v_mfma_f32_16x16x32_bf16 v[100:103], v[152:155], v[204:207], v[100:103]
    ds_read_b64_tr_b16 v[136:137], v186 offset:0
    ds_read_b64_tr_b16 v[138:139], v186 offset:8192
    v_mfma_f32_16x16x32_bf16 v[104:107], v[152:155], v[208:211], v[104:107]
    v_mfma_f32_16x16x32_bf16 v[108:111], v[152:155], v[212:215], v[108:111]
    s_waitcnt lgkmcnt(9)
    v_mfma_f32_16x16x32_bf16 v[112:115], v[156:159], v[200:203], v[112:115]
    ds_read_b128 v[172:175], v193 offset:3072
    v_mfma_f32_16x16x32_bf16 v[116:119], v[156:159], v[204:207], v[116:119]
    ds_read_b64_tr_b16 v[140:141], v187 offset:0
    ds_read_b64_tr_b16 v[142:143], v187 offset:8192
    v_mfma_f32_16x16x32_bf16 v[120:123], v[156:159], v[208:211], v[120:123]
    v_mfma_f32_16x16x32_bf16 v[124:127], v[156:159], v[212:215], v[124:127]
    s_waitcnt lgkmcnt(9)
    v_mfma_f32_16x16x32_bf16 v[0:3], v[128:131], v[160:163], v[0:3]
    ds_read_b64_tr_b16 v[144:145], v188 offset:0
    ds_read_b64_tr_b16 v[146:147], v188 offset:8192
    s_waitcnt lgkmcnt(10)
    v_mfma_f32_16x16x32_bf16 v[4:7], v[128:131], v[164:167], v[4:7]
    s_waitcnt lgkmcnt(7)
    v_mfma_f32_16x16x32_bf16 v[8:11], v[128:131], v[168:171], v[8:11]
    s_waitcnt lgkmcnt(4)
    v_mfma_f32_16x16x32_bf16 v[12:15], v[128:131], v[172:175], v[12:15]
    v_mfma_f32_16x16x32_bf16 v[16:19], v[132:135], v[160:163], v[16:19]
    ds_read_b64_tr_b16 v[148:149], v189 offset:0
    ds_read_b64_tr_b16 v[150:151], v189 offset:8192
    v_mfma_f32_16x16x32_bf16 v[20:23], v[132:135], v[164:167], v[20:23]
    v_mfma_f32_16x16x32_bf16 v[24:27], v[132:135], v[168:171], v[24:27]
    v_mfma_f32_16x16x32_bf16 v[28:31], v[132:135], v[172:175], v[28:31]
    v_mfma_f32_16x16x32_bf16 v[32:35], v[136:139], v[160:163], v[32:35]
    ds_read_b64_tr_b16 v[152:153], v190 offset:0
    ds_read_b64_tr_b16 v[154:155], v190 offset:8192
    v_mfma_f32_16x16x32_bf16 v[36:39], v[136:139], v[164:167], v[36:39]
    v_mfma_f32_16x16x32_bf16 v[40:43], v[136:139], v[168:171], v[40:43]
    v_mfma_f32_16x16x32_bf16 v[44:47], v[136:139], v[172:175], v[44:47]
    s_waitcnt lgkmcnt(6)
    v_mfma_f32_16x16x32_bf16 v[48:51], v[140:143], v[160:163], v[48:51]
    ds_read_b64_tr_b16 v[156:157], v191 offset:0
    ds_read_b64_tr_b16 v[158:159], v191 offset:8192
    v_mfma_f32_16x16x32_bf16 v[52:55], v[140:143], v[164:167], v[52:55]
    v_mfma_f32_16x16x32_bf16 v[56:59], v[140:143], v[168:171], v[56:59]
    v_mfma_f32_16x16x32_bf16 v[60:63], v[140:143], v[172:175], v[60:63]
    s_waitcnt vmcnt(0)
    s_barrier
    s_waitcnt lgkmcnt(6)
    v_mfma_f32_16x16x32_bf16 v[64:67], v[144:147], v[160:163], v[64:67]
    ds_read_b128 v[200:203], v193 offset:32768
    v_mfma_f32_16x16x32_bf16 v[68:71], v[144:147], v[164:167], v[68:71]
    ds_read_b64_tr_b16 v[128:129], v184 offset:32768
    ds_read_b64_tr_b16 v[130:131], v184 offset:40960
    v_mfma_f32_16x16x32_bf16 v[72:75], v[144:147], v[168:171], v[72:75]
    v_mfma_f32_16x16x32_bf16 v[76:79], v[144:147], v[172:175], v[76:79]
    s_waitcnt lgkmcnt(7)
    v_mfma_f32_16x16x32_bf16 v[80:83], v[148:151], v[160:163], v[80:83]
    ds_read_b128 v[204:207], v193 offset:33792
    v_mfma_f32_16x16x32_bf16 v[84:87], v[148:151], v[164:167], v[84:87]
    ds_read_b64_tr_b16 v[132:133], v185 offset:32768
    ds_read_b64_tr_b16 v[134:135], v185 offset:40960
    v_mfma_f32_16x16x32_bf16 v[88:91], v[148:151], v[168:171], v[88:91]
    v_mfma_f32_16x16x32_bf16 v[92:95], v[148:151], v[172:175], v[92:95]
    s_waitcnt lgkmcnt(8)
    v_mfma_f32_16x16x32_bf16 v[96:99], v[152:155], v[160:163], v[96:99]
    ds_read_b128 v[208:211], v193 offset:34816
    v_mfma_f32_16x16x32_bf16 v[100:103], v[152:155], v[164:167], v[100:103]
    ds_read_b64_tr_b16 v[136:137], v186 offset:32768
    ds_read_b64_tr_b16 v[138:139], v186 offset:40960
    v_mfma_f32_16x16x32_bf16 v[104:107], v[152:155], v[168:171], v[104:107]
    v_mfma_f32_16x16x32_bf16 v[108:111], v[152:155], v[172:175], v[108:111]
    s_waitcnt lgkmcnt(9)
    v_mfma_f32_16x16x32_bf16 v[112:115], v[156:159], v[160:163], v[112:115]
    ds_read_b128 v[212:215], v193 offset:35840
    v_mfma_f32_16x16x32_bf16 v[116:119], v[156:159], v[164:167], v[116:119]
    ds_read_b64_tr_b16 v[140:141], v187 offset:32768
    ds_read_b64_tr_b16 v[142:143], v187 offset:40960
    v_mfma_f32_16x16x32_bf16 v[120:123], v[156:159], v[168:171], v[120:123]
    v_mfma_f32_16x16x32_bf16 v[124:127], v[156:159], v[172:175], v[124:127]
    s_waitcnt lgkmcnt(9)
    v_mfma_f32_16x16x32_bf16 v[0:3], v[128:131], v[200:203], v[0:3]
    ds_read_b64_tr_b16 v[144:145], v188 offset:32768
    ds_read_b64_tr_b16 v[146:147], v188 offset:40960
    s_waitcnt lgkmcnt(10)
    v_mfma_f32_16x16x32_bf16 v[4:7], v[128:131], v[204:207], v[4:7]
    s_waitcnt lgkmcnt(7)
    v_mfma_f32_16x16x32_bf16 v[8:11], v[128:131], v[208:211], v[8:11]
    s_waitcnt lgkmcnt(4)
    v_mfma_f32_16x16x32_bf16 v[12:15], v[128:131], v[212:215], v[12:15]
    v_mfma_f32_16x16x32_bf16 v[16:19], v[132:135], v[200:203], v[16:19]
    ds_read_b64_tr_b16 v[148:149], v189 offset:32768
    ds_read_b64_tr_b16 v[150:151], v189 offset:40960
    v_mfma_f32_16x16x32_bf16 v[20:23], v[132:135], v[204:207], v[20:23]
    v_mfma_f32_16x16x32_bf16 v[24:27], v[132:135], v[208:211], v[24:27]
    v_mfma_f32_16x16x32_bf16 v[28:31], v[132:135], v[212:215], v[28:31]
    v_mfma_f32_16x16x32_bf16 v[32:35], v[136:139], v[200:203], v[32:35]
    ds_read_b64_tr_b16 v[152:153], v190 offset:32768
    ds_read_b64_tr_b16 v[154:155], v190 offset:40960
    v_mfma_f32_16x16x32_bf16 v[36:39], v[136:139], v[204:207], v[36:39]
    v_mfma_f32_16x16x32_bf16 v[40:43], v[136:139], v[208:211], v[40:43]
    v_mfma_f32_16x16x32_bf16 v[44:47], v[136:139], v[212:215], v[44:47]
    s_waitcnt lgkmcnt(6)
    v_mfma_f32_16x16x32_bf16 v[48:51], v[140:143], v[200:203], v[48:51]
    ds_read_b64_tr_b16 v[156:157], v191 offset:32768
    ds_read_b64_tr_b16 v[158:159], v191 offset:40960
    v_mfma_f32_16x16x32_bf16 v[52:55], v[140:143], v[204:207], v[52:55]
    v_mfma_f32_16x16x32_bf16 v[56:59], v[140:143], v[208:211], v[56:59]
    v_mfma_f32_16x16x32_bf16 v[60:63], v[140:143], v[212:215], v[60:63]
    s_waitcnt lgkmcnt(6)
    v_mfma_f32_16x16x32_bf16 v[64:67], v[144:147], v[200:203], v[64:67]
    v_mfma_f32_16x16x32_bf16 v[68:71], v[144:147], v[204:207], v[68:71]
    v_mfma_f32_16x16x32_bf16 v[72:75], v[144:147], v[208:211], v[72:75]
    v_mfma_f32_16x16x32_bf16 v[76:79], v[144:147], v[212:215], v[76:79]
    s_waitcnt lgkmcnt(4)
    v_mfma_f32_16x16x32_bf16 v[80:83], v[148:151], v[200:203], v[80:83]
    v_mfma_f32_16x16x32_bf16 v[84:87], v[148:151], v[204:207], v[84:87]
    v_mfma_f32_16x16x32_bf16 v[88:91], v[148:151], v[208:211], v[88:91]
    v_mfma_f32_16x16x32_bf16 v[92:95], v[148:151], v[212:215], v[92:95]
    s_waitcnt lgkmcnt(2)
    v_mfma_f32_16x16x32_bf16 v[96:99], v[152:155], v[200:203], v[96:99]
    v_mfma_f32_16x16x32_bf16 v[100:103], v[152:155], v[204:207], v[100:103]
    v_mfma_f32_16x16x32_bf16 v[104:107], v[152:155], v[208:211], v[104:107]
    v_mfma_f32_16x16x32_bf16 v[108:111], v[152:155], v[212:215], v[108:111]
    s_waitcnt lgkmcnt(0)
    v_mfma_f32_16x16x32_bf16 v[112:115], v[156:159], v[200:203], v[112:115]
    v_mfma_f32_16x16x32_bf16 v[116:119], v[156:159], v[204:207], v[116:119]
    v_mfma_f32_16x16x32_bf16 v[120:123], v[156:159], v[208:211], v[120:123]
    v_mfma_f32_16x16x32_bf16 v[124:127], v[156:159], v[212:215], v[124:127]
    s_nop 7
    s_nop 1
    s_cmp_eq_u32 s38, 3
    s_cbranch_scc1 W_F
    s_add_u32 s20, s6, 0x400000
    s_addc_u32 s21, s7, 0
    s_mov_b32 s22, 0x1000000
    s_mov_b32 s23, 0x20000
    s_lshl_b32 s47, s28, 4
    s_lshl_b32 s54, s52, 2
    s_add_u32 s47, s47, s54
    s_lshl_b32 s47, s47, 5
    s_lshl_b32 s54, s39, 1
    s_add_u32 s54, s54, s53
    s_add_u32 s47, s47, s54
    s_lshl_b32 s47, s47, 12
    v_cvt_pk_bf16_f32 v128, v0, v1
    v_cvt_pk_bf16_f32 v129, v2, v3
    v_cvt_pk_bf16_f32 v130, v16, v17
    v_cvt_pk_bf16_f32 v131, v18, v19
    buffer_store_dwordx4 v[128:131], v197, s[20:23], s47 offen offset:0 sc1
    v_cvt_pk_bf16_f32 v132, v32, v33
    v_cvt_pk_bf16_f32 v133, v34, v35
    v_cvt_pk_bf16_f32 v134, v48, v49
    v_cvt_pk_bf16_f32 v135, v50, v51
    buffer_store_dwordx4 v[132:135], v197, s[20:23], s47 offen offset:1024 sc1
    v_cvt_pk_bf16_f32 v136, v64, v65
    v_cvt_pk_bf16_f32 v137, v66, v67
    v_cvt_pk_bf16_f32 v138, v80, v81
    v_cvt_pk_bf16_f32 v139, v82, v83
    buffer_store_dwordx4 v[136:139], v197, s[20:23], s47 offen offset:2048 sc1
    v_cvt_pk_bf16_f32 v140, v96, v97
    v_cvt_pk_bf16_f32 v141, v98, v99
    v_cvt_pk_bf16_f32 v142, v112, v113
    v_cvt_pk_bf16_f32 v143, v114, v115
    buffer_store_dwordx4 v[140:143], v197, s[20:23], s47 offen offset:3072 sc1
    s_add_u32 s47, s47, 131072
    v_cvt_pk_bf16_f32 v128, v4, v5
    v_cvt_pk_bf16_f32 v129, v6, v7
    v_cvt_pk_bf16_f32 v130, v20, v21
    v_cvt_pk_bf16_f32 v131, v22, v23
    buffer_store_dwordx4 v[128:131], v197, s[20:23], s47 offen offset:0 sc1
    v_cvt_pk_bf16_f32 v132, v36, v37
    v_cvt_pk_bf16_f32 v133, v38, v39
    v_cvt_pk_bf16_f32 v134, v52, v53
    v_cvt_pk_bf16_f32 v135, v54, v55
    buffer_store_dwordx4 v[132:135], v197, s[20:23], s47 offen offset:1024 sc1
    v_cvt_pk_bf16_f32 v136, v68, v69
    v_cvt_pk_bf16_f32 v137, v70, v71
    v_cvt_pk_bf16_f32 v138, v84, v85
    v_cvt_pk_bf16_f32 v139, v86, v87
    buffer_store_dwordx4 v[136:139], v197, s[20:23], s47 offen offset:2048 sc1
    v_cvt_pk_bf16_f32 v140, v100, v101
    v_cvt_pk_bf16_f32 v141, v102, v103
    v_cvt_pk_bf16_f32 v142, v116, v117
    v_cvt_pk_bf16_f32 v143, v118, v119
    buffer_store_dwordx4 v[140:143], v197, s[20:23], s47 offen offset:3072 sc1
    s_add_u32 s47, s47, 131072
    v_cvt_pk_bf16_f32 v128, v8, v9
    v_cvt_pk_bf16_f32 v129, v10, v11
    v_cvt_pk_bf16_f32 v130, v24, v25
    v_cvt_pk_bf16_f32 v131, v26, v27
    buffer_store_dwordx4 v[128:131], v197, s[20:23], s47 offen offset:0 sc1
    v_cvt_pk_bf16_f32 v132, v40, v41
    v_cvt_pk_bf16_f32 v133, v42, v43
    v_cvt_pk_bf16_f32 v134, v56, v57
    v_cvt_pk_bf16_f32 v135, v58, v59
    buffer_store_dwordx4 v[132:135], v197, s[20:23], s47 offen offset:1024 sc1
    v_cvt_pk_bf16_f32 v136, v72, v73
    v_cvt_pk_bf16_f32 v137, v74, v75
    v_cvt_pk_bf16_f32 v138, v88, v89
    v_cvt_pk_bf16_f32 v139, v90, v91
    buffer_store_dwordx4 v[136:139], v197, s[20:23], s47 offen offset:2048 sc1
    v_cvt_pk_bf16_f32 v140, v104, v105
    v_cvt_pk_bf16_f32 v141, v106, v107
    v_cvt_pk_bf16_f32 v142, v120, v121
    v_cvt_pk_bf16_f32 v143, v122, v123
    buffer_store_dwordx4 v[140:143], v197, s[20:23], s47 offen offset:3072 sc1
    s_add_u32 s47, s47, 131072
    v_cvt_pk_bf16_f32 v128, v12, v13
    v_cvt_pk_bf16_f32 v129, v14, v15
    v_cvt_pk_bf16_f32 v130, v28, v29
    v_cvt_pk_bf16_f32 v131, v30, v31
    buffer_store_dwordx4 v[128:131], v197, s[20:23], s47 offen offset:0 sc1
    v_cvt_pk_bf16_f32 v132, v44, v45
    v_cvt_pk_bf16_f32 v133, v46, v47
    v_cvt_pk_bf16_f32 v134, v60, v61
    v_cvt_pk_bf16_f32 v135, v62, v63
    buffer_store_dwordx4 v[132:135], v197, s[20:23], s47 offen offset:1024 sc1
    v_cvt_pk_bf16_f32 v136, v76, v77
    v_cvt_pk_bf16_f32 v137, v78, v79
    v_cvt_pk_bf16_f32 v138, v92, v93
    v_cvt_pk_bf16_f32 v139, v94, v95
    buffer_store_dwordx4 v[136:139], v197, s[20:23], s47 offen offset:2048 sc1
    v_cvt_pk_bf16_f32 v140, v108, v109
    v_cvt_pk_bf16_f32 v141, v110, v111
    v_cvt_pk_bf16_f32 v142, v124, v125
    v_cvt_pk_bf16_f32 v143, v126, v127
    buffer_store_dwordx4 v[140:143], v197, s[20:23], s47 offen offset:3072 sc1
    s_branch W_next
W_F:
    s_add_u32 s20, s6, 0x3400000
    s_addc_u32 s21, s7, 0
    s_mov_b32 s22, 0x6c0000
    s_mov_b32 s23, 0x20000
    s_mov_b32 s24, s50
    s_mov_b32 s25, s51
    s_mov_b32 s26, 0xd80
    s_mov_b32 s27, 0x20000
    v_lshrrev_b32 v251, 8, v197
    v_lshlrev_b32 v251, 3, v251
    s_lshl_b32 s47, s53, 8
    s_add_u32 s47, s47, s46
    buffer_load_dwordx2 v[128:129], v251, s[24:27], s47 offen offset:0
    buffer_load_dwordx2 v[130:131], v251, s[24:27], s47 offen offset:32
    buffer_load_dwordx2 v[132:133], v251, s[24:27], s47 offen offset:64
    buffer_load_dwordx2 v[134:135], v251, s[24:27], s47 offen offset:96
    buffer_load_dwordx2 v[136:137], v251, s[24:27], s47 offen offset:128
    buffer_load_dwordx2 v[138:139], v251, s[24:27], s47 offen offset:160
    buffer_load_dwordx2 v[140:141], v251, s[24:27], s47 offen offset:192
    buffer_load_dwordx2 v[142:143], v251, s[24:27], s47 offen offset:224
    s_waitcnt vmcnt(0)
    v_lshlrev_b32 v216, 16, v128
    v_and_b32 v217, 0xffff0000, v128
    v_lshlrev_b32 v218, 16, v129
    v_and_b32 v219, 0xffff0000, v129
    v_lshlrev_b32 v220, 16, v130
    v_and_b32 v221, 0xffff0000, v130
    v_lshlrev_b32 v222, 16, v131
    v_and_b32 v223, 0xffff0000, v131
    v_lshlrev_b32 v224, 16, v132
    v_and_b32 v225, 0xffff0000, v132
    v_lshlrev_b32 v226, 16, v133
    v_and_b32 v227, 0xffff0000, v133
    v_lshlrev_b32 v228, 16, v134
    v_and_b32 v229, 0xffff0000, v134
    v_lshlrev_b32 v230, 16, v135
    v_and_b32 v231, 0xffff0000, v135
    v_lshlrev_b32 v232, 16, v136
    v_and_b32 v233, 0xffff0000, v136
    v_lshlrev_b32 v234, 16, v137
    v_and_b32 v235, 0xffff0000, v137
    v_lshlrev_b32 v236, 16, v138
    v_and_b32 v237, 0xffff0000, v138
    v_lshlrev_b32 v238, 16, v139
    v_and_b32 v239, 0xffff0000, v139
    v_lshlrev_b32 v240, 16, v140
    v_and_b32 v241, 0xffff0000, v140
    v_lshlrev_b32 v242, 16, v141
    v_and_b32 v243, 0xffff0000, v141
    v_lshlrev_b32 v244, 16, v142
    v_and_b32 v245, 0xffff0000, v142
    v_lshlrev_b32 v246, 16, v143
    v_and_b32 v247, 0xffff0000, v143
    s_lshl_b32 s47, s28, 4
    s_lshl_b32 s54, s52, 2
    s_add_u32 s47, s47, s54
    s_mul_i32 s47, s47, 54
    s_lshl_b32 s54, s39, 3
    s_lshl_b32 s55, s53, 2
    s_add_u32 s54, s54, s55
    s_add_u32 s47, s47, s54
    s_lshl_b32 s47, s47, 10
    s_mov_b32 s55, s47
    v_cvt_pk_bf16_f32 v250, v0, v1
    v_lshlrev_b32 v248, 16, v250
    v_and_b32 v249, 0xffff0000, v250
    v_add_f32 v248, v248, v216
    v_add_f32 v249, v249, v217
    v_cvt_pk_bf16_f32 v250, v248, v249
    v_lshlrev_b32 v248, 16, v250
    v_and_b32 v249, 0xffff0000, v250
    v_max_f32 v248, 0, v248
    v_max_f32 v249, 0, v249
    v_mul_f32 v248, v248, v248
    v_mul_f32 v249, v249, v249
    v_cvt_pk_bf16_f32 v128, v248, v249
    v_cvt_pk_bf16_f32 v250, v2, v3
    v_lshlrev_b32 v248, 16, v250
    v_and_b32 v249, 0xffff0000, v250
    v_add_f32 v248, v248, v218
    v_add_f32 v249, v249, v219
    v_cvt_pk_bf16_f32 v250, v248, v249
    v_lshlrev_b32 v248, 16, v250
    v_and_b32 v249, 0xffff0000, v250
    v_max_f32 v248, 0, v248
    v_max_f32 v249, 0, v249
    v_mul_f32 v248, v248, v248
    v_mul_f32 v249, v249, v249
    v_cvt_pk_bf16_f32 v129, v248, v249
    v_cvt_pk_bf16_f32 v250, v16, v17
    v_lshlrev_b32 v248, 16, v250
    v_and_b32 v249, 0xffff0000, v250
    v_add_f32 v248, v248, v220
    v_add_f32 v249, v249, v221
    v_cvt_pk_bf16_f32 v250, v248, v249
    v_lshlrev_b32 v248, 16, v250
    v_and_b32 v249, 0xffff0000, v250
    v_max_f32 v248, 0, v248
    v_max_f32 v249, 0, v249
    v_mul_f32 v248, v248, v248
    v_mul_f32 v249, v249, v249
    v_cvt_pk_bf16_f32 v130, v248, v249
    v_cvt_pk_bf16_f32 v250, v18, v19
    v_lshlrev_b32 v248, 16, v250
    v_and_b32 v249, 0xffff0000, v250
    v_add_f32 v248, v248, v222
    v_add_f32 v249, v249, v223
    v_cvt_pk_bf16_f32 v250, v248, v249
    v_lshlrev_b32 v248, 16, v250
    v_and_b32 v249, 0xffff0000, v250
    v_max_f32 v248, 0, v248
    v_max_f32 v249, 0, v249
    v_mul_f32 v248, v248, v248
    v_mul_f32 v249, v249, v249
    v_cvt_pk_bf16_f32 v131, v248, v249
    buffer_store_dwordx4 v[128:131], v197, s[20:23], s55 offen offset:0 sc1
    s_add_u32 s55, s55, 55296
    v_cvt_pk_bf16_f32 v250, v4, v5
    v_lshlrev_b32 v248, 16, v250
    v_and_b32 v249, 0xffff0000, v250
    v_add_f32 v248, v248, v216
    v_add_f32 v249, v249, v217
    v_cvt_pk_bf16_f32 v250, v248, v249
    v_lshlrev_b32 v248, 16, v250
    v_and_b32 v249, 0xffff0000, v250
    v_max_f32 v248, 0, v248
    v_max_f32 v249, 0, v249
    v_mul_f32 v248, v248, v248
    v_mul_f32 v249, v249, v249
    v_cvt_pk_bf16_f32 v132, v248, v249
    v_cvt_pk_bf16_f32 v250, v6, v7
    v_lshlrev_b32 v248, 16, v250
    v_and_b32 v249, 0xffff0000, v250
    v_add_f32 v248, v248, v218
    v_add_f32 v249, v249, v219
    v_cvt_pk_bf16_f32 v250, v248, v249
    v_lshlrev_b32 v248, 16, v250
    v_and_b32 v249, 0xffff0000, v250
    v_max_f32 v248, 0, v248
    v_max_f32 v249, 0, v249
    v_mul_f32 v248, v248, v248
    v_mul_f32 v249, v249, v249
    v_cvt_pk_bf16_f32 v133, v248, v249
    v_cvt_pk_bf16_f32 v250, v20, v21
    v_lshlrev_b32 v248, 16, v250
    v_and_b32 v249, 0xffff0000, v250
    v_add_f32 v248, v248, v220
    v_add_f32 v249, v249, v221
    v_cvt_pk_bf16_f32 v250, v248, v249
    v_lshlrev_b32 v248, 16, v250
    v_and_b32 v249, 0xffff0000, v250
    v_max_f32 v248, 0, v248
    v_max_f32 v249, 0, v249
    v_mul_f32 v248, v248, v248
    v_mul_f32 v249, v249, v249
    v_cvt_pk_bf16_f32 v134, v248, v249
    v_cvt_pk_bf16_f32 v250, v22, v23
    v_lshlrev_b32 v248, 16, v250
    v_and_b32 v249, 0xffff0000, v250
    v_add_f32 v248, v248, v222
    v_add_f32 v249, v249, v223
    v_cvt_pk_bf16_f32 v250, v248, v249
    v_lshlrev_b32 v248, 16, v250
    v_and_b32 v249, 0xffff0000, v250
    v_max_f32 v248, 0, v248
    v_max_f32 v249, 0, v249
    v_mul_f32 v248, v248, v248
    v_mul_f32 v249, v249, v249
    v_cvt_pk_bf16_f32 v135, v248, v249
    buffer_store_dwordx4 v[132:135], v197, s[20:23], s55 offen offset:0 sc1
    s_add_u32 s55, s55, 55296
    v_cvt_pk_bf16_f32 v250, v8, v9
    v_lshlrev_b32 v248, 16, v250
    v_and_b32 v249, 0xffff0000, v250
    v_add_f32 v248, v248, v216
    v_add_f32 v249, v249, v217
    v_cvt_pk_bf16_f32 v250, v248, v249
    v_lshlrev_b32 v248, 16, v250
    v_and_b32 v249, 0xffff0000, v250
    v_max_f32 v248, 0, v248
    v_max_f32 v249, 0, v249
    v_mul_f32 v248, v248, v248
    v_mul_f32 v249, v249, v249
    v_cvt_pk_bf16_f32 v136, v248, v249
    v_cvt_pk_bf16_f32 v250, v10, v11
    v_lshlrev_b32 v248, 16, v250
    v_and_b32 v249, 0xffff0000, v250
    v_add_f32 v248, v248, v218
    v_add_f32 v249, v249, v219
    v_cvt_pk_bf16_f32 v250, v248, v249
    v_lshlrev_b32 v248, 16, v250
    v_and_b32 v249, 0xffff0000, v250
    v_max_f32 v248, 0, v248
    v_max_f32 v249, 0, v249
    v_mul_f32 v248, v248, v248
    v_mul_f32 v249, v249, v249
    v_cvt_pk_bf16_f32 v137, v248, v249
    v_cvt_pk_bf16_f32 v250, v24, v25
    v_lshlrev_b32 v248, 16, v250
    v_and_b32 v249, 0xffff0000, v250
    v_add_f32 v248, v248, v220
    v_add_f32 v249, v249, v221
    v_cvt_pk_bf16_f32 v250, v248, v249
    v_lshlrev_b32 v248, 16, v250
    v_and_b32 v249, 0xffff0000, v250
    v_max_f32 v248, 0, v248
    v_max_f32 v249, 0, v249
    v_mul_f32 v248, v248, v248
    v_mul_f32 v249, v249, v249
    v_cvt_pk_bf16_f32 v138, v248, v249
    v_cvt_pk_bf16_f32 v250, v26, v27
    v_lshlrev_b32 v248, 16, v250
    v_and_b32 v249, 0xffff0000, v250
    v_add_f32 v248, v248, v222
    v_add_f32 v249, v249, v223
    v_cvt_pk_bf16_f32 v250, v248, v249
    v_lshlrev_b32 v248, 16, v250
    v_and_b32 v249, 0xffff0000, v250
    v_max_f32 v248, 0, v248
    v_max_f32 v249, 0, v249
    v_mul_f32 v248, v248, v248
    v_mul_f32 v249, v249, v249
    v_cvt_pk_bf16_f32 v139, v248, v249
    buffer_store_dwordx4 v[136:139], v197, s[20:23], s55 offen offset:0 sc1
    s_add_u32 s55, s55, 55296
    v_cvt_pk_bf16_f32 v250, v12, v13
    v_lshlrev_b32 v248, 16, v250
    v_and_b32 v249, 0xffff0000, v250
    v_add_f32 v248, v248, v216
    v_add_f32 v249, v249, v217
    v_cvt_pk_bf16_f32 v250, v248, v249
    v_lshlrev_b32 v248, 16, v250
    v_and_b32 v249, 0xffff0000, v250
    v_max_f32 v248, 0, v248
    v_max_f32 v249, 0, v249
    v_mul_f32 v248, v248, v248
    v_mul_f32 v249, v249, v249
    v_cvt_pk_bf16_f32 v140, v248, v249
    v_cvt_pk_bf16_f32 v250, v14, v15
    v_lshlrev_b32 v248, 16, v250
    v_and_b32 v249, 0xffff0000, v250
    v_add_f32 v248, v248, v218
    v_add_f32 v249, v249, v219
    v_cvt_pk_bf16_f32 v250, v248, v249
    v_lshlrev_b32 v248, 16, v250
    v_and_b32 v249, 0xffff0000, v250
    v_max_f32 v248, 0, v248
    v_max_f32 v249, 0, v249
    v_mul_f32 v248, v248, v248
    v_mul_f32 v249, v249, v249
    v_cvt_pk_bf16_f32 v141, v248, v249
    v_cvt_pk_bf16_f32 v250, v28, v29
    v_lshlrev_b32 v248, 16, v250
    v_and_b32 v249, 0xffff0000, v250
    v_add_f32 v248, v248, v220
    v_add_f32 v249, v249, v221
    v_cvt_pk_bf16_f32 v250, v248, v249
    v_lshlrev_b32 v248, 16, v250
    v_and_b32 v249, 0xffff0000, v250
    v_max_f32 v248, 0, v248
    v_max_f32 v249, 0, v249
    v_mul_f32 v248, v248, v248
    v_mul_f32 v249, v249, v249
    v_cvt_pk_bf16_f32 v142, v248, v249
    v_cvt_pk_bf16_f32 v250, v30, v31
    v_lshlrev_b32 v248, 16, v250
    v_and_b32 v249, 0xffff0000, v250
    v_add_f32 v248, v248, v222
    v_add_f32 v249, v249, v223
    v_cvt_pk_bf16_f32 v250, v248, v249
    v_lshlrev_b32 v248, 16, v250
    v_and_b32 v249, 0xffff0000, v250
    v_max_f32 v248, 0, v248
    v_max_f32 v249, 0, v249
    v_mul_f32 v248, v248, v248
    v_mul_f32 v249, v249, v249
    v_cvt_pk_bf16_f32 v143, v248, v249
    buffer_store_dwordx4 v[140:143], v197, s[20:23], s55 offen offset:0 sc1
    s_mov_b32 s55, s47
    v_cvt_pk_bf16_f32 v250, v32, v33
    v_lshlrev_b32 v248, 16, v250
    v_and_b32 v249, 0xffff0000, v250
    v_add_f32 v248, v248, v224
    v_add_f32 v249, v249, v225
    v_cvt_pk_bf16_f32 v250, v248, v249
    v_lshlrev_b32 v248, 16, v250
    v_and_b32 v249, 0xffff0000, v250
    v_max_f32 v248, 0, v248
    v_max_f32 v249, 0, v249
    v_mul_f32 v248, v248, v248
    v_mul_f32 v249, v249, v249
    v_cvt_pk_bf16_f32 v128, v248, v249
    v_cvt_pk_bf16_f32 v250, v34, v35
    v_lshlrev_b32 v248, 16, v250
    v_and_b32 v249, 0xffff0000, v250
    v_add_f32 v248, v248, v226
    v_add_f32 v249, v249, v227
    v_cvt_pk_bf16_f32 v250, v248, v249
    v_lshlrev_b32 v248, 16, v250
    v_and_b32 v249, 0xffff0000, v250
    v_max_f32 v248, 0, v248
    v_max_f32 v249, 0, v249
    v_mul_f32 v248, v248, v248
    v_mul_f32 v249, v249, v249
    v_cvt_pk_bf16_f32 v129, v248, v249
    v_cvt_pk_bf16_f32 v250, v48, v49
    v_lshlrev_b32 v248, 16, v250
    v_and_b32 v249, 0xffff0000, v250
    v_add_f32 v248, v248, v228
    v_add_f32 v249, v249, v229
    v_cvt_pk_bf16_f32 v250, v248, v249
    v_lshlrev_b32 v248, 16, v250
    v_and_b32 v249, 0xffff0000, v250
    v_max_f32 v248, 0, v248
    v_max_f32 v249, 0, v249
    v_mul_f32 v248, v248, v248
    v_mul_f32 v249, v249, v249
    v_cvt_pk_bf16_f32 v130, v248, v249
    v_cvt_pk_bf16_f32 v250, v50, v51
    v_lshlrev_b32 v248, 16, v250
    v_and_b32 v249, 0xffff0000, v250
    v_add_f32 v248, v248, v230
    v_add_f32 v249, v249, v231
    v_cvt_pk_bf16_f32 v250, v248, v249
    v_lshlrev_b32 v248, 16, v250
    v_and_b32 v249, 0xffff0000, v250
    v_max_f32 v248, 0, v248
    v_max_f32 v249, 0, v249
    v_mul_f32 v248, v248, v248
    v_mul_f32 v249, v249, v249
    v_cvt_pk_bf16_f32 v131, v248, v249
    buffer_store_dwordx4 v[128:131], v197, s[20:23], s55 offen offset:1024 sc1
    s_add_u32 s55, s55, 55296
    v_cvt_pk_bf16_f32 v250, v36, v37
    v_lshlrev_b32 v248, 16, v250
    v_and_b32 v249, 0xffff0000, v250
    v_add_f32 v248, v248, v224
    v_add_f32 v249, v249, v225
    v_cvt_pk_bf16_f32 v250, v248, v249
    v_lshlrev_b32 v248, 16, v250
    v_and_b32 v249, 0xffff0000, v250
    v_max_f32 v248, 0, v248
    v_max_f32 v249, 0, v249
    v_mul_f32 v248, v248, v248
    v_mul_f32 v249, v249, v249
    v_cvt_pk_bf16_f32 v132, v248, v249
    v_cvt_pk_bf16_f32 v250, v38, v39
    v_lshlrev_b32 v248, 16, v250
    v_and_b32 v249, 0xffff0000, v250
    v_add_f32 v248, v248, v226
    v_add_f32 v249, v249, v227
    v_cvt_pk_bf16_f32 v250, v248, v249
    v_lshlrev_b32 v248, 16, v250
    v_and_b32 v249, 0xffff0000, v250
    v_max_f32 v248, 0, v248
    v_max_f32 v249, 0, v249
    v_mul_f32 v248, v248, v248
    v_mul_f32 v249, v249, v249
    v_cvt_pk_bf16_f32 v133, v248, v249
    v_cvt_pk_bf16_f32 v250, v52, v53
    v_lshlrev_b32 v248, 16, v250
    v_and_b32 v249, 0xffff0000, v250
    v_add_f32 v248, v248, v228
    v_add_f32 v249, v249, v229
    v_cvt_pk_bf16_f32 v250, v248, v249
    v_lshlrev_b32 v248, 16, v250
    v_and_b32 v249, 0xffff0000, v250
    v_max_f32 v248, 0, v248
    v_max_f32 v249, 0, v249
    v_mul_f32 v248, v248, v248
    v_mul_f32 v249, v249, v249
    v_cvt_pk_bf16_f32 v134, v248, v249
    v_cvt_pk_bf16_f32 v250, v54, v55
    v_lshlrev_b32 v248, 16, v250
    v_and_b32 v249, 0xffff0000, v250
    v_add_f32 v248, v248, v230
    v_add_f32 v249, v249, v231
    v_cvt_pk_bf16_f32 v250, v248, v249
    v_lshlrev_b32 v248, 16, v250
    v_and_b32 v249, 0xffff0000, v250
    v_max_f32 v248, 0, v248
    v_max_f32 v249, 0, v249
    v_mul_f32 v248, v248, v248
    v_mul_f32 v249, v249, v249
    v_cvt_pk_bf16_f32 v135, v248, v249
    buffer_store_dwordx4 v[132:135], v197, s[20:23], s55 offen offset:1024 sc1
    s_add_u32 s55, s55, 55296
    v_cvt_pk_bf16_f32 v250, v40, v41
    v_lshlrev_b32 v248, 16, v250
    v_and_b32 v249, 0xffff0000, v250
    v_add_f32 v248, v248, v224
    v_add_f32 v249, v249, v225
    v_cvt_pk_bf16_f32 v250, v248, v249
    v_lshlrev_b32 v248, 16, v250
    v_and_b32 v249, 0xffff0000, v250
    v_max_f32 v248, 0, v248
    v_max_f32 v249, 0, v249
    v_mul_f32 v248, v248, v248
    v_mul_f32 v249, v249, v249
    v_cvt_pk_bf16_f32 v136, v248, v249
    v_cvt_pk_bf16_f32 v250, v42, v43
    v_lshlrev_b32 v248, 16, v250
    v_and_b32 v249, 0xffff0000, v250
    v_add_f32 v248, v248, v226
    v_add_f32 v249, v249, v227
    v_cvt_pk_bf16_f32 v250, v248, v249
    v_lshlrev_b32 v248, 16, v250
    v_and_b32 v249, 0xffff0000, v250
    v_max_f32 v248, 0, v248
    v_max_f32 v249, 0, v249
    v_mul_f32 v248, v248, v248
    v_mul_f32 v249, v249, v249
    v_cvt_pk_bf16_f32 v137, v248, v249
    v_cvt_pk_bf16_f32 v250, v56, v57
    v_lshlrev_b32 v248, 16, v250
    v_and_b32 v249, 0xffff0000, v250
    v_add_f32 v248, v248, v228
    v_add_f32 v249, v249, v229
    v_cvt_pk_bf16_f32 v250, v248, v249
    v_lshlrev_b32 v248, 16, v250
    v_and_b32 v249, 0xffff0000, v250
    v_max_f32 v248, 0, v248
    v_max_f32 v249, 0, v249
    v_mul_f32 v248, v248, v248
    v_mul_f32 v249, v249, v249
    v_cvt_pk_bf16_f32 v138, v248, v249
    v_cvt_pk_bf16_f32 v250, v58, v59
    v_lshlrev_b32 v248, 16, v250
    v_and_b32 v249, 0xffff0000, v250
    v_add_f32 v248, v248, v230
    v_add_f32 v249, v249, v231
    v_cvt_pk_bf16_f32 v250, v248, v249
    v_lshlrev_b32 v248, 16, v250
    v_and_b32 v249, 0xffff0000, v250
    v_max_f32 v248, 0, v248
    v_max_f32 v249, 0, v249
    v_mul_f32 v248, v248, v248
    v_mul_f32 v249, v249, v249
    v_cvt_pk_bf16_f32 v139, v248, v249
    buffer_store_dwordx4 v[136:139], v197, s[20:23], s55 offen offset:1024 sc1
    s_add_u32 s55, s55, 55296
    v_cvt_pk_bf16_f32 v250, v44, v45
    v_lshlrev_b32 v248, 16, v250
    v_and_b32 v249, 0xffff0000, v250
    v_add_f32 v248, v248, v224
    v_add_f32 v249, v249, v225
    v_cvt_pk_bf16_f32 v250, v248, v249
    v_lshlrev_b32 v248, 16, v250
    v_and_b32 v249, 0xffff0000, v250
    v_max_f32 v248, 0, v248
    v_max_f32 v249, 0, v249
    v_mul_f32 v248, v248, v248
    v_mul_f32 v249, v249, v249
    v_cvt_pk_bf16_f32 v140, v248, v249
    v_cvt_pk_bf16_f32 v250, v46, v47
    v_lshlrev_b32 v248, 16, v250
    v_and_b32 v249, 0xffff0000, v250
    v_add_f32 v248, v248, v226
    v_add_f32 v249, v249, v227
    v_cvt_pk_bf16_f32 v250, v248, v249
    v_lshlrev_b32 v248, 16, v250
    v_and_b32 v249, 0xffff0000, v250
    v_max_f32 v248, 0, v248
    v_max_f32 v249, 0, v249
    v_mul_f32 v248, v248, v248
    v_mul_f32 v249, v249, v249
    v_cvt_pk_bf16_f32 v141, v248, v249
    v_cvt_pk_bf16_f32 v250, v60, v61
    v_lshlrev_b32 v248, 16, v250
    v_and_b32 v249, 0xffff0000, v250
    v_add_f32 v248, v248, v228
    v_add_f32 v249, v249, v229
    v_cvt_pk_bf16_f32 v250, v248, v249
    v_lshlrev_b32 v248, 16, v250
    v_and_b32 v249, 0xffff0000, v250
    v_max_f32 v248, 0, v248
    v_max_f32 v249, 0, v249
    v_mul_f32 v248, v248, v248
    v_mul_f32 v249, v249, v249
    v_cvt_pk_bf16_f32 v142, v248, v249
    v_cvt_pk_bf16_f32 v250, v62, v63
    v_lshlrev_b32 v248, 16, v250
    v_and_b32 v249, 0xffff0000, v250
    v_add_f32 v248, v248, v230
    v_add_f32 v249, v249, v231
    v_cvt_pk_bf16_f32 v250, v248, v249
    v_lshlrev_b32 v248, 16, v250
    v_and_b32 v249, 0xffff0000, v250
    v_max_f32 v248, 0, v248
    v_max_f32 v249, 0, v249
    v_mul_f32 v248, v248, v248
    v_mul_f32 v249, v249, v249
    v_cvt_pk_bf16_f32 v143, v248, v249
    buffer_store_dwordx4 v[140:143], v197, s[20:23], s55 offen offset:1024 sc1
    s_cmp_ge_u32 s54, 52
    s_cbranch_scc1 W_next
    s_mov_b32 s55, s47
    v_cvt_pk_bf16_f32 v250, v64, v65
    v_lshlrev_b32 v248, 16, v250
    v_and_b32 v249, 0xffff0000, v250
    v_add_f32 v248, v248, v232
    v_add_f32 v249, v249, v233
    v_cvt_pk_bf16_f32 v250, v248, v249
    v_lshlrev_b32 v248, 16, v250
    v_and_b32 v249, 0xffff0000, v250
    v_max_f32 v248, 0, v248
    v_max_f32 v249, 0, v249
    v_mul_f32 v248, v248, v248
    v_mul_f32 v249, v249, v249
    v_cvt_pk_bf16_f32 v128, v248, v249
    v_cvt_pk_bf16_f32 v250, v66, v67
    v_lshlrev_b32 v248, 16, v250
    v_and_b32 v249, 0xffff0000, v250
    v_add_f32 v248, v248, v234
    v_add_f32 v249, v249, v235
    v_cvt_pk_bf16_f32 v250, v248, v249
    v_lshlrev_b32 v248, 16, v250
    v_and_b32 v249, 0xffff0000, v250
    v_max_f32 v248, 0, v248
    v_max_f32 v249, 0, v249
    v_mul_f32 v248, v248, v248
    v_mul_f32 v249, v249, v249
    v_cvt_pk_bf16_f32 v129, v248, v249
    v_cvt_pk_bf16_f32 v250, v80, v81
    v_lshlrev_b32 v248, 16, v250
    v_and_b32 v249, 0xffff0000, v250
    v_add_f32 v248, v248, v236
    v_add_f32 v249, v249, v237
    v_cvt_pk_bf16_f32 v250, v248, v249
    v_lshlrev_b32 v248, 16, v250
    v_and_b32 v249, 0xffff0000, v250
    v_max_f32 v248, 0, v248
    v_max_f32 v249, 0, v249
    v_mul_f32 v248, v248, v248
    v_mul_f32 v249, v249, v249
    v_cvt_pk_bf16_f32 v130, v248, v249
    v_cvt_pk_bf16_f32 v250, v82, v83
    v_lshlrev_b32 v248, 16, v250
    v_and_b32 v249, 0xffff0000, v250
    v_add_f32 v248, v248, v238
    v_add_f32 v249, v249, v239
    v_cvt_pk_bf16_f32 v250, v248, v249
    v_lshlrev_b32 v248, 16, v250
    v_and_b32 v249, 0xffff0000, v250
    v_max_f32 v248, 0, v248
    v_max_f32 v249, 0, v249
    v_mul_f32 v248, v248, v248
    v_mul_f32 v249, v249, v249
    v_cvt_pk_bf16_f32 v131, v248, v249
    buffer_store_dwordx4 v[128:131], v197, s[20:23], s55 offen offset:2048 sc1
    s_add_u32 s55, s55, 55296
    v_cvt_pk_bf16_f32 v250, v68, v69
    v_lshlrev_b32 v248, 16, v250
    v_and_b32 v249, 0xffff0000, v250
    v_add_f32 v248, v248, v232
    v_add_f32 v249, v249, v233
    v_cvt_pk_bf16_f32 v250, v248, v249
    v_lshlrev_b32 v248, 16, v250
    v_and_b32 v249, 0xffff0000, v250
    v_max_f32 v248, 0, v248
    v_max_f32 v249, 0, v249
    v_mul_f32 v248, v248, v248
    v_mul_f32 v249, v249, v249
    v_cvt_pk_bf16_f32 v132, v248, v249
    v_cvt_pk_bf16_f32 v250, v70, v71
    v_lshlrev_b32 v248, 16, v250
    v_and_b32 v249, 0xffff0000, v250
    v_add_f32 v248, v248, v234
    v_add_f32 v249, v249, v235
    v_cvt_pk_bf16_f32 v250, v248, v249
    v_lshlrev_b32 v248, 16, v250
    v_and_b32 v249, 0xffff0000, v250
    v_max_f32 v248, 0, v248
    v_max_f32 v249, 0, v249
    v_mul_f32 v248, v248, v248
    v_mul_f32 v249, v249, v249
    v_cvt_pk_bf16_f32 v133, v248, v249
    v_cvt_pk_bf16_f32 v250, v84, v85
    v_lshlrev_b32 v248, 16, v250
    v_and_b32 v249, 0xffff0000, v250
    v_add_f32 v248, v248, v236
    v_add_f32 v249, v249, v237
    v_cvt_pk_bf16_f32 v250, v248, v249
    v_lshlrev_b32 v248, 16, v250
    v_and_b32 v249, 0xffff0000, v250
    v_max_f32 v248, 0, v248
    v_max_f32 v249, 0, v249
    v_mul_f32 v248, v248, v248
    v_mul_f32 v249, v249, v249
    v_cvt_pk_bf16_f32 v134, v248, v249
    v_cvt_pk_bf16_f32 v250, v86, v87
    v_lshlrev_b32 v248, 16, v250
    v_and_b32 v249, 0xffff0000, v250
    v_add_f32 v248, v248, v238
    v_add_f32 v249, v249, v239
    v_cvt_pk_bf16_f32 v250, v248, v249
    v_lshlrev_b32 v248, 16, v250
    v_and_b32 v249, 0xffff0000, v250
    v_max_f32 v248, 0, v248
    v_max_f32 v249, 0, v249
    v_mul_f32 v248, v248, v248
    v_mul_f32 v249, v249, v249
    v_cvt_pk_bf16_f32 v135, v248, v249
    buffer_store_dwordx4 v[132:135], v197, s[20:23], s55 offen offset:2048 sc1
    s_add_u32 s55, s55, 55296
    v_cvt_pk_bf16_f32 v250, v72, v73
    v_lshlrev_b32 v248, 16, v250
    v_and_b32 v249, 0xffff0000, v250
    v_add_f32 v248, v248, v232
    v_add_f32 v249, v249, v233
    v_cvt_pk_bf16_f32 v250, v248, v249
    v_lshlrev_b32 v248, 16, v250
    v_and_b32 v249, 0xffff0000, v250
    v_max_f32 v248, 0, v248
    v_max_f32 v249, 0, v249
    v_mul_f32 v248, v248, v248
    v_mul_f32 v249, v249, v249
    v_cvt_pk_bf16_f32 v136, v248, v249
    v_cvt_pk_bf16_f32 v250, v74, v75
    v_lshlrev_b32 v248, 16, v250
    v_and_b32 v249, 0xffff0000, v250
    v_add_f32 v248, v248, v234
    v_add_f32 v249, v249, v235
    v_cvt_pk_bf16_f32 v250, v248, v249
    v_lshlrev_b32 v248, 16, v250
    v_and_b32 v249, 0xffff0000, v250
    v_max_f32 v248, 0, v248
    v_max_f32 v249, 0, v249
    v_mul_f32 v248, v248, v248
    v_mul_f32 v249, v249, v249
    v_cvt_pk_bf16_f32 v137, v248, v249
    v_cvt_pk_bf16_f32 v250, v88, v89
    v_lshlrev_b32 v248, 16, v250
    v_and_b32 v249, 0xffff0000, v250
    v_add_f32 v248, v248, v236
    v_add_f32 v249, v249, v237
    v_cvt_pk_bf16_f32 v250, v248, v249
    v_lshlrev_b32 v248, 16, v250
    v_and_b32 v249, 0xffff0000, v250
    v_max_f32 v248, 0, v248
    v_max_f32 v249, 0, v249
    v_mul_f32 v248, v248, v248
    v_mul_f32 v249, v249, v249
    v_cvt_pk_bf16_f32 v138, v248, v249
    v_cvt_pk_bf16_f32 v250, v90, v91
    v_lshlrev_b32 v248, 16, v250
    v_and_b32 v249, 0xffff0000, v250
    v_add_f32 v248, v248, v238
    v_add_f32 v249, v249, v239
    v_cvt_pk_bf16_f32 v250, v248, v249
    v_lshlrev_b32 v248, 16, v250
    v_and_b32 v249, 0xffff0000, v250
    v_max_f32 v248, 0, v248
    v_max_f32 v249, 0, v249
    v_mul_f32 v248, v248, v248
    v_mul_f32 v249, v249, v249
    v_cvt_pk_bf16_f32 v139, v248, v249
    buffer_store_dwordx4 v[136:139], v197, s[20:23], s55 offen offset:2048 sc1
    s_add_u32 s55, s55, 55296
    v_cvt_pk_bf16_f32 v250, v76, v77
    v_lshlrev_b32 v248, 16, v250
    v_and_b32 v249, 0xffff0000, v250
    v_add_f32 v248, v248, v232
    v_add_f32 v249, v249, v233
    v_cvt_pk_bf16_f32 v250, v248, v249
    v_lshlrev_b32 v248, 16, v250
    v_and_b32 v249, 0xffff0000, v250
    v_max_f32 v248, 0, v248
    v_max_f32 v249, 0, v249
    v_mul_f32 v248, v248, v248
    v_mul_f32 v249, v249, v249
    v_cvt_pk_bf16_f32 v140, v248, v249
    v_cvt_pk_bf16_f32 v250, v78, v79
    v_lshlrev_b32 v248, 16, v250
    v_and_b32 v249, 0xffff0000, v250
    v_add_f32 v248, v248, v234
    v_add_f32 v249, v249, v235
    v_cvt_pk_bf16_f32 v250, v248, v249
    v_lshlrev_b32 v248, 16, v250
    v_and_b32 v249, 0xffff0000, v250
    v_max_f32 v248, 0, v248
    v_max_f32 v249, 0, v249
    v_mul_f32 v248, v248, v248
    v_mul_f32 v249, v249, v249
    v_cvt_pk_bf16_f32 v141, v248, v249
    v_cvt_pk_bf16_f32 v250, v92, v93
    v_lshlrev_b32 v248, 16, v250
    v_and_b32 v249, 0xffff0000, v250
    v_add_f32 v248, v248, v236
    v_add_f32 v249, v249, v237
    v_cvt_pk_bf16_f32 v250, v248, v249
    v_lshlrev_b32 v248, 16, v250
    v_and_b32 v249, 0xffff0000, v250
    v_max_f32 v248, 0, v248
    v_max_f32 v249, 0, v249
    v_mul_f32 v248, v248, v248
    v_mul_f32 v249, v249, v249
    v_cvt_pk_bf16_f32 v142, v248, v249
    v_cvt_pk_bf16_f32 v250, v94, v95
    v_lshlrev_b32 v248, 16, v250
    v_and_b32 v249, 0xffff0000, v250
    v_add_f32 v248, v248, v238
    v_add_f32 v249, v249, v239
    v_cvt_pk_bf16_f32 v250, v248, v249
    v_lshlrev_b32 v248, 16, v250
    v_and_b32 v249, 0xffff0000, v250
    v_max_f32 v248, 0, v248
    v_max_f32 v249, 0, v249
    v_mul_f32 v248, v248, v248
    v_mul_f32 v249, v249, v249
    v_cvt_pk_bf16_f32 v143, v248, v249
    buffer_store_dwordx4 v[140:143], v197, s[20:23], s55 offen offset:2048 sc1
    s_mov_b32 s55, s47
    v_cvt_pk_bf16_f32 v250, v96, v97
    v_lshlrev_b32 v248, 16, v250
    v_and_b32 v249, 0xffff0000, v250
    v_add_f32 v248, v248, v240
    v_add_f32 v249, v249, v241
    v_cvt_pk_bf16_f32 v250, v248, v249
    v_lshlrev_b32 v248, 16, v250
    v_and_b32 v249, 0xffff0000, v250
    v_max_f32 v248, 0, v248
    v_max_f32 v249, 0, v249
    v_mul_f32 v248, v248, v248
    v_mul_f32 v249, v249, v249
    v_cvt_pk_bf16_f32 v128, v248, v249
    v_cvt_pk_bf16_f32 v250, v98, v99
    v_lshlrev_b32 v248, 16, v250
    v_and_b32 v249, 0xffff0000, v250
    v_add_f32 v248, v248, v242
    v_add_f32 v249, v249, v243
    v_cvt_pk_bf16_f32 v250, v248, v249
    v_lshlrev_b32 v248, 16, v250
    v_and_b32 v249, 0xffff0000, v250
    v_max_f32 v248, 0, v248
    v_max_f32 v249, 0, v249
    v_mul_f32 v248, v248, v248
    v_mul_f32 v249, v249, v249
    v_cvt_pk_bf16_f32 v129, v248, v249
    v_cvt_pk_bf16_f32 v250, v112, v113
    v_lshlrev_b32 v248, 16, v250
    v_and_b32 v249, 0xffff0000, v250
    v_add_f32 v248, v248, v244
    v_add_f32 v249, v249, v245
    v_cvt_pk_bf16_f32 v250, v248, v249
    v_lshlrev_b32 v248, 16, v250
    v_and_b32 v249, 0xffff0000, v250
    v_max_f32 v248, 0, v248
    v_max_f32 v249, 0, v249
    v_mul_f32 v248, v248, v248
    v_mul_f32 v249, v249, v249
    v_cvt_pk_bf16_f32 v130, v248, v249
    v_cvt_pk_bf16_f32 v250, v114, v115
    v_lshlrev_b32 v248, 16, v250
    v_and_b32 v249, 0xffff0000, v250
    v_add_f32 v248, v248, v246
    v_add_f32 v249, v249, v247
    v_cvt_pk_bf16_f32 v250, v248, v249
    v_lshlrev_b32 v248, 16, v250
    v_and_b32 v249, 0xffff0000, v250
    v_max_f32 v248, 0, v248
    v_max_f32 v249, 0, v249
    v_mul_f32 v248, v248, v248
    v_mul_f32 v249, v249, v249
    v_cvt_pk_bf16_f32 v131, v248, v249
    buffer_store_dwordx4 v[128:131], v197, s[20:23], s55 offen offset:3072 sc1
    s_add_u32 s55, s55, 55296
    v_cvt_pk_bf16_f32 v250, v100, v101
    v_lshlrev_b32 v248, 16, v250
    v_and_b32 v249, 0xffff0000, v250
    v_add_f32 v248, v248, v240
    v_add_f32 v249, v249, v241
    v_cvt_pk_bf16_f32 v250, v248, v249
    v_lshlrev_b32 v248, 16, v250
    v_and_b32 v249, 0xffff0000, v250
    v_max_f32 v248, 0, v248
    v_max_f32 v249, 0, v249
    v_mul_f32 v248, v248, v248
    v_mul_f32 v249, v249, v249
    v_cvt_pk_bf16_f32 v132, v248, v249
    v_cvt_pk_bf16_f32 v250, v102, v103
    v_lshlrev_b32 v248, 16, v250
    v_and_b32 v249, 0xffff0000, v250
    v_add_f32 v248, v248, v242
    v_add_f32 v249, v249, v243
    v_cvt_pk_bf16_f32 v250, v248, v249
    v_lshlrev_b32 v248, 16, v250
    v_and_b32 v249, 0xffff0000, v250
    v_max_f32 v248, 0, v248
    v_max_f32 v249, 0, v249
    v_mul_f32 v248, v248, v248
    v_mul_f32 v249, v249, v249
    v_cvt_pk_bf16_f32 v133, v248, v249
    v_cvt_pk_bf16_f32 v250, v116, v117
    v_lshlrev_b32 v248, 16, v250
    v_and_b32 v249, 0xffff0000, v250
    v_add_f32 v248, v248, v244
    v_add_f32 v249, v249, v245
    v_cvt_pk_bf16_f32 v250, v248, v249
    v_lshlrev_b32 v248, 16, v250
    v_and_b32 v249, 0xffff0000, v250
    v_max_f32 v248, 0, v248
    v_max_f32 v249, 0, v249
    v_mul_f32 v248, v248, v248
    v_mul_f32 v249, v249, v249
    v_cvt_pk_bf16_f32 v134, v248, v249
    v_cvt_pk_bf16_f32 v250, v118, v119
    v_lshlrev_b32 v248, 16, v250
    v_and_b32 v249, 0xffff0000, v250
    v_add_f32 v248, v248, v246
    v_add_f32 v249, v249, v247
    v_cvt_pk_bf16_f32 v250, v248, v249
    v_lshlrev_b32 v248, 16, v250
    v_and_b32 v249, 0xffff0000, v250
    v_max_f32 v248, 0, v248
    v_max_f32 v249, 0, v249
    v_mul_f32 v248, v248, v248
    v_mul_f32 v249, v249, v249
    v_cvt_pk_bf16_f32 v135, v248, v249
    buffer_store_dwordx4 v[132:135], v197, s[20:23], s55 offen offset:3072 sc1
    s_add_u32 s55, s55, 55296
    v_cvt_pk_bf16_f32 v250, v104, v105
    v_lshlrev_b32 v248, 16, v250
    v_and_b32 v249, 0xffff0000, v250
    v_add_f32 v248, v248, v240
    v_add_f32 v249, v249, v241
    v_cvt_pk_bf16_f32 v250, v248, v249
    v_lshlrev_b32 v248, 16, v250
    v_and_b32 v249, 0xffff0000, v250
    v_max_f32 v248, 0, v248
    v_max_f32 v249, 0, v249
    v_mul_f32 v248, v248, v248
    v_mul_f32 v249, v249, v249
    v_cvt_pk_bf16_f32 v136, v248, v249
    v_cvt_pk_bf16_f32 v250, v106, v107
    v_lshlrev_b32 v248, 16, v250
    v_and_b32 v249, 0xffff0000, v250
    v_add_f32 v248, v248, v242
    v_add_f32 v249, v249, v243
    v_cvt_pk_bf16_f32 v250, v248, v249
    v_lshlrev_b32 v248, 16, v250
    v_and_b32 v249, 0xffff0000, v250
    v_max_f32 v248, 0, v248
    v_max_f32 v249, 0, v249
    v_mul_f32 v248, v248, v248
    v_mul_f32 v249, v249, v249
    v_cvt_pk_bf16_f32 v137, v248, v249
    v_cvt_pk_bf16_f32 v250, v120, v121
    v_lshlrev_b32 v248, 16, v250
    v_and_b32 v249, 0xffff0000, v250
    v_add_f32 v248, v248, v244
    v_add_f32 v249, v249, v245
    v_cvt_pk_bf16_f32 v250, v248, v249
    v_lshlrev_b32 v248, 16, v250
    v_and_b32 v249, 0xffff0000, v250
    v_max_f32 v248, 0, v248
    v_max_f32 v249, 0, v249
    v_mul_f32 v248, v248, v248
    v_mul_f32 v249, v249, v249
    v_cvt_pk_bf16_f32 v138, v248, v249
    v_cvt_pk_bf16_f32 v250, v122, v123
    v_lshlrev_b32 v248, 16, v250
    v_and_b32 v249, 0xffff0000, v250
    v_add_f32 v248, v248, v246
    v_add_f32 v249, v249, v247
    v_cvt_pk_bf16_f32 v250, v248, v249
    v_lshlrev_b32 v248, 16, v250
    v_and_b32 v249, 0xffff0000, v250
    v_max_f32 v248, 0, v248
    v_max_f32 v249, 0, v249
    v_mul_f32 v248, v248, v248
    v_mul_f32 v249, v249, v249
    v_cvt_pk_bf16_f32 v139, v248, v249
    buffer_store_dwordx4 v[136:139], v197, s[20:23], s55 offen offset:3072 sc1
    s_add_u32 s55, s55, 55296
    v_cvt_pk_bf16_f32 v250, v108, v109
    v_lshlrev_b32 v248, 16, v250
    v_and_b32 v249, 0xffff0000, v250
    v_add_f32 v248, v248, v240
    v_add_f32 v249, v249, v241
    v_cvt_pk_bf16_f32 v250, v248, v249
    v_lshlrev_b32 v248, 16, v250
    v_and_b32 v249, 0xffff0000, v250
    v_max_f32 v248, 0, v248
    v_max_f32 v249, 0, v249
    v_mul_f32 v248, v248, v248
    v_mul_f32 v249, v249, v249
    v_cvt_pk_bf16_f32 v140, v248, v249
    v_cvt_pk_bf16_f32 v250, v110, v111
    v_lshlrev_b32 v248, 16, v250
    v_and_b32 v249, 0xffff0000, v250
    v_add_f32 v248, v248, v242
    v_add_f32 v249, v249, v243
    v_cvt_pk_bf16_f32 v250, v248, v249
    v_lshlrev_b32 v248, 16, v250
    v_and_b32 v249, 0xffff0000, v250
    v_max_f32 v248, 0, v248
    v_max_f32 v249, 0, v249
    v_mul_f32 v248, v248, v248
    v_mul_f32 v249, v249, v249
    v_cvt_pk_bf16_f32 v141, v248, v249
    v_cvt_pk_bf16_f32 v250, v124, v125
    v_lshlrev_b32 v248, 16, v250
    v_and_b32 v249, 0xffff0000, v250
    v_add_f32 v248, v248, v244
    v_add_f32 v249, v249, v245
    v_cvt_pk_bf16_f32 v250, v248, v249
    v_lshlrev_b32 v248, 16, v250
    v_and_b32 v249, 0xffff0000, v250
    v_max_f32 v248, 0, v248
    v_max_f32 v249, 0, v249
    v_mul_f32 v248, v248, v248
    v_mul_f32 v249, v249, v249
    v_cvt_pk_bf16_f32 v142, v248, v249
    v_cvt_pk_bf16_f32 v250, v126, v127
    v_lshlrev_b32 v248, 16, v250
    v_and_b32 v249, 0xffff0000, v250
    v_add_f32 v248, v248, v246
    v_add_f32 v249, v249, v247
    v_cvt_pk_bf16_f32 v250, v248, v249
    v_lshlrev_b32 v248, 16, v250
    v_and_b32 v249, 0xffff0000, v250
    v_max_f32 v248, 0, v248
    v_max_f32 v249, 0, v249
    v_mul_f32 v248, v248, v248
    v_mul_f32 v249, v249, v249
    v_cvt_pk_bf16_f32 v143, v248, v249
    buffer_store_dwordx4 v[140:143], v197, s[20:23], s55 offen offset:3072 sc1
    s_branch W_next
W_V:
    s_waitcnt vmcnt(6)
    s_barrier
    ds_read_b128 v[160:163], v192 offset:0
    ds_read_b64_tr_b16 v[128:129], v176 offset:0
    ds_read_b64_tr_b16 v[130:131], v176 offset:8192
    ds_read_b128 v[164:167], v192 offset:1024
    ds_read_b64_tr_b16 v[132:133], v177 offset:0
    ds_read_b64_tr_b16 v[134:135], v177 offset:8192
    ds_read_b64_tr_b16 v[136:137], v178 offset:0
    ds_read_b64_tr_b16 v[138:139], v178 offset:8192
    ds_read_b64_tr_b16 v[140:141], v179 offset:0
    ds_read_b64_tr_b16 v[142:143], v179 offset:8192
    s_waitcnt lgkmcnt(7)
    v_mfma_f32_16x16x32_bf16 v[0:3], v[160:163], v[128:131], 0
    ds_read_b64_tr_b16 v[144:145], v180 offset:0
    ds_read_b64_tr_b16 v[146:147], v180 offset:8192
    s_waitcnt lgkmcnt(8)
    v_mfma_f32_16x16x32_bf16 v[4:7], v[164:167], v[128:131], 0
    s_waitcnt lgkmcnt(6)
    v_mfma_f32_16x16x32_bf16 v[16:19], v[160:163], v[132:135], 0
    ds_read_b64_tr_b16 v[148:149], v181 offset:0
    ds_read_b64_tr_b16 v[150:151], v181 offset:8192
    v_mfma_f32_16x16x32_bf16 v[20:23], v[164:167], v[132:135], 0
    s_waitcnt lgkmcnt(6)
    v_mfma_f32_16x16x32_bf16 v[32:35], v[160:163], v[136:139], 0
    ds_read_b64_tr_b16 v[152:153], v182 offset:0
    ds_read_b64_tr_b16 v[154:155], v182 offset:8192
    v_mfma_f32_16x16x32_bf16 v[36:39], v[164:167], v[136:139], 0
    s_waitcnt lgkmcnt(6)
    v_mfma_f32_16x16x32_bf16 v[48:51], v[160:163], v[140:143], 0
    ds_read_b64_tr_b16 v[156:157], v183 offset:0
    ds_read_b64_tr_b16 v[158:159], v183 offset:8192
    v_mfma_f32_16x16x32_bf16 v[52:55], v[164:167], v[140:143], 0
    s_waitcnt vmcnt(3)
    s_barrier
    s_waitcnt lgkmcnt(6)
    v_mfma_f32_16x16x32_bf16 v[64:67], v[160:163], v[144:147], 0
    ds_read_b128 v[200:203], v192 offset:32768
    v_mfma_f32_16x16x32_bf16 v[68:71], v[164:167], v[144:147], 0
    ds_read_b64_tr_b16 v[128:129], v176 offset:32768
    ds_read_b64_tr_b16 v[130:131], v176 offset:40960
    s_add_u32 m0, s34, 98304
    s_nop 0
    buffer_load_dwordx4 v194, s[12:15], s31 offen lds
    s_waitcnt lgkmcnt(7)
    v_mfma_f32_16x16x32_bf16 v[80:83], v[160:163], v[148:151], 0
    ds_read_b128 v[204:207], v192 offset:33792
    v_mfma_f32_16x16x32_bf16 v[84:87], v[164:167], v[148:151], 0
    ds_read_b64_tr_b16 v[132:133], v177 offset:32768
    ds_read_b64_tr_b16 v[134:135], v177 offset:40960
    s_add_u32 m0, s34, 99328
    s_nop 0
    buffer_load_dwordx4 v195, s[12:15], s31 offen lds
    s_add_u32 s31, s31, s37
    s_waitcnt lgkmcnt(8)
    v_mfma_f32_16x16x32_bf16 v[96:99], v[160:163], v[152:155], 0
    v_mfma_f32_16x16x32_bf16 v[100:103], v[164:167], v[152:155], 0
    ds_read_b64_tr_b16 v[136:137], v178 offset:32768
    ds_read_b64_tr_b16 v[138:139], v178 offset:40960
    s_add_u32 m0, s35, 98304
    s_nop 0
    buffer_load_dwordx4 v196, s[16:19], s32 offen lds
    s_add_u32 s32, s32, 1024
    s_waitcnt lgkmcnt(8)
    v_mfma_f32_16x16x32_bf16 v[112:115], v[160:163], v[156:159], 0
    v_mfma_f32_16x16x32_bf16 v[116:119], v[164:167], v[156:159], 0
    ds_read_b64_tr_b16 v[140:141], v179 offset:32768
    ds_read_b64_tr_b16 v[142:143], v179 offset:40960
    s_waitcnt lgkmcnt(7)
    v_mfma_f32_16x16x32_bf16 v[0:3], v[200:203], v[128:131], v[0:3]
    ds_read_b64_tr_b16 v[144:145], v180 offset:32768
    ds_read_b64_tr_b16 v[146:147], v180 offset:40960
    s_waitcnt lgkmcnt(8)
    v_mfma_f32_16x16x32_bf16 v[4:7], v[204:207], v[128:131], v[4:7]
    s_waitcnt lgkmcnt(6)
    v_mfma_f32_16x16x32_bf16 v[16:19], v[200:203], v[132:135], v[16:19]
    ds_read_b64_tr_b16 v[148:149], v181 offset:32768
    ds_read_b64_tr_b16 v[150:151], v181 offset:40960
    v_mfma_f32_16x16x32_bf16 v[20:23], v[204:207], v[132:135], v[20:23]
    s_waitcnt lgkmcnt(6)
    v_mfma_f32_16x16x32_bf16 v[32:35], v[200:203], v[136:139], v[32:35]
    ds_read_b64_tr_b16 v[152:153], v182 offset:32768
    ds_read_b64_tr_b16 v[154:155], v182 offset:40960
    v_mfma_f32_16x16x32_bf16 v[36:39], v[204:207], v[136:139], v[36:39]
    s_waitcnt lgkmcnt(6)
    v_mfma_f32_16x16x32_bf16 v[48:51], v[200:203], v[140:143], v[48:51]
    ds_read_b64_tr_b16 v[156:157], v183 offset:32768
    ds_read_b64_tr_b16 v[158:159], v183 offset:40960
    v_mfma_f32_16x16x32_bf16 v[52:55], v[204:207], v[140:143], v[52:55]
    s_waitcnt vmcnt(3)
    s_barrier
    s_waitcnt lgkmcnt(6)
    v_mfma_f32_16x16x32_bf16 v[64:67], v[200:203], v[144:147], v[64:67]
    ds_read_b128 v[160:163], v193 offset:0
    v_mfma_f32_16x16x32_bf16 v[68:71], v[204:207], v[144:147], v[68:71]
    ds_read_b64_tr_b16 v[128:129], v184 offset:0
    ds_read_b64_tr_b16 v[130:131], v184 offset:8192
    s_add_u32 m0, s34, 0
    s_nop 0
    buffer_load_dwordx4 v194, s[12:15], s31 offen lds
    s_waitcnt lgkmcnt(7)
    v_mfma_f32_16x16x32_bf16 v[80:83], v[200:203], v[148:151], v[80:83]
    ds_read_b128 v[164:167], v193 offset:1024
    v_mfma_f32_16x16x32_bf16 v[84:87], v[204:207], v[148:151], v[84:87]
    ds_read_b64_tr_b16 v[132:133], v185 offset:0
    ds_read_b64_tr_b16 v[134:135], v185 offset:8192
    s_add_u32 m0, s34, 1024
    s_nop 0
    buffer_load_dwordx4 v195, s[12:15], s31 offen lds
    s_add_u32 s31, s31, s37
    s_waitcnt lgkmcnt(8)
    v_mfma_f32_16x16x32_bf16 v[96:99], v[200:203], v[152:155], v[96:99]
    v_mfma_f32_16x16x32_bf16 v[100:103], v[204:207], v[152:155], v[100:103]
    ds_read_b64_tr_b16 v[136:137], v186 offset:0
    ds_read_b64_tr_b16 v[138:139], v186 offset:8192
    s_add_u32 m0, s35, 0
    s_nop 0
    buffer_load_dwordx4 v196, s[16:19], s32 offen lds
    s_add_u32 s32, s32, 1024
    s_waitcnt lgkmcnt(8)
    v_mfma_f32_16x16x32_bf16 v[112:115], v[200:203], v[156:159], v[112:115]
    v_mfma_f32_16x16x32_bf16 v[116:119], v[204:207], v[156:159], v[116:119]
    ds_read_b64_tr_b16 v[140:141], v187 offset:0
    ds_read_b64_tr_b16 v[142:143], v187 offset:8192
    s_waitcnt lgkmcnt(7)
    v_mfma_f32_16x16x32_bf16 v[0:3], v[160:163], v[128:131], v[0:3]
    ds_read_b64_tr_b16 v[144:145], v188 offset:0
    ds_read_b64_tr_b16 v[146:147], v188 offset:8192
    s_waitcnt lgkmcnt(8)
    v_mfma_f32_16x16x32_bf16 v[4:7], v[164:167], v[128:131], v[4:7]
    s_waitcnt lgkmcnt(6)
    v_mfma_f32_16x16x32_bf16 v[16:19], v[160:163], v[132:135], v[16:19]
    ds_read_b64_tr_b16 v[148:149], v189 offset:0
    ds_read_b64_tr_b16 v[150:151], v189 offset:8192
    v_mfma_f32_16x16x32_bf16 v[20:23], v[164:167], v[132:135], v[20:23]
    s_waitcnt lgkmcnt(6)
    v_mfma_f32_16x16x32_bf16 v[32:35], v[160:163], v[136:139], v[32:35]
    ds_read_b64_tr_b16 v[152:153], v190 offset:0
    ds_read_b64_tr_b16 v[154:155], v190 offset:8192
    v_mfma_f32_16x16x32_bf16 v[36:39], v[164:167], v[136:139], v[36:39]
    s_waitcnt lgkmcnt(6)
    v_mfma_f32_16x16x32_bf16 v[48:51], v[160:163], v[140:143], v[48:51]
    ds_read_b64_tr_b16 v[156:157], v191 offset:0
    ds_read_b64_tr_b16 v[158:159], v191 offset:8192
    v_mfma_f32_16x16x32_bf16 v[52:55], v[164:167], v[140:143], v[52:55]
    s_waitcnt vmcnt(3)
    s_barrier
    s_waitcnt lgkmcnt(6)
    v_mfma_f32_16x16x32_bf16 v[64:67], v[160:163], v[144:147], v[64:67]
    ds_read_b128 v[200:203], v193 offset:32768
    v_mfma_f32_16x16x32_bf16 v[68:71], v[164:167], v[144:147], v[68:71]
    ds_read_b64_tr_b16 v[128:129], v184 offset:32768
    ds_read_b64_tr_b16 v[130:131], v184 offset:40960
    s_add_u32 m0, s34, 32768
    s_nop 0
    buffer_load_dwordx4 v194, s[12:15], s31 offen lds
    s_waitcnt lgkmcnt(7)
    v_mfma_f32_16x16x32_bf16 v[80:83], v[160:163], v[148:151], v[80:83]
    ds_read_b128 v[204:207], v193 offset:33792
    v_mfma_f32_16x16x32_bf16 v[84:87], v[164:167], v[148:151], v[84:87]
    ds_read_b64_tr_b16 v[132:133], v185 offset:32768
    ds_read_b64_tr_b16 v[134:135], v185 offset:40960
    s_add_u32 m0, s34, 33792
    s_nop 0
    buffer_load_dwordx4 v195, s[12:15], s31 offen lds
    s_add_u32 s31, s31, s37
    s_waitcnt lgkmcnt(8)
    v_mfma_f32_16x16x32_bf16 v[96:99], v[160:163], v[152:155], v[96:99]
    v_mfma_f32_16x16x32_bf16 v[100:103], v[164:167], v[152:155], v[100:103]
    ds_read_b64_tr_b16 v[136:137], v186 offset:32768
    ds_read_b64_tr_b16 v[138:139], v186 offset:40960
    s_add_u32 m0, s35, 32768
    s_nop 0
    buffer_load_dwordx4 v196, s[16:19], s32 offen lds
    s_add_u32 s32, s32, 1024
    s_waitcnt lgkmcnt(8)
    v_mfma_f32_16x16x32_bf16 v[112:115], v[160:163], v[156:159], v[112:115]
    v_mfma_f32_16x16x32_bf16 v[116:119], v[164:167], v[156:159], v[116:119]
    ds_read_b64_tr_b16 v[140:141], v187 offset:32768
    ds_read_b64_tr_b16 v[142:143], v187 offset:40960
    s_waitcnt lgkmcnt(7)
    v_mfma_f32_16x16x32_bf16 v[0:3], v[200:203], v[128:131], v[0:3]
    ds_read_b64_tr_b16 v[144:145], v188 offset:32768
    ds_read_b64_tr_b16 v[146:147], v188 offset:40960
    s_waitcnt lgkmcnt(8)
    v_mfma_f32_16x16x32_bf16 v[4:7], v[204:207], v[128:131], v[4:7]
    s_waitcnt lgkmcnt(6)
    v_mfma_f32_16x16x32_bf16 v[16:19], v[200:203], v[132:135], v[16:19]
    ds_read_b64_tr_b16 v[148:149], v189 offset:32768
    ds_read_b64_tr_b16 v[150:151], v189 offset:40960
    v_mfma_f32_16x16x32_bf16 v[20:23], v[204:207], v[132:135], v[20:23]
    s_waitcnt lgkmcnt(6)
    v_mfma_f32_16x16x32_bf16 v[32:35], v[200:203], v[136:139], v[32:35]
    ds_read_b64_tr_b16 v[152:153], v190 offset:32768
    ds_read_b64_tr_b16 v[154:155], v190 offset:40960
    v_mfma_f32_16x16x32_bf16 v[36:39], v[204:207], v[136:139], v[36:39]
    s_waitcnt lgkmcnt(6)
    v_mfma_f32_16x16x32_bf16 v[48:51], v[200:203], v[140:143], v[48:51]
    ds_read_b64_tr_b16 v[156:157], v191 offset:32768
    ds_read_b64_tr_b16 v[158:159], v191 offset:40960
    v_mfma_f32_16x16x32_bf16 v[52:55], v[204:207], v[140:143], v[52:55]
    s_waitcnt vmcnt(3)
    s_barrier
    s_waitcnt lgkmcnt(6)
    v_mfma_f32_16x16x32_bf16 v[64:67], v[200:203], v[144:147], v[64:67]
    ds_read_b128 v[160:163], v192 offset:0
    v_mfma_f32_16x16x32_bf16 v[68:71], v[204:207], v[144:147], v[68:71]
    ds_read_b64_tr_b16 v[128:129], v176 offset:0
    ds_read_b64_tr_b16 v[130:131], v176 offset:8192
    s_add_u32 m0, s34, 65536
    s_nop 0
    buffer_load_dwordx4 v194, s[12:15], s31 offen lds
    s_waitcnt lgkmcnt(7)
    v_mfma_f32_16x16x32_bf16 v[80:83], v[200:203], v[148:151], v[80:83]
    ds_read_b128 v[164:167], v192 offset:1024
    v_mfma_f32_16x16x32_bf16 v[84:87], v[204:207], v[148:151], v[84:87]
    ds_read_b64_tr_b16 v[132:133], v177 offset:0
    ds_read_b64_tr_b16 v[134:135], v177 offset:8192
    s_add_u32 m0, s34, 66560
    s_nop 0
    buffer_load_dwordx4 v195, s[12:15], s31 offen lds
    s_add_u32 s31, s31, s37
    s_waitcnt lgkmcnt(8)
    v_mfma_f32_16x16x32_bf16 v[96:99], v[200:203], v[152:155], v[96:99]
    v_mfma_f32_16x16x32_bf16 v[100:103], v[204:207], v[152:155], v[100:103]
    ds_read_b64_tr_b16 v[136:137], v178 offset:0
    ds_read_b64_tr_b16 v[138:139], v178 offset:8192
    s_add_u32 m0, s35, 65536
    s_nop 0
    buffer_load_dwordx4 v196, s[16:19], s32 offen lds
    s_add_u32 s32, s32, 1024
    s_waitcnt lgkmcnt(8)
    v_mfma_f32_16x16x32_bf16 v[112:115], v[200:203], v[156:159], v[112:115]
    v_mfma_f32_16x16x32_bf16 v[116:119], v[204:207], v[156:159], v[116:119]
    ds_read_b64_tr_b16 v[140:141], v179 offset:0
    ds_read_b64_tr_b16 v[142:143], v179 offset:8192
    s_waitcnt lgkmcnt(7)
    v_mfma_f32_16x16x32_bf16 v[0:3], v[160:163], v[128:131], v[0:3]
    ds_read_b64_tr_b16 v[144:145], v180 offset:0
    ds_read_b64_tr_b16 v[146:147], v180 offset:8192
    s_waitcnt lgkmcnt(8)
    v_mfma_f32_16x16x32_bf16 v[4:7], v[164:167], v[128:131], v[4:7]
    s_waitcnt lgkmcnt(6)
    v_mfma_f32_16x16x32_bf16 v[16:19], v[160:163], v[132:135], v[16:19]
    ds_read_b64_tr_b16 v[148:149], v181 offset:0
    ds_read_b64_tr_b16 v[150:151], v181 offset:8192
    v_mfma_f32_16x16x32_bf16 v[20:23], v[164:167], v[132:135], v[20:23]
    s_waitcnt lgkmcnt(6)
    v_mfma_f32_16x16x32_bf16 v[32:35], v[160:163], v[136:139], v[32:35]
    ds_read_b64_tr_b16 v[152:153], v182 offset:0
    ds_read_b64_tr_b16 v[154:155], v182 offset:8192
    v_mfma_f32_16x16x32_bf16 v[36:39], v[164:167], v[136:139], v[36:39]
    s_waitcnt lgkmcnt(6)
    v_mfma_f32_16x16x32_bf16 v[48:51], v[160:163], v[140:143], v[48:51]
    ds_read_b64_tr_b16 v[156:157], v183 offset:0
    ds_read_b64_tr_b16 v[158:159], v183 offset:8192
    v_mfma_f32_16x16x32_bf16 v[52:55], v[164:167], v[140:143], v[52:55]
    s_waitcnt vmcnt(3)
    s_barrier
    s_waitcnt lgkmcnt(6)
    v_mfma_f32_16x16x32_bf16 v[64:67], v[160:163], v[144:147], v[64:67]
    ds_read_b128 v[200:203], v192 offset:32768
    v_mfma_f32_16x16x32_bf16 v[68:71], v[164:167], v[144:147], v[68:71]
    ds_read_b64_tr_b16 v[128:129], v176 offset:32768
    ds_read_b64_tr_b16 v[130:131], v176 offset:40960
    s_add_u32 m0, s34, 98304
    s_nop 0
    buffer_load_dwordx4 v194, s[12:15], s31 offen lds
    s_waitcnt lgkmcnt(7)
    v_mfma_f32_16x16x32_bf16 v[80:83], v[160:163], v[148:151], v[80:83]
    ds_read_b128 v[204:207], v192 offset:33792
    v_mfma_f32_16x16x32_bf16 v[84:87], v[164:167], v[148:151], v[84:87]
    ds_read_b64_tr_b16 v[132:133], v177 offset:32768
    ds_read_b64_tr_b16 v[134:135], v177 offset:40960
    s_add_u32 m0, s34, 99328
    s_nop 0
    buffer_load_dwordx4 v195, s[12:15], s31 offen lds
    s_add_u32 s31, s31, s37
    s_waitcnt lgkmcnt(8)
    v_mfma_f32_16x16x32_bf16 v[96:99], v[160:163], v[152:155], v[96:99]
    v_mfma_f32_16x16x32_bf16 v[100:103], v[164:167], v[152:155], v[100:103]
    ds_read_b64_tr_b16 v[136:137], v178 offset:32768
    ds_read_b64_tr_b16 v[138:139], v178 offset:40960
    s_add_u32 m0, s35, 98304
    s_nop 0
    buffer_load_dwordx4 v196, s[16:19], s32 offen lds
    s_add_u32 s32, s32, 1024
    s_waitcnt lgkmcnt(8)
    v_mfma_f32_16x16x32_bf16 v[112:115], v[160:163], v[156:159], v[112:115]
    v_mfma_f32_16x16x32_bf16 v[116:119], v[164:167], v[156:159], v[116:119]
    ds_read_b64_tr_b16 v[140:141], v179 offset:32768
    ds_read_b64_tr_b16 v[142:143], v179 offset:40960
    s_waitcnt lgkmcnt(7)
    v_mfma_f32_16x16x32_bf16 v[0:3], v[200:203], v[128:131], v[0:3]
    ds_read_b64_tr_b16 v[144:145], v180 offset:32768
    ds_read_b64_tr_b16 v[146:147], v180 offset:40960
    s_waitcnt lgkmcnt(8)
    v_mfma_f32_16x16x32_bf16 v[4:7], v[204:207], v[128:131], v[4:7]
    s_waitcnt lgkmcnt(6)
    v_mfma_f32_16x16x32_bf16 v[16:19], v[200:203], v[132:135], v[16:19]
    ds_read_b64_tr_b16 v[148:149], v181 offset:32768
    ds_read_b64_tr_b16 v[150:151], v181 offset:40960
    v_mfma_f32_16x16x32_bf16 v[20:23], v[204:207], v[132:135], v[20:23]
    s_waitcnt lgkmcnt(6)
    v_mfma_f32_16x16x32_bf16 v[32:35], v[200:203], v[136:139], v[32:35]
    ds_read_b64_tr_b16 v[152:153], v182 offset:32768
    ds_read_b64_tr_b16 v[154:155], v182 offset:40960
    v_mfma_f32_16x16x32_bf16 v[36:39], v[204:207], v[136:139], v[36:39]
    s_waitcnt lgkmcnt(6)
    v_mfma_f32_16x16x32_bf16 v[48:51], v[200:203], v[140:143], v[48:51]
    ds_read_b64_tr_b16 v[156:157], v183 offset:32768
    ds_read_b64_tr_b16 v[158:159], v183 offset:40960
    v_mfma_f32_16x16x32_bf16 v[52:55], v[204:207], v[140:143], v[52:55]
    s_waitcnt vmcnt(3)
    s_barrier
    s_waitcnt lgkmcnt(6)
    v_mfma_f32_16x16x32_bf16 v[64:67], v[200:203], v[144:147], v[64:67]
    ds_read_b128 v[160:163], v193 offset:0
    v_mfma_f32_16x16x32_bf16 v[68:71], v[204:207], v[144:147], v[68:71]
    ds_read_b64_tr_b16 v[128:129], v184 offset:0
    ds_read_b64_tr_b16 v[130:131], v184 offset:8192
    s_add_u32 m0, s34, 0
    s_nop 0
    buffer_load_dwordx4 v194, s[12:15], s31 offen lds
    s_waitcnt lgkmcnt(7)
    v_mfma_f32_16x16x32_bf16 v[80:83], v[200:203], v[148:151], v[80:83]
    ds_read_b128 v[164:167], v193 offset:1024
    v_mfma_f32_16x16x32_bf16 v[84:87], v[204:207], v[148:151], v[84:87]
    ds_read_b64_tr_b16 v[132:133], v185 offset:0
    ds_read_b64_tr_b16 v[134:135], v185 offset:8192
    s_add_u32 m0, s34, 1024
    s_nop 0
    buffer_load_dwordx4 v195, s[12:15], s31 offen lds
    s_add_u32 s31, s31, s37
    s_waitcnt lgkmcnt(8)
    v_mfma_f32_16x16x32_bf16 v[96:99], v[200:203], v[152:155], v[96:99]
    v_mfma_f32_16x16x32_bf16 v[100:103], v[204:207], v[152:155], v[100:103]
    ds_read_b64_tr_b16 v[136:137], v186 offset:0
    ds_read_b64_tr_b16 v[138:139], v186 offset:8192
    s_add_u32 m0, s35, 0
    s_nop 0
    buffer_load_dwordx4 v196, s[16:19], s32 offen lds
    s_add_u32 s32, s32, 1024
    s_waitcnt lgkmcnt(8)
    v_mfma_f32_16x16x32_bf16 v[112:115], v[200:203], v[156:159], v[112:115]
    v_mfma_f32_16x16x32_bf16 v[116:119], v[204:207], v[156:159], v[116:119]
    ds_read_b64_tr_b16 v[140:141], v187 offset:0
    ds_read_b64_tr_b16 v[142:143], v187 offset:8192
    s_waitcnt lgkmcnt(7)
    v_mfma_f32_16x16x32_bf16 v[0:3], v[160:163], v[128:131], v[0:3]
    ds_read_b64_tr_b16 v[144:145], v188 offset:0
    ds_read_b64_tr_b16 v[146:147], v188 offset:8192
    s_waitcnt lgkmcnt(8)
    v_mfma_f32_16x16x32_bf16 v[4:7], v[164:167], v[128:131], v[4:7]
    s_waitcnt lgkmcnt(6)
    v_mfma_f32_16x16x32_bf16 v[16:19], v[160:163], v[132:135], v[16:19]
    ds_read_b64_tr_b16 v[148:149], v189 offset:0
    ds_read_b64_tr_b16 v[150:151], v189 offset:8192
    v_mfma_f32_16x16x32_bf16 v[20:23], v[164:167], v[132:135], v[20:23]
    s_waitcnt lgkmcnt(6)
    v_mfma_f32_16x16x32_bf16 v[32:35], v[160:163], v[136:139], v[32:35]
    ds_read_b64_tr_b16 v[152:153], v190 offset:0
    ds_read_b64_tr_b16 v[154:155], v190 offset:8192
    v_mfma_f32_16x16x32_bf16 v[36:39], v[164:167], v[136:139], v[36:39]
    s_waitcnt lgkmcnt(6)
    v_mfma_f32_16x16x32_bf16 v[48:51], v[160:163], v[140:143], v[48:51]
    ds_read_b64_tr_b16 v[156:157], v191 offset:0
    ds_read_b64_tr_b16 v[158:159], v191 offset:8192
    v_mfma_f32_16x16x32_bf16 v[52:55], v[164:167], v[140:143], v[52:55]
    s_waitcnt vmcnt(3)
    s_barrier
    s_waitcnt lgkmcnt(6)
    v_mfma_f32_16x16x32_bf16 v[64:67], v[160:163], v[144:147], v[64:67]
    ds_read_b128 v[200:203], v193 offset:32768
    v_mfma_f32_16x16x32_bf16 v[68:71], v[164:167], v[144:147], v[68:71]
    ds_read_b64_tr_b16 v[128:129], v184 offset:32768
    ds_read_b64_tr_b16 v[130:131], v184 offset:40960
    s_add_u32 m0, s34, 32768
    s_nop 0
    buffer_load_dwordx4 v194, s[12:15], s31 offen lds
    s_waitcnt lgkmcnt(7)
    v_mfma_f32_16x16x32_bf16 v[80:83], v[160:163], v[148:151], v[80:83]
    ds_read_b128 v[204:207], v193 offset:33792
    v_mfma_f32_16x16x32_bf16 v[84:87], v[164:167], v[148:151], v[84:87]
    ds_read_b64_tr_b16 v[132:133], v185 offset:32768
    ds_read_b64_tr_b16 v[134:135], v185 offset:40960
    s_add_u32 m0, s34, 33792
    s_nop 0
    buffer_load_dwordx4 v195, s[12:15], s31 offen lds
    s_add_u32 s31, s31, s37
    s_waitcnt lgkmcnt(8)
    v_mfma_f32_16x16x32_bf16 v[96:99], v[160:163], v[152:155], v[96:99]
    v_mfma_f32_16x16x32_bf16 v[100:103], v[164:167], v[152:155], v[100:103]
    ds_read_b64_tr_b16 v[136:137], v186 offset:32768
    ds_read_b64_tr_b16 v[138:139], v186 offset:40960
    s_add_u32 m0, s35, 32768
    s_nop 0
    buffer_load_dwordx4 v196, s[16:19], s32 offen lds
    s_add_u32 s32, s32, 1024
    s_waitcnt lgkmcnt(8)
    v_mfma_f32_16x16x32_bf16 v[112:115], v[160:163], v[156:159], v[112:115]
    v_mfma_f32_16x16x32_bf16 v[116:119], v[164:167], v[156:159], v[116:119]
    ds_read_b64_tr_b16 v[140:141], v187 offset:32768
    ds_read_b64_tr_b16 v[142:143], v187 offset:40960
    s_waitcnt lgkmcnt(7)
    v_mfma_f32_16x16x32_bf16 v[0:3], v[200:203], v[128:131], v[0:3]
    ds_read_b64_tr_b16 v[144:145], v188 offset:32768
    ds_read_b64_tr_b16 v[146:147], v188 offset:40960
    s_waitcnt lgkmcnt(8)
    v_mfma_f32_16x16x32_bf16 v[4:7], v[204:207], v[128:131], v[4:7]
    s_waitcnt lgkmcnt(6)
    v_mfma_f32_16x16x32_bf16 v[16:19], v[200:203], v[132:135], v[16:19]
    ds_read_b64_tr_b16 v[148:149], v189 offset:32768
    ds_read_b64_tr_b16 v[150:151], v189 offset:40960
    v_mfma_f32_16x16x32_bf16 v[20:23], v[204:207], v[132:135], v[20:23]
    s_waitcnt lgkmcnt(6)
    v_mfma_f32_16x16x32_bf16 v[32:35], v[200:203], v[136:139], v[32:35]
    ds_read_b64_tr_b16 v[152:153], v190 offset:32768
    ds_read_b64_tr_b16 v[154:155], v190 offset:40960
    v_mfma_f32_16x16x32_bf16 v[36:39], v[204:207], v[136:139], v[36:39]
    s_waitcnt lgkmcnt(6)
    v_mfma_f32_16x16x32_bf16 v[48:51], v[200:203], v[140:143], v[48:51]
    ds_read_b64_tr_b16 v[156:157], v191 offset:32768
    ds_read_b64_tr_b16 v[158:159], v191 offset:40960
    v_mfma_f32_16x16x32_bf16 v[52:55], v[204:207], v[140:143], v[52:55]
    s_waitcnt vmcnt(3)
    s_barrier
    s_waitcnt lgkmcnt(6)
    v_mfma_f32_16x16x32_bf16 v[64:67], v[200:203], v[144:147], v[64:67]
    ds_read_b128 v[160:163], v192 offset:0
    v_mfma_f32_16x16x32_bf16 v[68:71], v[204:207], v[144:147], v[68:71]
    ds_read_b64_tr_b16 v[128:129], v176 offset:0
    ds_read_b64_tr_b16 v[130:131], v176 offset:8192
    s_add_u32 m0, s34, 65536
    s_nop 0
    buffer_load_dwordx4 v194, s[12:15], s31 offen lds
    s_waitcnt lgkmcnt(7)
    v_mfma_f32_16x16x32_bf16 v[80:83], v[200:203], v[148:151], v[80:83]
    ds_read_b128 v[164:167], v192 offset:1024
    v_mfma_f32_16x16x32_bf16 v[84:87], v[204:207], v[148:151], v[84:87]
    ds_read_b64_tr_b16 v[132:133], v177 offset:0
    ds_read_b64_tr_b16 v[134:135], v177 offset:8192
    s_add_u32 m0, s34, 66560
    s_nop 0
    buffer_load_dwordx4 v195, s[12:15], s31 offen lds
    s_add_u32 s31, s31, s37
    s_waitcnt lgkmcnt(8)
    v_mfma_f32_16x16x32_bf16 v[96:99], v[200:203], v[152:155], v[96:99]
    v_mfma_f32_16x16x32_bf16 v[100:103], v[204:207], v[152:155], v[100:103]
    ds_read_b64_tr_b16 v[136:137], v178 offset:0
    ds_read_b64_tr_b16 v[138:139], v178 offset:8192
    s_add_u32 m0, s35, 65536
    s_nop 0
    buffer_load_dwordx4 v196, s[16:19], s32 offen lds
    s_add_u32 s32, s32, 1024
    s_waitcnt lgkmcnt(8)
    v_mfma_f32_16x16x32_bf16 v[112:115], v[200:203], v[156:159], v[112:115]
    v_mfma_f32_16x16x32_bf16 v[116:119], v[204:207], v[156:159], v[116:119]
    ds_read_b64_tr_b16 v[140:141], v179 offset:0
    ds_read_b64_tr_b16 v[142:143], v179 offset:8192
    s_waitcnt lgkmcnt(7)
    v_mfma_f32_16x16x32_bf16 v[0:3], v[160:163], v[128:131], v[0:3]
    ds_read_b64_tr_b16 v[144:145], v180 offset:0
    ds_read_b64_tr_b16 v[146:147], v180 offset:8192
    s_waitcnt lgkmcnt(8)
    v_mfma_f32_16x16x32_bf16 v[4:7], v[164:167], v[128:131], v[4:7]
    s_waitcnt lgkmcnt(6)
    v_mfma_f32_16x16x32_bf16 v[16:19], v[160:163], v[132:135], v[16:19]
    ds_read_b64_tr_b16 v[148:149], v181 offset:0
    ds_read_b64_tr_b16 v[150:151], v181 offset:8192
    v_mfma_f32_16x16x32_bf16 v[20:23], v[164:167], v[132:135], v[20:23]
    s_waitcnt lgkmcnt(6)
    v_mfma_f32_16x16x32_bf16 v[32:35], v[160:163], v[136:139], v[32:35]
    ds_read_b64_tr_b16 v[152:153], v182 offset:0
    ds_read_b64_tr_b16 v[154:155], v182 offset:8192
    v_mfma_f32_16x16x32_bf16 v[36:39], v[164:167], v[136:139], v[36:39]
    s_waitcnt lgkmcnt(6)
    v_mfma_f32_16x16x32_bf16 v[48:51], v[160:163], v[140:143], v[48:51]
    ds_read_b64_tr_b16 v[156:157], v183 offset:0
    ds_read_b64_tr_b16 v[158:159], v183 offset:8192
    v_mfma_f32_16x16x32_bf16 v[52:55], v[164:167], v[140:143], v[52:55]
    s_waitcnt vmcnt(3)
    s_barrier
    s_waitcnt lgkmcnt(6)
    v_mfma_f32_16x16x32_bf16 v[64:67], v[160:163], v[144:147], v[64:67]
    ds_read_b128 v[200:203], v192 offset:32768
    v_mfma_f32_16x16x32_bf16 v[68:71], v[164:167], v[144:147], v[68:71]
    ds_read_b64_tr_b16 v[128:129], v176 offset:32768
    ds_read_b64_tr_b16 v[130:131], v176 offset:40960
    s_add_u32 m0, s34, 98304
    s_nop 0
    buffer_load_dwordx4 v194, s[12:15], s31 offen lds
    s_waitcnt lgkmcnt(7)
    v_mfma_f32_16x16x32_bf16 v[80:83], v[160:163], v[148:151], v[80:83]
    ds_read_b128 v[204:207], v192 offset:33792
    v_mfma_f32_16x16x32_bf16 v[84:87], v[164:167], v[148:151], v[84:87]
    ds_read_b64_tr_b16 v[132:133], v177 offset:32768
    ds_read_b64_tr_b16 v[134:135], v177 offset:40960
    s_add_u32 m0, s34, 99328
    s_nop 0
    buffer_load_dwordx4 v195, s[12:15], s31 offen lds
    s_add_u32 s31, s31, s37
    s_waitcnt lgkmcnt(8)
    v_mfma_f32_16x16x32_bf16 v[96:99], v[160:163], v[152:155], v[96:99]
    v_mfma_f32_16x16x32_bf16 v[100:103], v[164:167], v[152:155], v[100:103]
    ds_read_b64_tr_b16 v[136:137], v178 offset:32768
    ds_read_b64_tr_b16 v[138:139], v178 offset:40960
    s_add_u32 m0, s35, 98304
    s_nop 0
    buffer_load_dwordx4 v196, s[16:19], s32 offen lds
    s_add_u32 s32, s32, 1024
    s_waitcnt lgkmcnt(8)
    v_mfma_f32_16x16x32_bf16 v[112:115], v[160:163], v[156:159], v[112:115]
    v_mfma_f32_16x16x32_bf16 v[116:119], v[164:167], v[156:159], v[116:119]
    ds_read_b64_tr_b16 v[140:141], v179 offset:32768
    ds_read_b64_tr_b16 v[142:143], v179 offset:40960
    s_waitcnt lgkmcnt(7)
    v_mfma_f32_16x16x32_bf16 v[0:3], v[200:203], v[128:131], v[0:3]
    ds_read_b64_tr_b16 v[144:145], v180 offset:32768
    ds_read_b64_tr_b16 v[146:147], v180 offset:40960
    s_waitcnt lgkmcnt(8)
    v_mfma_f32_16x16x32_bf16 v[4:7], v[204:207], v[128:131], v[4:7]
    s_waitcnt lgkmcnt(6)
    v_mfma_f32_16x16x32_bf16 v[16:19], v[200:203], v[132:135], v[16:19]
    ds_read_b64_tr_b16 v[148:149], v181 offset:32768
    ds_read_b64_tr_b16 v[150:151], v181 offset:40960
    v_mfma_f32_16x16x32_bf16 v[20:23], v[204:207], v[132:135], v[20:23]
    s_waitcnt lgkmcnt(6)
    v_mfma_f32_16x16x32_bf16 v[32:35], v[200:203], v[136:139], v[32:35]
    ds_read_b64_tr_b16 v[152:153], v182 offset:32768
    ds_read_b64_tr_b16 v[154:155], v182 offset:40960
    v_mfma_f32_16x16x32_bf16 v[36:39], v[204:207], v[136:139], v[36:39]
    s_waitcnt lgkmcnt(6)
    v_mfma_f32_16x16x32_bf16 v[48:51], v[200:203], v[140:143], v[48:51]
    ds_read_b64_tr_b16 v[156:157], v183 offset:32768
    ds_read_b64_tr_b16 v[158:159], v183 offset:40960
    v_mfma_f32_16x16x32_bf16 v[52:55], v[204:207], v[140:143], v[52:55]
    s_waitcnt vmcnt(3)
    s_barrier
    s_waitcnt lgkmcnt(6)
    v_mfma_f32_16x16x32_bf16 v[64:67], v[200:203], v[144:147], v[64:67]
    ds_read_b128 v[160:163], v193 offset:0
    v_mfma_f32_16x16x32_bf16 v[68:71], v[204:207], v[144:147], v[68:71]
    ds_read_b64_tr_b16 v[128:129], v184 offset:0
    ds_read_b64_tr_b16 v[130:131], v184 offset:8192
    s_add_u32 m0, s34, 0
    s_nop 0
    buffer_load_dwordx4 v194, s[12:15], s31 offen lds
    s_waitcnt lgkmcnt(7)
    v_mfma_f32_16x16x32_bf16 v[80:83], v[200:203], v[148:151], v[80:83]
    ds_read_b128 v[164:167], v193 offset:1024
    v_mfma_f32_16x16x32_bf16 v[84:87], v[204:207], v[148:151], v[84:87]
    ds_read_b64_tr_b16 v[132:133], v185 offset:0
    ds_read_b64_tr_b16 v[134:135], v185 offset:8192
    s_add_u32 m0, s34, 1024
    s_nop 0
    buffer_load_dwordx4 v195, s[12:15], s31 offen lds
    s_add_u32 s31, s31, s37
    s_waitcnt lgkmcnt(8)
    v_mfma_f32_16x16x32_bf16 v[96:99], v[200:203], v[152:155], v[96:99]
    v_mfma_f32_16x16x32_bf16 v[100:103], v[204:207], v[152:155], v[100:103]
    ds_read_b64_tr_b16 v[136:137], v186 offset:0
    ds_read_b64_tr_b16 v[138:139], v186 offset:8192
    s_add_u32 m0, s35, 0
    s_nop 0
    buffer_load_dwordx4 v196, s[16:19], s32 offen lds
    s_add_u32 s32, s32, 1024
    s_waitcnt lgkmcnt(8)
    v_mfma_f32_16x16x32_bf16 v[112:115], v[200:203], v[156:159], v[112:115]
    v_mfma_f32_16x16x32_bf16 v[116:119], v[204:207], v[156:159], v[116:119]
    ds_read_b64_tr_b16 v[140:141], v187 offset:0
    ds_read_b64_tr_b16 v[142:143], v187 offset:8192
    s_waitcnt lgkmcnt(7)
    v_mfma_f32_16x16x32_bf16 v[0:3], v[160:163], v[128:131], v[0:3]
    ds_read_b64_tr_b16 v[144:145], v188 offset:0
    ds_read_b64_tr_b16 v[146:147], v188 offset:8192
    s_waitcnt lgkmcnt(8)
    v_mfma_f32_16x16x32_bf16 v[4:7], v[164:167], v[128:131], v[4:7]
    s_waitcnt lgkmcnt(6)
    v_mfma_f32_16x16x32_bf16 v[16:19], v[160:163], v[132:135], v[16:19]
    ds_read_b64_tr_b16 v[148:149], v189 offset:0
    ds_read_b64_tr_b16 v[150:151], v189 offset:8192
    v_mfma_f32_16x16x32_bf16 v[20:23], v[164:167], v[132:135], v[20:23]
    s_waitcnt lgkmcnt(6)
    v_mfma_f32_16x16x32_bf16 v[32:35], v[160:163], v[136:139], v[32:35]
    ds_read_b64_tr_b16 v[152:153], v190 offset:0
    ds_read_b64_tr_b16 v[154:155], v190 offset:8192
    v_mfma_f32_16x16x32_bf16 v[36:39], v[164:167], v[136:139], v[36:39]
    s_waitcnt lgkmcnt(6)
    v_mfma_f32_16x16x32_bf16 v[48:51], v[160:163], v[140:143], v[48:51]
    ds_read_b64_tr_b16 v[156:157], v191 offset:0
    ds_read_b64_tr_b16 v[158:159], v191 offset:8192
    v_mfma_f32_16x16x32_bf16 v[52:55], v[164:167], v[140:143], v[52:55]
    s_waitcnt vmcnt(3)
    s_barrier
    s_waitcnt lgkmcnt(6)
    v_mfma_f32_16x16x32_bf16 v[64:67], v[160:163], v[144:147], v[64:67]
    ds_read_b128 v[200:203], v193 offset:32768
    v_mfma_f32_16x16x32_bf16 v[68:71], v[164:167], v[144:147], v[68:71]
    ds_read_b64_tr_b16 v[128:129], v184 offset:32768
    ds_read_b64_tr_b16 v[130:131], v184 offset:40960
    s_add_u32 m0, s34, 32768
    s_nop 0
    buffer_load_dwordx4 v194, s[12:15], s31 offen lds
    s_waitcnt lgkmcnt(7)
    v_mfma_f32_16x16x32_bf16 v[80:83], v[160:163], v[148:151], v[80:83]
    ds_read_b128 v[204:207], v193 offset:33792
    v_mfma_f32_16x16x32_bf16 v[84:87], v[164:167], v[148:151], v[84:87]
    ds_read_b64_tr_b16 v[132:133], v185 offset:32768
    ds_read_b64_tr_b16 v[134:135], v185 offset:40960
    s_add_u32 m0, s34, 33792
    s_nop 0
    buffer_load_dwordx4 v195, s[12:15], s31 offen lds
    s_add_u32 s31, s31, s37
    s_waitcnt lgkmcnt(8)
    v_mfma_f32_16x16x32_bf16 v[96:99], v[160:163], v[152:155], v[96:99]
    v_mfma_f32_16x16x32_bf16 v[100:103], v[164:167], v[152:155], v[100:103]
    ds_read_b64_tr_b16 v[136:137], v186 offset:32768
    ds_read_b64_tr_b16 v[138:139], v186 offset:40960
    s_add_u32 m0, s35, 32768
    s_nop 0
    buffer_load_dwordx4 v196, s[16:19], s32 offen lds
    s_add_u32 s32, s32, 1024
    s_waitcnt lgkmcnt(8)
    v_mfma_f32_16x16x32_bf16 v[112:115], v[160:163], v[156:159], v[112:115]
    v_mfma_f32_16x16x32_bf16 v[116:119], v[164:167], v[156:159], v[116:119]
    ds_read_b64_tr_b16 v[140:141], v187 offset:32768
    ds_read_b64_tr_b16 v[142:143], v187 offset:40960
    s_waitcnt lgkmcnt(7)
    v_mfma_f32_16x16x32_bf16 v[0:3], v[200:203], v[128:131], v[0:3]
    ds_read_b64_tr_b16 v[144:145], v188 offset:32768
    ds_read_b64_tr_b16 v[146:147], v188 offset:40960
    s_waitcnt lgkmcnt(8)
    v_mfma_f32_16x16x32_bf16 v[4:7], v[204:207], v[128:131], v[4:7]
    s_waitcnt lgkmcnt(6)
    v_mfma_f32_16x16x32_bf16 v[16:19], v[200:203], v[132:135], v[16:19]
    ds_read_b64_tr_b16 v[148:149], v189 offset:32768
    ds_read_b64_tr_b16 v[150:151], v189 offset:40960
    v_mfma_f32_16x16x32_bf16 v[20:23], v[204:207], v[132:135], v[20:23]
    s_waitcnt lgkmcnt(6)
    v_mfma_f32_16x16x32_bf16 v[32:35], v[200:203], v[136:139], v[32:35]
    ds_read_b64_tr_b16 v[152:153], v190 offset:32768
    ds_read_b64_tr_b16 v[154:155], v190 offset:40960
    v_mfma_f32_16x16x32_bf16 v[36:39], v[204:207], v[136:139], v[36:39]
    s_waitcnt lgkmcnt(6)
    v_mfma_f32_16x16x32_bf16 v[48:51], v[200:203], v[140:143], v[48:51]
    ds_read_b64_tr_b16 v[156:157], v191 offset:32768
    ds_read_b64_tr_b16 v[158:159], v191 offset:40960
    v_mfma_f32_16x16x32_bf16 v[52:55], v[204:207], v[140:143], v[52:55]
    s_waitcnt vmcnt(3)
    s_barrier
    s_waitcnt lgkmcnt(6)
    v_mfma_f32_16x16x32_bf16 v[64:67], v[200:203], v[144:147], v[64:67]
    ds_read_b128 v[160:163], v192 offset:0
    v_mfma_f32_16x16x32_bf16 v[68:71], v[204:207], v[144:147], v[68:71]
    ds_read_b64_tr_b16 v[128:129], v176 offset:0
    ds_read_b64_tr_b16 v[130:131], v176 offset:8192
    s_add_u32 m0, s34, 65536
    s_nop 0
    buffer_load_dwordx4 v194, s[12:15], s31 offen lds
    s_waitcnt lgkmcnt(7)
    v_mfma_f32_16x16x32_bf16 v[80:83], v[200:203], v[148:151], v[80:83]
    ds_read_b128 v[164:167], v192 offset:1024
    v_mfma_f32_16x16x32_bf16 v[84:87], v[204:207], v[148:151], v[84:87]
    ds_read_b64_tr_b16 v[132:133], v177 offset:0
    ds_read_b64_tr_b16 v[134:135], v177 offset:8192
    s_add_u32 m0, s34, 66560
    s_nop 0
    buffer_load_dwordx4 v195, s[12:15], s31 offen lds
    s_add_u32 s31, s31, s37
    s_waitcnt lgkmcnt(8)
    v_mfma_f32_16x16x32_bf16 v[96:99], v[200:203], v[152:155], v[96:99]
    v_mfma_f32_16x16x32_bf16 v[100:103], v[204:207], v[152:155], v[100:103]
    ds_read_b64_tr_b16 v[136:137], v178 offset:0
    ds_read_b64_tr_b16 v[138:139], v178 offset:8192
    s_add_u32 m0, s35, 65536
    s_nop 0
    buffer_load_dwordx4 v196, s[16:19], s32 offen lds
    s_add_u32 s32, s32, 1024
    s_waitcnt lgkmcnt(8)
    v_mfma_f32_16x16x32_bf16 v[112:115], v[200:203], v[156:159], v[112:115]
    v_mfma_f32_16x16x32_bf16 v[116:119], v[204:207], v[156:159], v[116:119]
    ds_read_b64_tr_b16 v[140:141], v179 offset:0
    ds_read_b64_tr_b16 v[142:143], v179 offset:8192
    s_waitcnt lgkmcnt(7)
    v_mfma_f32_16x16x32_bf16 v[0:3], v[160:163], v[128:131], v[0:3]
    ds_read_b64_tr_b16 v[144:145], v180 offset:0
    ds_read_b64_tr_b16 v[146:147], v180 offset:8192
    s_waitcnt lgkmcnt(8)
    v_mfma_f32_16x16x32_bf16 v[4:7], v[164:167], v[128:131], v[4:7]
    s_waitcnt lgkmcnt(6)
    v_mfma_f32_16x16x32_bf16 v[16:19], v[160:163], v[132:135], v[16:19]
    ds_read_b64_tr_b16 v[148:149], v181 offset:0
    ds_read_b64_tr_b16 v[150:151], v181 offset:8192
    v_mfma_f32_16x16x32_bf16 v[20:23], v[164:167], v[132:135], v[20:23]
    s_waitcnt lgkmcnt(6)
    v_mfma_f32_16x16x32_bf16 v[32:35], v[160:163], v[136:139], v[32:35]
    ds_read_b64_tr_b16 v[152:153], v182 offset:0
    ds_read_b64_tr_b16 v[154:155], v182 offset:8192
    v_mfma_f32_16x16x32_bf16 v[36:39], v[164:167], v[136:139], v[36:39]
    s_waitcnt lgkmcnt(6)
    v_mfma_f32_16x16x32_bf16 v[48:51], v[160:163], v[140:143], v[48:51]
    ds_read_b64_tr_b16 v[156:157], v183 offset:0
    ds_read_b64_tr_b16 v[158:159], v183 offset:8192
    v_mfma_f32_16x16x32_bf16 v[52:55], v[164:167], v[140:143], v[52:55]
    s_waitcnt vmcnt(3)
    s_barrier
    s_waitcnt lgkmcnt(6)
    v_mfma_f32_16x16x32_bf16 v[64:67], v[160:163], v[144:147], v[64:67]
    ds_read_b128 v[200:203], v192 offset:32768
    v_mfma_f32_16x16x32_bf16 v[68:71], v[164:167], v[144:147], v[68:71]
    ds_read_b64_tr_b16 v[128:129], v176 offset:32768
    ds_read_b64_tr_b16 v[130:131], v176 offset:40960
    s_add_u32 m0, s34, 98304
    s_nop 0
    buffer_load_dwordx4 v194, s[12:15], s31 offen lds
    s_waitcnt lgkmcnt(7)
    v_mfma_f32_16x16x32_bf16 v[80:83], v[160:163], v[148:151], v[80:83]
    ds_read_b128 v[204:207], v192 offset:33792
    v_mfma_f32_16x16x32_bf16 v[84:87], v[164:167], v[148:151], v[84:87]
    ds_read_b64_tr_b16 v[132:133], v177 offset:32768
    ds_read_b64_tr_b16 v[134:135], v177 offset:40960
    s_add_u32 m0, s34, 99328
    s_nop 0
    buffer_load_dwordx4 v195, s[12:15], s31 offen lds
    s_add_u32 s31, s31, s37
    s_waitcnt lgkmcnt(8)
    v_mfma_f32_16x16x32_bf16 v[96:99], v[160:163], v[152:155], v[96:99]
    v_mfma_f32_16x16x32_bf16 v[100:103], v[164:167], v[152:155], v[100:103]
    ds_read_b64_tr_b16 v[136:137], v178 offset:32768
    ds_read_b64_tr_b16 v[138:139], v178 offset:40960
    s_add_u32 m0, s35, 98304
    s_nop 0
    buffer_load_dwordx4 v196, s[16:19], s32 offen lds
    s_add_u32 s32, s32, 1024
    s_waitcnt lgkmcnt(8)
    v_mfma_f32_16x16x32_bf16 v[112:115], v[160:163], v[156:159], v[112:115]
    v_mfma_f32_16x16x32_bf16 v[116:119], v[164:167], v[156:159], v[116:119]
    ds_read_b64_tr_b16 v[140:141], v179 offset:32768
    ds_read_b64_tr_b16 v[142:143], v179 offset:40960
    s_waitcnt lgkmcnt(7)
    v_mfma_f32_16x16x32_bf16 v[0:3], v[200:203], v[128:131], v[0:3]
    ds_read_b64_tr_b16 v[144:145], v180 offset:32768
    ds_read_b64_tr_b16 v[146:147], v180 offset:40960
    s_waitcnt lgkmcnt(8)
    v_mfma_f32_16x16x32_bf16 v[4:7], v[204:207], v[128:131], v[4:7]
    s_waitcnt lgkmcnt(6)
    v_mfma_f32_16x16x32_bf16 v[16:19], v[200:203], v[132:135], v[16:19]
    ds_read_b64_tr_b16 v[148:149], v181 offset:32768
    ds_read_b64_tr_b16 v[150:151], v181 offset:40960
    v_mfma_f32_16x16x32_bf16 v[20:23], v[204:207], v[132:135], v[20:23]
    s_waitcnt lgkmcnt(6)
    v_mfma_f32_16x16x32_bf16 v[32:35], v[200:203], v[136:139], v[32:35]
    ds_read_b64_tr_b16 v[152:153], v182 offset:32768
    ds_read_b64_tr_b16 v[154:155], v182 offset:40960
    v_mfma_f32_16x16x32_bf16 v[36:39], v[204:207], v[136:139], v[36:39]
    s_waitcnt lgkmcnt(6)
    v_mfma_f32_16x16x32_bf16 v[48:51], v[200:203], v[140:143], v[48:51]
    ds_read_b64_tr_b16 v[156:157], v183 offset:32768
    ds_read_b64_tr_b16 v[158:159], v183 offset:40960
    v_mfma_f32_16x16x32_bf16 v[52:55], v[204:207], v[140:143], v[52:55]
    s_waitcnt vmcnt(3)
    s_barrier
    s_waitcnt lgkmcnt(6)
    v_mfma_f32_16x16x32_bf16 v[64:67], v[200:203], v[144:147], v[64:67]
    ds_read_b128 v[160:163], v193 offset:0
    v_mfma_f32_16x16x32_bf16 v[68:71], v[204:207], v[144:147], v[68:71]
    ds_read_b64_tr_b16 v[128:129], v184 offset:0
    ds_read_b64_tr_b16 v[130:131], v184 offset:8192
    s_add_u32 m0, s34, 0
    s_nop 0
    buffer_load_dwordx4 v194, s[12:15], s31 offen lds
    s_waitcnt lgkmcnt(7)
    v_mfma_f32_16x16x32_bf16 v[80:83], v[200:203], v[148:151], v[80:83]
    ds_read_b128 v[164:167], v193 offset:1024
    v_mfma_f32_16x16x32_bf16 v[84:87], v[204:207], v[148:151], v[84:87]
    ds_read_b64_tr_b16 v[132:133], v185 offset:0
    ds_read_b64_tr_b16 v[134:135], v185 offset:8192
    s_add_u32 m0, s34, 1024
    s_nop 0
    buffer_load_dwordx4 v195, s[12:15], s31 offen lds
    s_add_u32 s31, s31, s37
    s_waitcnt lgkmcnt(8)
    v_mfma_f32_16x16x32_bf16 v[96:99], v[200:203], v[152:155], v[96:99]
    v_mfma_f32_16x16x32_bf16 v[100:103], v[204:207], v[152:155], v[100:103]
    ds_read_b64_tr_b16 v[136:137], v186 offset:0
    ds_read_b64_tr_b16 v[138:139], v186 offset:8192
    s_add_u32 m0, s35, 0
    s_nop 0
    buffer_load_dwordx4 v196, s[16:19], s32 offen lds
    s_add_u32 s32, s32, 1024
    s_waitcnt lgkmcnt(8)
    v_mfma_f32_16x16x32_bf16 v[112:115], v[200:203], v[156:159], v[112:115]
    v_mfma_f32_16x16x32_bf16 v[116:119], v[204:207], v[156:159], v[116:119]
    ds_read_b64_tr_b16 v[140:141], v187 offset:0
    ds_read_b64_tr_b16 v[142:143], v187 offset:8192
    s_waitcnt lgkmcnt(7)
    v_mfma_f32_16x16x32_bf16 v[0:3], v[160:163], v[128:131], v[0:3]
    ds_read_b64_tr_b16 v[144:145], v188 offset:0
    ds_read_b64_tr_b16 v[146:147], v188 offset:8192
    s_waitcnt lgkmcnt(8)
    v_mfma_f32_16x16x32_bf16 v[4:7], v[164:167], v[128:131], v[4:7]
    s_waitcnt lgkmcnt(6)
    v_mfma_f32_16x16x32_bf16 v[16:19], v[160:163], v[132:135], v[16:19]
    ds_read_b64_tr_b16 v[148:149], v189 offset:0
    ds_read_b64_tr_b16 v[150:151], v189 offset:8192
    v_mfma_f32_16x16x32_bf16 v[20:23], v[164:167], v[132:135], v[20:23]
    s_waitcnt lgkmcnt(6)
    v_mfma_f32_16x16x32_bf16 v[32:35], v[160:163], v[136:139], v[32:35]
    ds_read_b64_tr_b16 v[152:153], v190 offset:0
    ds_read_b64_tr_b16 v[154:155], v190 offset:8192
    v_mfma_f32_16x16x32_bf16 v[36:39], v[164:167], v[136:139], v[36:39]
    s_waitcnt lgkmcnt(6)
    v_mfma_f32_16x16x32_bf16 v[48:51], v[160:163], v[140:143], v[48:51]
    ds_read_b64_tr_b16 v[156:157], v191 offset:0
    ds_read_b64_tr_b16 v[158:159], v191 offset:8192
    v_mfma_f32_16x16x32_bf16 v[52:55], v[164:167], v[140:143], v[52:55]
    s_waitcnt vmcnt(3)
    s_barrier
    s_waitcnt lgkmcnt(6)
    v_mfma_f32_16x16x32_bf16 v[64:67], v[160:163], v[144:147], v[64:67]
    ds_read_b128 v[200:203], v193 offset:32768
    v_mfma_f32_16x16x32_bf16 v[68:71], v[164:167], v[144:147], v[68:71]
    ds_read_b64_tr_b16 v[128:129], v184 offset:32768
    ds_read_b64_tr_b16 v[130:131], v184 offset:40960
    s_add_u32 m0, s34, 32768
    s_nop 0
    buffer_load_dwordx4 v194, s[12:15], s31 offen lds
    s_waitcnt lgkmcnt(7)
    v_mfma_f32_16x16x32_bf16 v[80:83], v[160:163], v[148:151], v[80:83]
    ds_read_b128 v[204:207], v193 offset:33792
    v_mfma_f32_16x16x32_bf16 v[84:87], v[164:167], v[148:151], v[84:87]
    ds_read_b64_tr_b16 v[132:133], v185 offset:32768
    ds_read_b64_tr_b16 v[134:135], v185 offset:40960
    s_add_u32 m0, s34, 33792
    s_nop 0
    buffer_load_dwordx4 v195, s[12:15], s31 offen lds
    s_add_u32 s31, s31, s37
    s_waitcnt lgkmcnt(8)
    v_mfma_f32_16x16x32_bf16 v[96:99], v[160:163], v[152:155], v[96:99]
    v_mfma_f32_16x16x32_bf16 v[100:103], v[164:167], v[152:155], v[100:103]
    ds_read_b64_tr_b16 v[136:137], v186 offset:32768
    ds_read_b64_tr_b16 v[138:139], v186 offset:40960
    s_add_u32 m0, s35, 32768
    s_nop 0
    buffer_load_dwordx4 v196, s[16:19], s32 offen lds
    s_add_u32 s32, s32, 1024
    s_waitcnt lgkmcnt(8)
    v_mfma_f32_16x16x32_bf16 v[112:115], v[160:163], v[156:159], v[112:115]
    v_mfma_f32_16x16x32_bf16 v[116:119], v[164:167], v[156:159], v[116:119]
    ds_read_b64_tr_b16 v[140:141], v187 offset:32768
    ds_read_b64_tr_b16 v[142:143], v187 offset:40960
    s_waitcnt lgkmcnt(7)
    v_mfma_f32_16x16x32_bf16 v[0:3], v[200:203], v[128:131], v[0:3]
    ds_read_b64_tr_b16 v[144:145], v188 offset:32768
    ds_read_b64_tr_b16 v[146:147], v188 offset:40960
    s_waitcnt lgkmcnt(8)
    v_mfma_f32_16x16x32_bf16 v[4:7], v[204:207], v[128:131], v[4:7]
    s_waitcnt lgkmcnt(6)
    v_mfma_f32_16x16x32_bf16 v[16:19], v[200:203], v[132:135], v[16:19]
    ds_read_b64_tr_b16 v[148:149], v189 offset:32768
    ds_read_b64_tr_b16 v[150:151], v189 offset:40960
    v_mfma_f32_16x16x32_bf16 v[20:23], v[204:207], v[132:135], v[20:23]
    s_waitcnt lgkmcnt(6)
    v_mfma_f32_16x16x32_bf16 v[32:35], v[200:203], v[136:139], v[32:35]
    ds_read_b64_tr_b16 v[152:153], v190 offset:32768
    ds_read_b64_tr_b16 v[154:155], v190 offset:40960
    v_mfma_f32_16x16x32_bf16 v[36:39], v[204:207], v[136:139], v[36:39]
    s_waitcnt lgkmcnt(6)
    v_mfma_f32_16x16x32_bf16 v[48:51], v[200:203], v[140:143], v[48:51]
    ds_read_b64_tr_b16 v[156:157], v191 offset:32768
    ds_read_b64_tr_b16 v[158:159], v191 offset:40960
    v_mfma_f32_16x16x32_bf16 v[52:55], v[204:207], v[140:143], v[52:55]
    s_waitcnt vmcnt(3)
    s_barrier
    s_waitcnt lgkmcnt(6)
    v_mfma_f32_16x16x32_bf16 v[64:67], v[200:203], v[144:147], v[64:67]
    ds_read_b128 v[160:163], v192 offset:0
    v_mfma_f32_16x16x32_bf16 v[68:71], v[204:207], v[144:147], v[68:71]
    ds_read_b64_tr_b16 v[128:129], v176 offset:0
    ds_read_b64_tr_b16 v[130:131], v176 offset:8192
    s_add_u32 m0, s34, 65536
    s_nop 0
    buffer_load_dwordx4 v194, s[12:15], s31 offen lds
    s_waitcnt lgkmcnt(7)
    v_mfma_f32_16x16x32_bf16 v[80:83], v[200:203], v[148:151], v[80:83]
    ds_read_b128 v[164:167], v192 offset:1024
    v_mfma_f32_16x16x32_bf16 v[84:87], v[204:207], v[148:151], v[84:87]
    ds_read_b64_tr_b16 v[132:133], v177 offset:0
    ds_read_b64_tr_b16 v[134:135], v177 offset:8192
    s_add_u32 m0, s34, 66560
    s_nop 0
    buffer_load_dwordx4 v195, s[12:15], s31 offen lds
    s_add_u32 s31, s31, s37
    s_waitcnt lgkmcnt(8)
    v_mfma_f32_16x16x32_bf16 v[96:99], v[200:203], v[152:155], v[96:99]
    v_mfma_f32_16x16x32_bf16 v[100:103], v[204:207], v[152:155], v[100:103]
    ds_read_b64_tr_b16 v[136:137], v178 offset:0
    ds_read_b64_tr_b16 v[138:139], v178 offset:8192
    s_add_u32 m0, s35, 65536
    s_nop 0
    buffer_load_dwordx4 v196, s[16:19], s32 offen lds
    s_add_u32 s32, s32, 1024
    s_waitcnt lgkmcnt(8)
    v_mfma_f32_16x16x32_bf16 v[112:115], v[200:203], v[156:159], v[112:115]
    v_mfma_f32_16x16x32_bf16 v[116:119], v[204:207], v[156:159], v[116:119]
    ds_read_b64_tr_b16 v[140:141], v179 offset:0
    ds_read_b64_tr_b16 v[142:143], v179 offset:8192
    s_waitcnt lgkmcnt(7)
    v_mfma_f32_16x16x32_bf16 v[0:3], v[160:163], v[128:131], v[0:3]
    ds_read_b64_tr_b16 v[144:145], v180 offset:0
    ds_read_b64_tr_b16 v[146:147], v180 offset:8192
    s_waitcnt lgkmcnt(8)
    v_mfma_f32_16x16x32_bf16 v[4:7], v[164:167], v[128:131], v[4:7]
    s_waitcnt lgkmcnt(6)
    v_mfma_f32_16x16x32_bf16 v[16:19], v[160:163], v[132:135], v[16:19]
    ds_read_b64_tr_b16 v[148:149], v181 offset:0
    ds_read_b64_tr_b16 v[150:151], v181 offset:8192
    v_mfma_f32_16x16x32_bf16 v[20:23], v[164:167], v[132:135], v[20:23]
    s_waitcnt lgkmcnt(6)
    v_mfma_f32_16x16x32_bf16 v[32:35], v[160:163], v[136:139], v[32:35]
    ds_read_b64_tr_b16 v[152:153], v182 offset:0
    ds_read_b64_tr_b16 v[154:155], v182 offset:8192
    v_mfma_f32_16x16x32_bf16 v[36:39], v[164:167], v[136:139], v[36:39]
    s_waitcnt lgkmcnt(6)
    v_mfma_f32_16x16x32_bf16 v[48:51], v[160:163], v[140:143], v[48:51]
    ds_read_b64_tr_b16 v[156:157], v183 offset:0
    ds_read_b64_tr_b16 v[158:159], v183 offset:8192
    v_mfma_f32_16x16x32_bf16 v[52:55], v[164:167], v[140:143], v[52:55]
    s_waitcnt vmcnt(3)
    s_barrier
    s_waitcnt lgkmcnt(6)
    v_mfma_f32_16x16x32_bf16 v[64:67], v[160:163], v[144:147], v[64:67]
    ds_read_b128 v[200:203], v192 offset:32768
    v_mfma_f32_16x16x32_bf16 v[68:71], v[164:167], v[144:147], v[68:71]
    ds_read_b64_tr_b16 v[128:129], v176 offset:32768
    ds_read_b64_tr_b16 v[130:131], v176 offset:40960
    s_add_u32 m0, s34, 98304
    s_nop 0
    buffer_load_dwordx4 v194, s[12:15], s31 offen lds
    s_waitcnt lgkmcnt(7)
    v_mfma_f32_16x16x32_bf16 v[80:83], v[160:163], v[148:151], v[80:83]
    ds_read_b128 v[204:207], v192 offset:33792
    v_mfma_f32_16x16x32_bf16 v[84:87], v[164:167], v[148:151], v[84:87]
    ds_read_b64_tr_b16 v[132:133], v177 offset:32768
    ds_read_b64_tr_b16 v[134:135], v177 offset:40960
    s_add_u32 m0, s34, 99328
    s_nop 0
    buffer_load_dwordx4 v195, s[12:15], s31 offen lds
    s_add_u32 s31, s31, s37
    s_waitcnt lgkmcnt(8)
    v_mfma_f32_16x16x32_bf16 v[96:99], v[160:163], v[152:155], v[96:99]
    v_mfma_f32_16x16x32_bf16 v[100:103], v[164:167], v[152:155], v[100:103]
    ds_read_b64_tr_b16 v[136:137], v178 offset:32768
    ds_read_b64_tr_b16 v[138:139], v178 offset:40960
    s_add_u32 m0, s35, 98304
    s_nop 0
    buffer_load_dwordx4 v196, s[16:19], s32 offen lds
    s_add_u32 s32, s32, 1024
    s_waitcnt lgkmcnt(8)
    v_mfma_f32_16x16x32_bf16 v[112:115], v[160:163], v[156:159], v[112:115]
    v_mfma_f32_16x16x32_bf16 v[116:119], v[164:167], v[156:159], v[116:119]
    ds_read_b64_tr_b16 v[140:141], v179 offset:32768
    ds_read_b64_tr_b16 v[142:143], v179 offset:40960
    s_waitcnt lgkmcnt(7)
    v_mfma_f32_16x16x32_bf16 v[0:3], v[200:203], v[128:131], v[0:3]
    ds_read_b64_tr_b16 v[144:145], v180 offset:32768
    ds_read_b64_tr_b16 v[146:147], v180 offset:40960
    s_waitcnt lgkmcnt(8)
    v_mfma_f32_16x16x32_bf16 v[4:7], v[204:207], v[128:131], v[4:7]
    s_waitcnt lgkmcnt(6)
    v_mfma_f32_16x16x32_bf16 v[16:19], v[200:203], v[132:135], v[16:19]
    ds_read_b64_tr_b16 v[148:149], v181 offset:32768
    ds_read_b64_tr_b16 v[150:151], v181 offset:40960
    v_mfma_f32_16x16x32_bf16 v[20:23], v[204:207], v[132:135], v[20:23]
    s_waitcnt lgkmcnt(6)
    v_mfma_f32_16x16x32_bf16 v[32:35], v[200:203], v[136:139], v[32:35]
    ds_read_b64_tr_b16 v[152:153], v182 offset:32768
    ds_read_b64_tr_b16 v[154:155], v182 offset:40960
    v_mfma_f32_16x16x32_bf16 v[36:39], v[204:207], v[136:139], v[36:39]
    s_waitcnt lgkmcnt(6)
    v_mfma_f32_16x16x32_bf16 v[48:51], v[200:203], v[140:143], v[48:51]
    ds_read_b64_tr_b16 v[156:157], v183 offset:32768
    ds_read_b64_tr_b16 v[158:159], v183 offset:40960
    v_mfma_f32_16x16x32_bf16 v[52:55], v[204:207], v[140:143], v[52:55]
    s_waitcnt vmcnt(3)
    s_barrier
    s_waitcnt lgkmcnt(6)
    v_mfma_f32_16x16x32_bf16 v[64:67], v[200:203], v[144:147], v[64:67]
    ds_read_b128 v[160:163], v193 offset:0
    v_mfma_f32_16x16x32_bf16 v[68:71], v[204:207], v[144:147], v[68:71]
    ds_read_b64_tr_b16 v[128:129], v184 offset:0
    ds_read_b64_tr_b16 v[130:131], v184 offset:8192
    s_waitcnt lgkmcnt(7)
    v_mfma_f32_16x16x32_bf16 v[80:83], v[200:203], v[148:151], v[80:83]
    ds_read_b128 v[164:167], v193 offset:1024
    v_mfma_f32_16x16x32_bf16 v[84:87], v[204:207], v[148:151], v[84:87]
    ds_read_b64_tr_b16 v[132:133], v185 offset:0
    ds_read_b64_tr_b16 v[134:135], v185 offset:8192
    s_waitcnt lgkmcnt(8)
    v_mfma_f32_16x16x32_bf16 v[96:99], v[200:203], v[152:155], v[96:99]
    v_mfma_f32_16x16x32_bf16 v[100:103], v[204:207], v[152:155], v[100:103]
    ds_read_b64_tr_b16 v[136:137], v186 offset:0
    ds_read_b64_tr_b16 v[138:139], v186 offset:8192
    s_waitcnt lgkmcnt(8)
    v_mfma_f32_16x16x32_bf16 v[112:115], v[200:203], v[156:159], v[112:115]
    v_mfma_f32_16x16x32_bf16 v[116:119], v[204:207], v[156:159], v[116:119]
    ds_read_b64_tr_b16 v[140:141], v187 offset:0
    ds_read_b64_tr_b16 v[142:143], v187 offset:8192
    s_waitcnt lgkmcnt(7)
    v_mfma_f32_16x16x32_bf16 v[0:3], v[160:163], v[128:131], v[0:3]
    ds_read_b64_tr_b16 v[144:145], v188 offset:0
    ds_read_b64_tr_b16 v[146:147], v188 offset:8192
    s_waitcnt lgkmcnt(8)
    v_mfma_f32_16x16x32_bf16 v[4:7], v[164:167], v[128:131], v[4:7]
    s_waitcnt lgkmcnt(6)
    v_mfma_f32_16x16x32_bf16 v[16:19], v[160:163], v[132:135], v[16:19]
    ds_read_b64_tr_b16 v[148:149], v189 offset:0
    ds_read_b64_tr_b16 v[150:151], v189 offset:8192
    v_mfma_f32_16x16x32_bf16 v[20:23], v[164:167], v[132:135], v[20:23]
    s_waitcnt lgkmcnt(6)
    v_mfma_f32_16x16x32_bf16 v[32:35], v[160:163], v[136:139], v[32:35]
    ds_read_b64_tr_b16 v[152:153], v190 offset:0
    ds_read_b64_tr_b16 v[154:155], v190 offset:8192
    v_mfma_f32_16x16x32_bf16 v[36:39], v[164:167], v[136:139], v[36:39]
    s_waitcnt lgkmcnt(6)
    v_mfma_f32_16x16x32_bf16 v[48:51], v[160:163], v[140:143], v[48:51]
    ds_read_b64_tr_b16 v[156:157], v191 offset:0
    ds_read_b64_tr_b16 v[158:159], v191 offset:8192
    v_mfma_f32_16x16x32_bf16 v[52:55], v[164:167], v[140:143], v[52:55]
    s_waitcnt vmcnt(0)
    s_barrier
    s_waitcnt lgkmcnt(6)
    v_mfma_f32_16x16x32_bf16 v[64:67], v[160:163], v[144:147], v[64:67]
    ds_read_b128 v[200:203], v193 offset:32768
    v_mfma_f32_16x16x32_bf16 v[68:71], v[164:167], v[144:147], v[68:71]
    ds_read_b64_tr_b16 v[128:129], v184 offset:32768
    ds_read_b64_tr_b16 v[130:131], v184 offset:40960
    s_waitcnt lgkmcnt(7)
    v_mfma_f32_16x16x32_bf16 v[80:83], v[160:163], v[148:151], v[80:83]
    ds_read_b128 v[204:207], v193 offset:33792
    v_mfma_f32_16x16x32_bf16 v[84:87], v[164:167], v[148:151], v[84:87]
    ds_read_b64_tr_b16 v[132:133], v185 offset:32768
    ds_read_b64_tr_b16 v[134:135], v185 offset:40960
    s_waitcnt lgkmcnt(8)
    v_mfma_f32_16x16x32_bf16 v[96:99], v[160:163], v[152:155], v[96:99]
    v_mfma_f32_16x16x32_bf16 v[100:103], v[164:167], v[152:155], v[100:103]
    ds_read_b64_tr_b16 v[136:137], v186 offset:32768
    ds_read_b64_tr_b16 v[138:139], v186 offset:40960
    s_waitcnt lgkmcnt(8)
    v_mfma_f32_16x16x32_bf16 v[112:115], v[160:163], v[156:159], v[112:115]
    v_mfma_f32_16x16x32_bf16 v[116:119], v[164:167], v[156:159], v[116:119]
    ds_read_b64_tr_b16 v[140:141], v187 offset:32768
    ds_read_b64_tr_b16 v[142:143], v187 offset:40960
    s_waitcnt lgkmcnt(7)
    v_mfma_f32_16x16x32_bf16 v[0:3], v[200:203], v[128:131], v[0:3]
    ds_read_b64_tr_b16 v[144:145], v188 offset:32768
    ds_read_b64_tr_b16 v[146:147], v188 offset:40960
    s_waitcnt lgkmcnt(8)
    v_mfma_f32_16x16x32_bf16 v[4:7], v[204:207], v[128:131], v[4:7]
    s_waitcnt lgkmcnt(6)
    v_mfma_f32_16x16x32_bf16 v[16:19], v[200:203], v[132:135], v[16:19]
    ds_read_b64_tr_b16 v[148:149], v189 offset:32768
    ds_read_b64_tr_b16 v[150:151], v189 offset:40960
    v_mfma_f32_16x16x32_bf16 v[20:23], v[204:207], v[132:135], v[20:23]
    s_waitcnt lgkmcnt(6)
    v_mfma_f32_16x16x32_bf16 v[32:35], v[200:203], v[136:139], v[32:35]
    ds_read_b64_tr_b16 v[152:153], v190 offset:32768
    ds_read_b64_tr_b16 v[154:155], v190 offset:40960
    v_mfma_f32_16x16x32_bf16 v[36:39], v[204:207], v[136:139], v[36:39]
    s_waitcnt lgkmcnt(6)
    v_mfma_f32_16x16x32_bf16 v[48:51], v[200:203], v[140:143], v[48:51]
    ds_read_b64_tr_b16 v[156:157], v191 offset:32768
    ds_read_b64_tr_b16 v[158:159], v191 offset:40960
    v_mfma_f32_16x16x32_bf16 v[52:55], v[204:207], v[140:143], v[52:55]
    s_waitcnt lgkmcnt(6)
    v_mfma_f32_16x16x32_bf16 v[64:67], v[200:203], v[144:147], v[64:67]
    v_mfma_f32_16x16x32_bf16 v[68:71], v[204:207], v[144:147], v[68:71]
    s_waitcnt lgkmcnt(4)
    v_mfma_f32_16x16x32_bf16 v[80:83], v[200:203], v[148:151], v[80:83]
    v_mfma_f32_16x16x32_bf16 v[84:87], v[204:207], v[148:151], v[84:87]
    s_waitcnt lgkmcnt(2)
    v_mfma_f32_16x16x32_bf16 v[96:99], v[200:203], v[152:155], v[96:99]
    v_mfma_f32_16x16x32_bf16 v[100:103], v[204:207], v[152:155], v[100:103]
    s_waitcnt lgkmcnt(0)
    v_mfma_f32_16x16x32_bf16 v[112:115], v[200:203], v[156:159], v[112:115]
    v_mfma_f32_16x16x32_bf16 v[116:119], v[204:207], v[156:159], v[116:119]
    s_nop 7
    s_nop 1
    s_add_u32 s20, s6, 0x2400000
    s_addc_u32 s21, s7, 0
    s_mov_b32 s22, 0x1000000
    s_mov_b32 s23, 0x20000
    s_lshl_b32 s47, s28, 2
    s_add_u32 s47, s47, s52
    s_lshl_b32 s47, s47, 5
    s_lshl_b32 s54, s39, 1
    s_add_u32 s54, s54, s53
    s_add_u32 s47, s47, s54
    s_lshl_b32 s47, s47, 13
    v_cvt_pk_bf16_f32 v128, v0, v1
    v_cvt_pk_bf16_f32 v129, v2, v3
    v_cvt_pk_bf16_f32 v130, v4, v5
    v_cvt_pk_bf16_f32 v131, v6, v7
    buffer_store_dwordx4 v[128:131], v197, s[20:23], s47 offen offset:0 sc1
    v_cvt_pk_bf16_f32 v132, v16, v17
    v_cvt_pk_bf16_f32 v133, v18, v19
    v_cvt_pk_bf16_f32 v134, v20, v21
    v_cvt_pk_bf16_f32 v135, v22, v23
    buffer_store_dwordx4 v[132:135], v197, s[20:23], s47 offen offset:1024 sc1
    v_cvt_pk_bf16_f32 v136, v32, v33
    v_cvt_pk_bf16_f32 v137, v34, v35
    v_cvt_pk_bf16_f32 v138, v36, v37
    v_cvt_pk_bf16_f32 v139, v38, v39
    buffer_store_dwordx4 v[136:139], v197, s[20:23], s47 offen offset:2048 sc1
    v_cvt_pk_bf16_f32 v140, v48, v49
    v_cvt_pk_bf16_f32 v141, v50, v51
    v_cvt_pk_bf16_f32 v142, v52, v53
    v_cvt_pk_bf16_f32 v143, v54, v55
    buffer_store_dwordx4 v[140:143], v197, s[20:23], s47 offen offset:3072 sc1
    s_add_u32 s47, s47, 4096
    v_cvt_pk_bf16_f32 v128, v64, v65
    v_cvt_pk_bf16_f32 v129, v66, v67
    v_cvt_pk_bf16_f32 v130, v68, v69
    v_cvt_pk_bf16_f32 v131, v70, v71
    buffer_store_dwordx4 v[128:131], v197, s[20:23], s47 offen offset:0 sc1
    v_cvt_pk_bf16_f32 v132, v80, v81
    v_cvt_pk_bf16_f32 v133, v82, v83
    v_cvt_pk_bf16_f32 v134, v84, v85
    v_cvt_pk_bf16_f32 v135, v86, v87
    buffer_store_dwordx4 v[132:135], v197, s[20:23], s47 offen offset:1024 sc1
    v_cvt_pk_bf16_f32 v136, v96, v97
    v_cvt_pk_bf16_f32 v137, v98, v99
    v_cvt_pk_bf16_f32 v138, v100, v101
    v_cvt_pk_bf16_f32 v139, v102, v103
    buffer_store_dwordx4 v[136:139], v197, s[20:23], s47 offen offset:2048 sc1
    v_cvt_pk_bf16_f32 v140, v112, v113
    v_cvt_pk_bf16_f32 v141, v114, v115
    v_cvt_pk_bf16_f32 v142, v116, v117
    v_cvt_pk_bf16_f32 v143, v118, v119
    buffer_store_dwordx4 v[140:143], v197, s[20:23], s47 offen offset:3072 sc1
W_next:
    s_cmp_lg_u32 s72, 0
    s_cbranch_scc1 W_ns1
W_ns1:
    s_waitcnt vmcnt(0)
    s_barrier
    s_cmp_lg_u32 s33, 0
    s_cbranch_scc1 FA_16
    s_mov_b64 exec, 1
    s_lshl_b32 s3, s73, 7
    v_mov_b32 v254, 0
    v_mov_b32 v255, s84
    buffer_atomic_add v255, v254, s[76:79], s3 offen
    s_mov_b64 exec, -1
FA_16:
    s_cmp_lg_u32 s72, 0
    s_cbranch_scc1 W_ns2
W_ns2:
    s_cmp_lg_u32 s72, 3
    s_cbranch_scc1 W_ns3
W_ns3:
W_skip:
    s_add_u32 s72, s72, 1
    s_cmp_lt_u32 s72, 6
    s_cbranch_scc1 W_task
    s_branch W_attn
W_side:
    s_sub_u32 s58, s58, 56
    s_lshl_b32 s58, s58, 3
    s_add_u32 s58, s58, s33
    v_lshrrev_b32 v1, 4, v197
    s_mov_b32 s37, 0x1999999a
    v_add_u32 v2, 0, v1
    v_mul_hi_u32 v3, v2, s37
    v_mul_u32_u24 v4, 10, v3
    v_sub_u32 v4, v2, v4
    v_mul_u32_u24 v3, 1280, v3
    v_lshl_add_u32 v8, v4, 4, v3
    v_add_u32 v2, 64, v1
    v_mul_hi_u32 v3, v2, s37
    v_mul_u32_u24 v4, 10, v3
    v_sub_u32 v4, v2, v4
    v_mul_u32_u24 v3, 1280, v3
    v_lshl_add_u32 v9, v4, 4, v3
    v_add_u32 v2, 128, v1
    v_mul_hi_u32 v3, v2, s37
    v_mul_u32_u24 v4, 10, v3
    v_sub_u32 v4, v2, v4
    v_mul_u32_u24 v3, 1280, v3
    v_lshl_add_u32 v10, v4, 4, v3
    v_add_u32 v2, 192, v1
    v_mul_hi_u32 v3, v2, s37
    v_mul_u32_u24 v4, 10, v3
    v_sub_u32 v4, v2, v4
    v_mul_u32_u24 v3, 1280, v3
    v_lshl_add_u32 v11, v4, 4, v3
    v_add_u32 v2, 256, v1
    v_mul_hi_u32 v3, v2, s37
    v_mul_u32_u24 v4, 10, v3
    v_sub_u32 v4, v2, v4
    v_mul_u32_u24 v3, 1280, v3
    v_lshl_add_u32 v12, v4, 4, v3
    s_mul_i32 s34, s33, 5120
    v_lshrrev_b32 v2, 2, v1
    v_mul_u32_u24 v2, 160, v2
    v_and_b32 v3, 3, v1
    v_lshl_add_u32 v2, v3, 3, v2
    v_add_u32 v13, s34, v2
    v_add_u32 v14, 4096, v197
    s_add_u32 s24, s6, 0x6800000
    s_addc_u32 s25, s7, 0
    s_mov_b32 s26, 0xa00000
    s_mov_b32 s27, 0x20000
W_rl:
    s_and_b32 s3, s58, 7
    s_lshr_b32 s47, s58, 3
    s_cmp_lt_u32 s47, 128
    s_cselect_b32 s8, s60, s64
    s_cselect_b32 s9, s61, s65
    s_mov_b32 s10, 2211840
    s_cmov_b32 s10, 5242880
    s_mov_b32 s11, 0x20000
    s_cselect_b32 s54, 0, 128
    s_mov_b32 s55, 54
    s_cmov_b32 s55, 128
    s_mov_b32 s56, 6291456
    s_cmov_b32 s56, 0
    s_sub_u32 s54, s47, s54
    s_mul_i32 s55, s55, s3
    s_add_u32 s55, s55, s54
    s_mul_i32 s55, s55, 5120
    s_add_u32 s55, s55, s56
    s_mul_i32 s54, s54, 40960
    s_mul_i32 s3, s3, 160
    s_add_u32 s54, s54, s3
    s_add_u32 m0, s34, 0
    s_nop 0
    buffer_load_dwordx4 v8, s[8:11], s54 offen lds
    s_add_u32 m0, s34, 1024
    s_nop 0
    buffer_load_dwordx4 v9, s[8:11], s54 offen lds
    s_add_u32 m0, s34, 2048
    s_nop 0
    buffer_load_dwordx4 v10, s[8:11], s54 offen lds
    s_add_u32 m0, s34, 3072
    s_nop 0
    buffer_load_dwordx4 v11, s[8:11], s54 offen lds
    s_add_u32 m0, s34, 4096
    s_nop 0
    buffer_load_dwordx4 v12, s[8:11], s54 offen lds
    s_waitcnt vmcnt(0)
    ds_read_b64_tr_b16 v[16:17], v13 offset:0
    ds_read_b64_tr_b16 v[18:19], v13 offset:2560
    ds_read_b64_tr_b16 v[20:21], v13 offset:32
    ds_read_b64_tr_b16 v[22:23], v13 offset:2592
    ds_read_b64_tr_b16 v[24:25], v13 offset:64
    ds_read_b64_tr_b16 v[26:27], v13 offset:2624
    ds_read_b64_tr_b16 v[28:29], v13 offset:96
    ds_read_b64_tr_b16 v[30:31], v13 offset:2656
    ds_read_b64_tr_b16 v[32:33], v13 offset:128
    ds_read_b64_tr_b16 v[34:35], v13 offset:2688
    s_waitcnt lgkmcnt(0)
    buffer_store_dwordx4 v[16:19], v197, s[24:27], s55 offen offset:0 sc1
    buffer_store_dwordx4 v[20:23], v197, s[24:27], s55 offen offset:1024 sc1
    buffer_store_dwordx4 v[24:27], v197, s[24:27], s55 offen offset:2048 sc1
    buffer_store_dwordx4 v[28:31], v197, s[24:27], s55 offen offset:3072 sc1
    buffer_store_dwordx4 v[32:35], v14, s[24:27], s55 offen offset:0 sc1
    s_add_u32 s58, s58, 576
    s_cmp_lt_u32 s58, 1456
    s_cbranch_scc1 W_rl
    s_mov_b32 s73, 200
    s_waitcnt vmcnt(0)
    s_barrier
    s_cmp_lg_u32 s33, 0
    s_cbranch_scc1 FA_17
    s_mov_b64 exec, 1
    s_lshl_b32 s3, s73, 7
    v_mov_b32 v254, 0
    v_mov_b32 v255, 1
    buffer_atomic_add v255, v254, s[76:79], s3 offen
    s_mov_b64 exec, -1
FA_17:
W_attn:
    v_mov_b32 v250, v197
    v_lshrrev_b32 v251, 4, v250
    v_add_u32 v253, 4096, v250
    v_and_b32 v249, 31, v251
    v_lshlrev_b32 v249, 4, v249
    v_mov_b32 v0, 0xf149f2ca
    v_cmp_gt_u32 vcc, 32, v251
    s_nop 1
    v_cndmask_b32 v240, 0, v0, vcc
    v_cndmask_b32 v241, 0, v0, vcc
    v_cndmask_b32 v242, 0, v0, vcc
    v_cndmask_b32 v243, 0, v0, vcc
    v_lshrrev_b32 v1, 4, v251
    v_lshlrev_b32 v1, 2, v1
    v_and_b32 v2, 15, v251
    v_add_u32 v244, 0, v1
    v_cmp_gt_u32 vcc, v244, v2
    s_nop 1
    v_cndmask_b32 v244, 0, v0, vcc
    v_add_u32 v245, 1, v1
    v_cmp_gt_u32 vcc, v245, v2
    s_nop 1
    v_cndmask_b32 v245, 0, v0, vcc
    v_add_u32 v246, 2, v1
    v_cmp_gt_u32 vcc, v246, v2
    s_nop 1
    v_cndmask_b32 v246, 0, v0, vcc
    v_add_u32 v247, 3, v1
    v_cmp_gt_u32 vcc, v247, v2
    s_nop 1
    v_cndmask_b32 v247, 0, v0, vcc
    s_mov_b32 s74, 200
    s_cmp_lg_u32 s33, 0
    s_cbranch_scc1 FK_19
    s_lshl_b32 s3, s74, 7
    v_mov_b32 v254, 0
FW_18:
    buffer_load_dword v255, v254, s[76:79], s3 offen sc1
    s_waitcnt vmcnt(0)
    v_readfirstlane_b32 s75, v255
    s_cmp_ge_u32 s75, 72
    s_cbranch_scc1 FK_19
    s_sleep 16
    s_sub_u32 s44, s44, 1
    s_cbranch_scc0 FW_18
    s_branch M_done2
FK_19:
    s_barrier
    s_lshr_b32 s52, s33, 2
    s_and_b32 s53, s33, 3
    s_lshl_b32 s36, s71, 1
    s_add_u32 s36, s36, s52
    s_add_u32 s12, s6, 0x6e00000
    s_addc_u32 s13, s7, 0
    s_mov_b32 s14, 0x21c000
    s_mov_b32 s15, 0x20000
    s_add_u32 s20, s6, 0x3400000
    s_addc_u32 s21, s7, 0
    s_mov_b32 s22, 0x6c0000
    s_mov_b32 s23, 0x20000
    s_lshr_b32 s74, s71, 1
    s_add_u32 s74, s74, 192
    s_cmp_lg_u32 s33, 0
    s_cbranch_scc1 FK_21
    s_lshl_b32 s3, s74, 7
    v_mov_b32 v254, 0
FW_20:
    buffer_load_dword v255, v254, s[76:79], s3 offen sc1
    s_waitcnt vmcnt(0)
    v_readfirstlane_b32 s75, v255
    s_cmp_ge_u32 s75, 7
    s_cbranch_scc1 FK_21
    s_sleep 16
    s_sub_u32 s44, s44, 1
    s_cbranch_scc0 FW_20
    s_branch M_done2
FK_21:
    s_barrier
    v_add_u32 v232, 0, v250
    v_add_u32 v233, 55296, v250
    v_add_u32 v234, 110592, v250
    v_add_u32 v235, 165888, v250
    s_mul_i32 s3, s53, 13
    s_min_u32 s43, s53, 2
    s_add_u32 s3, s3, s43
    s_mul_i32 s40, s36, 4*54*1024
    s_lshl_b32 s43, s3, 10
    s_add_u32 s40, s40, s43
    s_mul_i32 s41, s70, 54
    s_add_u32 s41, s41, s3
    s_mul_i32 s41, s41, 5120
    s_cmp_lt_u32 s53, 2
    s_cselect_b32 s42, 14, 13
    buffer_load_dwordx4 v[96:99], v250, s[12:15], s41 offen offset:0 sc1
    buffer_load_dwordx4 v[100:103], v250, s[12:15], s41 offen offset:1024 sc1
    buffer_load_dwordx4 v[104:107], v250, s[12:15], s41 offen offset:2048 sc1
    buffer_load_dwordx4 v[108:111], v250, s[12:15], s41 offen offset:3072 sc1
    buffer_load_dwordx4 v[112:115], v253, s[12:15], s41 offen offset:0 sc1
    buffer_load_dwordx4 v[80:83], v232, s[20:23], s40 offen sc1
    buffer_load_dwordx4 v[84:87], v233, s[20:23], s40 offen sc1
    buffer_load_dwordx4 v[88:91], v234, s[20:23], s40 offen sc1
    buffer_load_dwordx4 v[92:95], v235, s[20:23], s40 offen sc1
    s_add_u32 s41, s41, 5120
    s_add_u32 s40, s40, 1024
    buffer_load_dwordx4 v[132:135], v250, s[12:15], s41 offen offset:0 sc1
    buffer_load_dwordx4 v[136:139], v250, s[12:15], s41 offen offset:1024 sc1
    buffer_load_dwordx4 v[140:143], v250, s[12:15], s41 offen offset:2048 sc1
    buffer_load_dwordx4 v[144:147], v250, s[12:15], s41 offen offset:3072 sc1
    buffer_load_dwordx4 v[148:151], v253, s[12:15], s41 offen offset:0 sc1
    buffer_load_dwordx4 v[116:119], v232, s[20:23], s40 offen sc1
    buffer_load_dwordx4 v[120:123], v233, s[20:23], s40 offen sc1
    buffer_load_dwordx4 v[124:127], v234, s[20:23], s40 offen sc1
    buffer_load_dwordx4 v[128:131], v235, s[20:23], s40 offen sc1
    s_add_u32 s41, s41, 5120
    s_add_u32 s40, s40, 1024
    buffer_load_dwordx4 v[168:171], v250, s[12:15], s41 offen offset:0 sc1
    buffer_load_dwordx4 v[172:175], v250, s[12:15], s41 offen offset:1024 sc1
    buffer_load_dwordx4 v[176:179], v250, s[12:15], s41 offen offset:2048 sc1
    buffer_load_dwordx4 v[180:183], v250, s[12:15], s41 offen offset:3072 sc1
    buffer_load_dwordx4 v[184:187], v253, s[12:15], s41 offen offset:0 sc1
    buffer_load_dwordx4 v[152:155], v232, s[20:23], s40 offen sc1
    buffer_load_dwordx4 v[156:159], v233, s[20:23], s40 offen sc1
    buffer_load_dwordx4 v[160:163], v234, s[20:23], s40 offen sc1
    buffer_load_dwordx4 v[164:167], v235, s[20:23], s40 offen sc1
    s_add_u32 s41, s41, 5120
    s_add_u32 s40, s40, 1024
    v_mov_b32 v0, 0
    v_mov_b32 v1, 0
    v_mov_b32 v2, 0
    v_mov_b32 v3, 0
    v_mov_b32 v4, 0
    v_mov_b32 v5, 0
    v_mov_b32 v6, 0
    v_mov_b32 v7, 0
    v_mov_b32 v8, 0
    v_mov_b32 v9, 0
    v_mov_b32 v10, 0
    v_mov_b32 v11, 0
    v_mov_b32 v12, 0
    v_mov_b32 v13, 0
    v_mov_b32 v14, 0
    v_mov_b32 v15, 0
    v_mov_b32 v16, 0
    v_mov_b32 v17, 0
    v_mov_b32 v18, 0
    v_mov_b32 v19, 0
    v_mov_b32 v20, 0
    v_mov_b32 v21, 0
    v_mov_b32 v22, 0
    v_mov_b32 v23, 0
    v_mov_b32 v24, 0
    v_mov_b32 v25, 0
    v_mov_b32 v26, 0
    v_mov_b32 v27, 0
    v_mov_b32 v28, 0
    v_mov_b32 v29, 0
    v_mov_b32 v30, 0
    v_mov_b32 v31, 0
    v_mov_b32 v32, 0
    v_mov_b32 v33, 0
    v_mov_b32 v34, 0
    v_mov_b32 v35, 0
    v_mov_b32 v36, 0
    v_mov_b32 v37, 0
    v_mov_b32 v38, 0
    v_mov_b32 v39, 0
    v_mov_b32 v40, 0
    v_mov_b32 v41, 0
    v_mov_b32 v42, 0
    v_mov_b32 v43, 0
    v_mov_b32 v44, 0
    v_mov_b32 v45, 0
    v_mov_b32 v46, 0
    v_mov_b32 v47, 0
    v_mov_b32 v48, 0
    v_mov_b32 v49, 0
    v_mov_b32 v50, 0
    v_mov_b32 v51, 0
    v_mov_b32 v52, 0
    v_mov_b32 v53, 0
    v_mov_b32 v54, 0
    v_mov_b32 v55, 0
    v_mov_b32 v56, 0
    v_mov_b32 v57, 0
    v_mov_b32 v58, 0
    v_mov_b32 v59, 0
    v_mov_b32 v60, 0
    v_mov_b32 v61, 0
    v_mov_b32 v62, 0
    v_mov_b32 v63, 0
    v_mov_b32 v64, 0
    v_mov_b32 v65, 0
    v_mov_b32 v66, 0
    v_mov_b32 v67, 0
    v_mov_b32 v68, 0
    v_mov_b32 v69, 0
    v_mov_b32 v70, 0
    v_mov_b32 v71, 0
    v_mov_b32 v72, 0
    v_mov_b32 v73, 0
    v_mov_b32 v74, 0
    v_mov_b32 v75, 0
    v_mov_b32 v76, 0
    v_mov_b32 v77, 0
    v_mov_b32 v78, 0
    v_mov_b32 v79, 0
    s_mov_b32 s45, 0
P_gl:
    buffer_load_dwordx4 v[204:207], v250, s[12:15], s41 offen offset:0 sc1
    buffer_load_dwordx4 v[208:211], v250, s[12:15], s41 offen offset:1024 sc1
    buffer_load_dwordx4 v[212:215], v250, s[12:15], s41 offen offset:2048 sc1
    buffer_load_dwordx4 v[216:219], v250, s[12:15], s41 offen offset:3072 sc1
    buffer_load_dwordx4 v[220:223], v253, s[12:15], s41 offen offset:0 sc1
    buffer_load_dwordx4 v[188:191], v232, s[20:23], s40 offen sc1
    buffer_load_dwordx4 v[192:195], v233, s[20:23], s40 offen sc1
    buffer_load_dwordx4 v[196:199], v234, s[20:23], s40 offen sc1
    buffer_load_dwordx4 v[200:203], v235, s[20:23], s40 offen sc1
    s_add_u32 s41, s41, 5120
    s_add_u32 s40, s40, 1024
    s_waitcnt vmcnt(27)
    v_mfma_f32_16x16x32_bf16 v[0:3], v[96:99], v[80:83], v[0:3]
    v_mfma_f32_16x16x32_bf16 v[20:23], v[96:99], v[84:87], v[20:23]
    v_mfma_f32_16x16x32_bf16 v[40:43], v[96:99], v[88:91], v[40:43]
    v_mfma_f32_16x16x32_bf16 v[60:63], v[96:99], v[92:95], v[60:63]
    v_mfma_f32_16x16x32_bf16 v[4:7], v[100:103], v[80:83], v[4:7]
    v_mfma_f32_16x16x32_bf16 v[24:27], v[100:103], v[84:87], v[24:27]
    v_mfma_f32_16x16x32_bf16 v[44:47], v[100:103], v[88:91], v[44:47]
    v_mfma_f32_16x16x32_bf16 v[64:67], v[100:103], v[92:95], v[64:67]
    v_mfma_f32_16x16x32_bf16 v[8:11], v[104:107], v[80:83], v[8:11]
    v_mfma_f32_16x16x32_bf16 v[28:31], v[104:107], v[84:87], v[28:31]
    v_mfma_f32_16x16x32_bf16 v[48:51], v[104:107], v[88:91], v[48:51]
    v_mfma_f32_16x16x32_bf16 v[68:71], v[104:107], v[92:95], v[68:71]
    v_mfma_f32_16x16x32_bf16 v[12:15], v[108:111], v[80:83], v[12:15]
    v_mfma_f32_16x16x32_bf16 v[32:35], v[108:111], v[84:87], v[32:35]
    v_mfma_f32_16x16x32_bf16 v[52:55], v[108:111], v[88:91], v[52:55]
    v_mfma_f32_16x16x32_bf16 v[72:75], v[108:111], v[92:95], v[72:75]
    v_mfma_f32_16x16x32_bf16 v[16:19], v[112:115], v[80:83], v[16:19]
    v_mfma_f32_16x16x32_bf16 v[36:39], v[112:115], v[84:87], v[36:39]
    v_mfma_f32_16x16x32_bf16 v[56:59], v[112:115], v[88:91], v[56:59]
    v_mfma_f32_16x16x32_bf16 v[76:79], v[112:115], v[92:95], v[76:79]
    s_add_u32 s45, s45, 1
    s_cmp_ge_u32 s45, s42
    s_cbranch_scc1 P_ge
    buffer_load_dwordx4 v[96:99], v250, s[12:15], s41 offen offset:0 sc1
    buffer_load_dwordx4 v[100:103], v250, s[12:15], s41 offen offset:1024 sc1
    buffer_load_dwordx4 v[104:107], v250, s[12:15], s41 offen offset:2048 sc1
    buffer_load_dwordx4 v[108:111], v250, s[12:15], s41 offen offset:3072 sc1
    buffer_load_dwordx4 v[112:115], v253, s[12:15], s41 offen offset:0 sc1
    buffer_load_dwordx4 v[80:83], v232, s[20:23], s40 offen sc1
    buffer_load_dwordx4 v[84:87], v233, s[20:23], s40 offen sc1
    buffer_load_dwordx4 v[88:91], v234, s[20:23], s40 offen sc1
    buffer_load_dwordx4 v[92:95], v235, s[20:23], s40 offen sc1
    s_add_u32 s41, s41, 5120
    s_add_u32 s40, s40, 1024
    s_waitcnt vmcnt(27)
    v_mfma_f32_16x16x32_bf16 v[0:3], v[132:135], v[116:119], v[0:3]
    v_mfma_f32_16x16x32_bf16 v[20:23], v[132:135], v[120:123], v[20:23]
    v_mfma_f32_16x16x32_bf16 v[40:43], v[132:135], v[124:127], v[40:43]
    v_mfma_f32_16x16x32_bf16 v[60:63], v[132:135], v[128:131], v[60:63]
    v_mfma_f32_16x16x32_bf16 v[4:7], v[136:139], v[116:119], v[4:7]
    v_mfma_f32_16x16x32_bf16 v[24:27], v[136:139], v[120:123], v[24:27]
    v_mfma_f32_16x16x32_bf16 v[44:47], v[136:139], v[124:127], v[44:47]
    v_mfma_f32_16x16x32_bf16 v[64:67], v[136:139], v[128:131], v[64:67]
    v_mfma_f32_16x16x32_bf16 v[8:11], v[140:143], v[116:119], v[8:11]
    v_mfma_f32_16x16x32_bf16 v[28:31], v[140:143], v[120:123], v[28:31]
    v_mfma_f32_16x16x32_bf16 v[48:51], v[140:143], v[124:127], v[48:51]
    v_mfma_f32_16x16x32_bf16 v[68:71], v[140:143], v[128:131], v[68:71]
    v_mfma_f32_16x16x32_bf16 v[12:15], v[144:147], v[116:119], v[12:15]
    v_mfma_f32_16x16x32_bf16 v[32:35], v[144:147], v[120:123], v[32:35]
    v_mfma_f32_16x16x32_bf16 v[52:55], v[144:147], v[124:127], v[52:55]
    v_mfma_f32_16x16x32_bf16 v[72:75], v[144:147], v[128:131], v[72:75]
    v_mfma_f32_16x16x32_bf16 v[16:19], v[148:151], v[116:119], v[16:19]
    v_mfma_f32_16x16x32_bf16 v[36:39], v[148:151], v[120:123], v[36:39]
    v_mfma_f32_16x16x32_bf16 v[56:59], v[148:151], v[124:127], v[56:59]
    v_mfma_f32_16x16x32_bf16 v[76:79], v[148:151], v[128:131], v[76:79]
    s_add_u32 s45, s45, 1
    s_cmp_ge_u32 s45, s42
    s_cbranch_scc1 P_ge
    buffer_load_dwordx4 v[132:135], v250, s[12:15], s41 offen offset:0 sc1
    buffer_load_dwordx4 v[136:139], v250, s[12:15], s41 offen offset:1024 sc1
    buffer_load_dwordx4 v[140:143], v250, s[12:15], s41 offen offset:2048 sc1
    buffer_load_dwordx4 v[144:147], v250, s[12:15], s41 offen offset:3072 sc1
    buffer_load_dwordx4 v[148:151], v253, s[12:15], s41 offen offset:0 sc1
    buffer_load_dwordx4 v[116:119], v232, s[20:23], s40 offen sc1
    buffer_load_dwordx4 v[120:123], v233, s[20:23], s40 offen sc1
    buffer_load_dwordx4 v[124:127], v234, s[20:23], s40 offen sc1
    buffer_load_dwordx4 v[128:131], v235, s[20:23], s40 offen sc1
    s_add_u32 s41, s41, 5120
    s_add_u32 s40, s40, 1024
    s_waitcnt vmcnt(27)
    v_mfma_f32_16x16x32_bf16 v[0:3], v[168:171], v[152:155], v[0:3]
    v_mfma_f32_16x16x32_bf16 v[20:23], v[168:171], v[156:159], v[20:23]
    v_mfma_f32_16x16x32_bf16 v[40:43], v[168:171], v[160:163], v[40:43]
    v_mfma_f32_16x16x32_bf16 v[60:63], v[168:171], v[164:167], v[60:63]
    v_mfma_f32_16x16x32_bf16 v[4:7], v[172:175], v[152:155], v[4:7]
    v_mfma_f32_16x16x32_bf16 v[24:27], v[172:175], v[156:159], v[24:27]
    v_mfma_f32_16x16x32_bf16 v[44:47], v[172:175], v[160:163], v[44:47]
    v_mfma_f32_16x16x32_bf16 v[64:67], v[172:175], v[164:167], v[64:67]
    v_mfma_f32_16x16x32_bf16 v[8:11], v[176:179], v[152:155], v[8:11]
    v_mfma_f32_16x16x32_bf16 v[28:31], v[176:179], v[156:159], v[28:31]
    v_mfma_f32_16x16x32_bf16 v[48:51], v[176:179], v[160:163], v[48:51]
    v_mfma_f32_16x16x32_bf16 v[68:71], v[176:179], v[164:167], v[68:71]
    v_mfma_f32_16x16x32_bf16 v[12:15], v[180:183], v[152:155], v[12:15]
    v_mfma_f32_16x16x32_bf16 v[32:35], v[180:183], v[156:159], v[32:35]
    v_mfma_f32_16x16x32_bf16 v[52:55], v[180:183], v[160:163], v[52:55]
    v_mfma_f32_16x16x32_bf16 v[72:75], v[180:183], v[164:167], v[72:75]
    v_mfma_f32_16x16x32_bf16 v[16:19], v[184:187], v[152:155], v[16:19]
    v_mfma_f32_16x16x32_bf16 v[36:39], v[184:187], v[156:159], v[36:39]
    v_mfma_f32_16x16x32_bf16 v[56:59], v[184:187], v[160:163], v[56:59]
    v_mfma_f32_16x16x32_bf16 v[76:79], v[184:187], v[164:167], v[76:79]
    s_add_u32 s45, s45, 1
    s_cmp_ge_u32 s45, s42
    s_cbranch_scc1 P_ge
    buffer_load_dwordx4 v[168:171], v250, s[12:15], s41 offen offset:0 sc1
    buffer_load_dwordx4 v[172:175], v250, s[12:15], s41 offen offset:1024 sc1
    buffer_load_dwordx4 v[176:179], v250, s[12:15], s41 offen offset:2048 sc1
    buffer_load_dwordx4 v[180:183], v250, s[12:15], s41 offen offset:3072 sc1
    buffer_load_dwordx4 v[184:187], v253, s[12:15], s41 offen offset:0 sc1
    buffer_load_dwordx4 v[152:155], v232, s[20:23], s40 offen sc1
    buffer_load_dwordx4 v[156:159], v233, s[20:23], s40 offen sc1
    buffer_load_dwordx4 v[160:163], v234, s[20:23], s40 offen sc1
    buffer_load_dwordx4 v[164:167], v235, s[20:23], s40 offen sc1
    s_add_u32 s41, s41, 5120
    s_add_u32 s40, s40, 1024
    s_waitcnt vmcnt(27)
    v_mfma_f32_16x16x32_bf16 v[0:3], v[204:207], v[188:191], v[0:3]
    v_mfma_f32_16x16x32_bf16 v[20:23], v[204:207], v[192:195], v[20:23]
    v_mfma_f32_16x16x32_bf16 v[40:43], v[204:207], v[196:199], v[40:43]
    v_mfma_f32_16x16x32_bf16 v[60:63], v[204:207], v[200:203], v[60:63]
    v_mfma_f32_16x16x32_bf16 v[4:7], v[208:211], v[188:191], v[4:7]
    v_mfma_f32_16x16x32_bf16 v[24:27], v[208:211], v[192:195], v[24:27]
    v_mfma_f32_16x16x32_bf16 v[44:47], v[208:211], v[196:199], v[44:47]
    v_mfma_f32_16x16x32_bf16 v[64:67], v[208:211], v[200:203], v[64:67]
    v_mfma_f32_16x16x32_bf16 v[8:11], v[212:215], v[188:191], v[8:11]
    v_mfma_f32_16x16x32_bf16 v[28:31], v[212:215], v[192:195], v[28:31]
    v_mfma_f32_16x16x32_bf16 v[48:51], v[212:215], v[196:199], v[48:51]
    v_mfma_f32_16x16x32_bf16 v[68:71], v[212:215], v[200:203], v[68:71]
    v_mfma_f32_16x16x32_bf16 v[12:15], v[216:219], v[188:191], v[12:15]
    v_mfma_f32_16x16x32_bf16 v[32:35], v[216:219], v[192:195], v[32:35]
    v_mfma_f32_16x16x32_bf16 v[52:55], v[216:219], v[196:199], v[52:55]
    v_mfma_f32_16x16x32_bf16 v[72:75], v[216:219], v[200:203], v[72:75]
    v_mfma_f32_16x16x32_bf16 v[16:19], v[220:223], v[188:191], v[16:19]
    v_mfma_f32_16x16x32_bf16 v[36:39], v[220:223], v[192:195], v[36:39]
    v_mfma_f32_16x16x32_bf16 v[56:59], v[220:223], v[196:199], v[56:59]
    v_mfma_f32_16x16x32_bf16 v[76:79], v[220:223], v[200:203], v[76:79]
    s_add_u32 s45, s45, 1
    s_cmp_ge_u32 s45, s42
    s_cbranch_scc1 P_ge
    s_branch P_gl
P_ge:
    s_waitcnt vmcnt(0)
    s_nop 7
    s_cmp_eq_u32 s53, 0
    s_cbranch_scc1 P_sk0
    s_cmp_gt_u32 s53, 0
    s_cselect_b32 s3, 1, 0
    s_sub_u32 s3, s53, s3
    s_add_u32 s3, s3, 0
    s_mul_i32 s3, s3, 5120
    s_mul_i32 s43, s52, 61440
    s_add_u32 s3, s3, s43
    v_add_u32 v237, s3, v250
    ds_write_b128 v237, v[0:3] offset:0
    ds_write_b128 v237, v[4:7] offset:1024
    ds_write_b128 v237, v[8:11] offset:2048
    ds_write_b128 v237, v[12:15] offset:3072
    ds_write_b128 v237, v[16:19] offset:4096
    s_branch P_sn0
P_sk0:
    v_mov_b32 v160, v0
    v_mov_b32 v161, v1
    v_mov_b32 v162, v2
    v_mov_b32 v163, v3
    v_mov_b32 v164, v4
    v_mov_b32 v165, v5
    v_mov_b32 v166, v6
    v_mov_b32 v167, v7
    v_mov_b32 v168, v8
    v_mov_b32 v169, v9
    v_mov_b32 v170, v10
    v_mov_b32 v171, v11
    v_mov_b32 v172, v12
    v_mov_b32 v173, v13
    v_mov_b32 v174, v14
    v_mov_b32 v175, v15
    v_mov_b32 v176, v16
    v_mov_b32 v177, v17
    v_mov_b32 v178, v18
    v_mov_b32 v179, v19
P_sn0:
    s_cmp_eq_u32 s53, 1
    s_cbranch_scc1 P_sk1
    s_cmp_gt_u32 s53, 1
    s_cselect_b32 s3, 1, 0
    s_sub_u32 s3, s53, s3
    s_add_u32 s3, s3, 3
    s_mul_i32 s3, s3, 5120
    s_mul_i32 s43, s52, 61440
    s_add_u32 s3, s3, s43
    v_add_u32 v237, s3, v250
    ds_write_b128 v237, v[20:23] offset:0
    ds_write_b128 v237, v[24:27] offset:1024
    ds_write_b128 v237, v[28:31] offset:2048
    ds_write_b128 v237, v[32:35] offset:3072
    ds_write_b128 v237, v[36:39] offset:4096
    s_branch P_sn1
P_sk1:
    v_mov_b32 v160, v20
    v_mov_b32 v161, v21
    v_mov_b32 v162, v22
    v_mov_b32 v163, v23
    v_mov_b32 v164, v24
    v_mov_b32 v165, v25
    v_mov_b32 v166, v26
    v_mov_b32 v167, v27
    v_mov_b32 v168, v28
    v_mov_b32 v169, v29
    v_mov_b32 v170, v30
    v_mov_b32 v171, v31
    v_mov_b32 v172, v32
    v_mov_b32 v173, v33
    v_mov_b32 v174, v34
    v_mov_b32 v175, v35
    v_mov_b32 v176, v36
    v_mov_b32 v177, v37
    v_mov_b32 v178, v38
    v_mov_b32 v179, v39
P_sn1:
    s_cmp_eq_u32 s53, 2
    s_cbranch_scc1 P_sk2
    s_cmp_gt_u32 s53, 2
    s_cselect_b32 s3, 1, 0
    s_sub_u32 s3, s53, s3
    s_add_u32 s3, s3, 6
    s_mul_i32 s3, s3, 5120
    s_mul_i32 s43, s52, 61440
    s_add_u32 s3, s3, s43
    v_add_u32 v237, s3, v250
    ds_write_b128 v237, v[40:43] offset:0
    ds_write_b128 v237, v[44:47] offset:1024
    ds_write_b128 v237, v[48:51] offset:2048
    ds_write_b128 v237, v[52:55] offset:3072
    ds_write_b128 v237, v[56:59] offset:4096
    s_branch P_sn2
P_sk2:
    v_mov_b32 v160, v40
    v_mov_b32 v161, v41
    v_mov_b32 v162, v42
    v_mov_b32 v163, v43
    v_mov_b32 v164, v44
    v_mov_b32 v165, v45
    v_mov_b32 v166, v46
    v_mov_b32 v167, v47
    v_mov_b32 v168, v48
    v_mov_b32 v169, v49
    v_mov_b32 v170, v50
    v_mov_b32 v171, v51
    v_mov_b32 v172, v52
    v_mov_b32 v173, v53
    v_mov_b32 v174, v54
    v_mov_b32 v175, v55
    v_mov_b32 v176, v56
    v_mov_b32 v177, v57
    v_mov_b32 v178, v58
    v_mov_b32 v179, v59
P_sn2:
    s_cmp_eq_u32 s53, 3
    s_cbranch_scc1 P_sk3
    s_cmp_gt_u32 s53, 3
    s_cselect_b32 s3, 1, 0
    s_sub_u32 s3, s53, s3
    s_add_u32 s3, s3, 9
    s_mul_i32 s3, s3, 5120
    s_mul_i32 s43, s52, 61440
    s_add_u32 s3, s3, s43
    v_add_u32 v237, s3, v250
    ds_write_b128 v237, v[60:63] offset:0
    ds_write_b128 v237, v[64:67] offset:1024
    ds_write_b128 v237, v[68:71] offset:2048
    ds_write_b128 v237, v[72:75] offset:3072
    ds_write_b128 v237, v[76:79] offset:4096
    s_branch P_sn3
P_sk3:
    v_mov_b32 v160, v60
    v_mov_b32 v161, v61
    v_mov_b32 v162, v62
    v_mov_b32 v163, v63
    v_mov_b32 v164, v64
    v_mov_b32 v165, v65
    v_mov_b32 v166, v66
    v_mov_b32 v167, v67
    v_mov_b32 v168, v68
    v_mov_b32 v169, v69
    v_mov_b32 v170, v70
    v_mov_b32 v171, v71
    v_mov_b32 v172, v72
    v_mov_b32 v173, v73
    v_mov_b32 v174, v74
    v_mov_b32 v175, v75
    v_mov_b32 v176, v76
    v_mov_b32 v177, v77
    v_mov_b32 v178, v78
    v_mov_b32 v179, v79
P_sn3:
    s_waitcnt lgkmcnt(0)
    s_barrier
    s_mul_i32 s3, s53, 15360
    s_mul_i32 s43, s52, 61440
    s_add_u32 s3, s3, s43
    v_add_u32 v237, s3, v250
    ds_read_b128 v[0:3], v237 offset:0
    ds_read_b128 v[4:7], v237 offset:1024
    ds_read_b128 v[8:11], v237 offset:2048
    ds_read_b128 v[12:15], v237 offset:3072
    ds_read_b128 v[16:19], v237 offset:4096
    ds_read_b128 v[20:23], v237 offset:5120
    ds_read_b128 v[24:27], v237 offset:6144
    ds_read_b128 v[28:31], v237 offset:7168
    ds_read_b128 v[32:35], v237 offset:8192
    ds_read_b128 v[36:39], v237 offset:9216
    ds_read_b128 v[40:43], v237 offset:10240
    ds_read_b128 v[44:47], v237 offset:11264
    ds_read_b128 v[48:51], v237 offset:12288
    ds_read_b128 v[52:55], v237 offset:13312
    ds_read_b128 v[56:59], v237 offset:14336
    s_mov_b32 s8, s66
    s_mov_b32 s9, s67
    s_mov_b32 s10, 0x500
    s_mov_b32 s11, 0x20000
    s_add_u32 s28, s6, 0x7400000
    s_addc_u32 s29, s7, 0
    s_mov_b32 s30, 0x280000
    s_mov_b32 s31, 0x20000
    v_lshrrev_b32 v65, 4, v251
    v_lshlrev_b32 v65, 3, v65
    s_mul_i32 s35, s70, 160
    buffer_load_dwordx2 v[70:71], v65, s[8:11], s35 offen offset:0
    buffer_load_dwordx2 v[72:73], v65, s[8:11], s35 offen offset:32
    buffer_load_dwordx2 v[74:75], v65, s[8:11], s35 offen offset:64
    buffer_load_dwordx2 v[76:77], v65, s[8:11], s35 offen offset:96
    buffer_load_dwordx2 v[78:79], v65, s[8:11], s35 offen offset:128
    s_waitcnt lgkmcnt(0)
    v_add_f32 v160, v160, v0
    v_add_f32 v161, v161, v1
    v_add_f32 v162, v162, v2
    v_add_f32 v163, v163, v3
    v_add_f32 v164, v164, v4
    v_add_f32 v165, v165, v5
    v_add_f32 v166, v166, v6
    v_add_f32 v167, v167, v7
    v_add_f32 v168, v168, v8
    v_add_f32 v169, v169, v9
    v_add_f32 v170, v170, v10
    v_add_f32 v171, v171, v11
    v_add_f32 v172, v172, v12
    v_add_f32 v173, v173, v13
    v_add_f32 v174, v174, v14
    v_add_f32 v175, v175, v15
    v_add_f32 v176, v176, v16
    v_add_f32 v177, v177, v17
    v_add_f32 v178, v178, v18
    v_add_f32 v179, v179, v19
    v_add_f32 v160, v160, v20
    v_add_f32 v161, v161, v21
    v_add_f32 v162, v162, v22
    v_add_f32 v163, v163, v23
    v_add_f32 v164, v164, v24
    v_add_f32 v165, v165, v25
    v_add_f32 v166, v166, v26
    v_add_f32 v167, v167, v27
    v_add_f32 v168, v168, v28
    v_add_f32 v169, v169, v29
    v_add_f32 v170, v170, v30
    v_add_f32 v171, v171, v31
    v_add_f32 v172, v172, v32
    v_add_f32 v173, v173, v33
    v_add_f32 v174, v174, v34
    v_add_f32 v175, v175, v35
    v_add_f32 v176, v176, v36
    v_add_f32 v177, v177, v37
    v_add_f32 v178, v178, v38
    v_add_f32 v179, v179, v39
    v_add_f32 v160, v160, v40
    v_add_f32 v161, v161, v41
    v_add_f32 v162, v162, v42
    v_add_f32 v163, v163, v43
    v_add_f32 v164, v164, v44
    v_add_f32 v165, v165, v45
    v_add_f32 v166, v166, v46
    v_add_f32 v167, v167, v47
    v_add_f32 v168, v168, v48
    v_add_f32 v169, v169, v49
    v_add_f32 v170, v170, v50
    v_add_f32 v171, v171, v51
    v_add_f32 v172, v172, v52
    v_add_f32 v173, v173, v53
    v_add_f32 v174, v174, v54
    v_add_f32 v175, v175, v55
    v_add_f32 v176, v176, v56
    v_add_f32 v177, v177, v57
    v_add_f32 v178, v178, v58
    v_add_f32 v179, v179, v59
    s_waitcnt vmcnt(0)
    s_lshl_b32 s3, s36, 2
    s_add_u32 s3, s3, s53
    s_mul_i32 s3, s3, 40
    s_mul_i32 s35, s70, 5
    s_add_u32 s3, s3, s35
    s_lshl_b32 s3, s3, 9
    v_lshlrev_b32 v66, 3, v251
    v_cvt_pk_bf16_f32 v4, v160, v161
    v_lshlrev_b32 v0, 16, v4
    v_and_b32 v1, 0xffff0000, v4
    v_lshlrev_b32 v2, 16, v70
    v_and_b32 v3, 0xffff0000, v70
    v_add_f32 v0, v0, v2
    v_add_f32 v1, v1, v3
    v_cvt_pk_bf16_f32 v4, v0, v1
    v_lshlrev_b32 v0, 16, v4
    v_and_b32 v1, 0xffff0000, v4
    v_mul_f32 v2, 0xbfb8aa3b, v0
    v_mul_f32 v3, 0xbfb8aa3b, v1
    v_exp_f32 v2, v2
    v_exp_f32 v3, v3
    s_nop 0
    v_add_f32 v2, 1.0, v2
    v_add_f32 v3, 1.0, v3
    v_rcp_f32 v2, v2
    v_rcp_f32 v3, v3
    s_nop 0
    v_mul_f32 v0, v0, v2
    v_mul_f32 v1, v1, v3
    v_cvt_pk_bf16_f32 v8, v0, v1
    v_cvt_pk_bf16_f32 v4, v162, v163
    v_lshlrev_b32 v0, 16, v4
    v_and_b32 v1, 0xffff0000, v4
    v_lshlrev_b32 v2, 16, v71
    v_and_b32 v3, 0xffff0000, v71
    v_add_f32 v0, v0, v2
    v_add_f32 v1, v1, v3
    v_cvt_pk_bf16_f32 v4, v0, v1
    v_lshlrev_b32 v0, 16, v4
    v_and_b32 v1, 0xffff0000, v4
    v_mul_f32 v2, 0xbfb8aa3b, v0
    v_mul_f32 v3, 0xbfb8aa3b, v1
    v_exp_f32 v2, v2
    v_exp_f32 v3, v3
    s_nop 0
    v_add_f32 v2, 1.0, v2
    v_add_f32 v3, 1.0, v3
    v_rcp_f32 v2, v2
    v_rcp_f32 v3, v3
    s_nop 0
    v_mul_f32 v0, v0, v2
    v_mul_f32 v1, v1, v3
    v_cvt_pk_bf16_f32 v9, v0, v1
    buffer_store_dwordx2 v[8:9], v66, s[28:31], s3 offen offset:0 sc1
    v_cvt_pk_bf16_f32 v4, v164, v165
    v_lshlrev_b32 v0, 16, v4
    v_and_b32 v1, 0xffff0000, v4
    v_lshlrev_b32 v2, 16, v72
    v_and_b32 v3, 0xffff0000, v72
    v_add_f32 v0, v0, v2
    v_add_f32 v1, v1, v3
    v_cvt_pk_bf16_f32 v4, v0, v1
    v_lshlrev_b32 v0, 16, v4
    v_and_b32 v1, 0xffff0000, v4
    v_mul_f32 v2, 0xbfb8aa3b, v0
    v_mul_f32 v3, 0xbfb8aa3b, v1
    v_exp_f32 v2, v2
    v_exp_f32 v3, v3
    s_nop 0
    v_add_f32 v2, 1.0, v2
    v_add_f32 v3, 1.0, v3
    v_rcp_f32 v2, v2
    v_rcp_f32 v3, v3
    s_nop 0
    v_mul_f32 v0, v0, v2
    v_mul_f32 v1, v1, v3
    v_cvt_pk_bf16_f32 v10, v0, v1
    v_cvt_pk_bf16_f32 v4, v166, v167
    v_lshlrev_b32 v0, 16, v4
    v_and_b32 v1, 0xffff0000, v4
    v_lshlrev_b32 v2, 16, v73
    v_and_b32 v3, 0xffff0000, v73
    v_add_f32 v0, v0, v2
    v_add_f32 v1, v1, v3
    v_cvt_pk_bf16_f32 v4, v0, v1
    v_lshlrev_b32 v0, 16, v4
    v_and_b32 v1, 0xffff0000, v4
    v_mul_f32 v2, 0xbfb8aa3b, v0
    v_mul_f32 v3, 0xbfb8aa3b, v1
    v_exp_f32 v2, v2
    v_exp_f32 v3, v3
    s_nop 0
    v_add_f32 v2, 1.0, v2
    v_add_f32 v3, 1.0, v3
    v_rcp_f32 v2, v2
    v_rcp_f32 v3, v3
    s_nop 0
    v_mul_f32 v0, v0, v2
    v_mul_f32 v1, v1, v3
    v_cvt_pk_bf16_f32 v11, v0, v1
    buffer_store_dwordx2 v[10:11], v66, s[28:31], s3 offen offset:512 sc1
    v_cvt_pk_bf16_f32 v4, v168, v169
    v_lshlrev_b32 v0, 16, v4
    v_and_b32 v1, 0xffff0000, v4
    v_lshlrev_b32 v2, 16, v74
    v_and_b32 v3, 0xffff0000, v74
    v_add_f32 v0, v0, v2
    v_add_f32 v1, v1, v3
    v_cvt_pk_bf16_f32 v4, v0, v1
    v_lshlrev_b32 v0, 16, v4
    v_and_b32 v1, 0xffff0000, v4
    v_mul_f32 v2, 0xbfb8aa3b, v0
    v_mul_f32 v3, 0xbfb8aa3b, v1
    v_exp_f32 v2, v2
    v_exp_f32 v3, v3
    s_nop 0
    v_add_f32 v2, 1.0, v2
    v_add_f32 v3, 1.0, v3
    v_rcp_f32 v2, v2
    v_rcp_f32 v3, v3
    s_nop 0
    v_mul_f32 v0, v0, v2
    v_mul_f32 v1, v1, v3
    v_cvt_pk_bf16_f32 v12, v0, v1
    v_cvt_pk_bf16_f32 v4, v170, v171
    v_lshlrev_b32 v0, 16, v4
    v_and_b32 v1, 0xffff0000, v4
    v_lshlrev_b32 v2, 16, v75
    v_and_b32 v3, 0xffff0000, v75
    v_add_f32 v0, v0, v2
    v_add_f32 v1, v1, v3
    v_cvt_pk_bf16_f32 v4, v0, v1
    v_lshlrev_b32 v0, 16, v4
    v_and_b32 v1, 0xffff0000, v4
    v_mul_f32 v2, 0xbfb8aa3b, v0
    v_mul_f32 v3, 0xbfb8aa3b, v1
    v_exp_f32 v2, v2
    v_exp_f32 v3, v3
    s_nop 0
    v_add_f32 v2, 1.0, v2
    v_add_f32 v3, 1.0, v3
    v_rcp_f32 v2, v2
    v_rcp_f32 v3, v3
    s_nop 0
    v_mul_f32 v0, v0, v2
    v_mul_f32 v1, v1, v3
    v_cvt_pk_bf16_f32 v13, v0, v1
    buffer_store_dwordx2 v[12:13], v66, s[28:31], s3 offen offset:1024 sc1
    v_cvt_pk_bf16_f32 v4, v172, v173
    v_lshlrev_b32 v0, 16, v4
    v_and_b32 v1, 0xffff0000, v4
    v_lshlrev_b32 v2, 16, v76
    v_and_b32 v3, 0xffff0000, v76
    v_add_f32 v0, v0, v2
    v_add_f32 v1, v1, v3
    v_cvt_pk_bf16_f32 v4, v0, v1
    v_lshlrev_b32 v0, 16, v4
    v_and_b32 v1, 0xffff0000, v4
    v_mul_f32 v2, 0xbfb8aa3b, v0
    v_mul_f32 v3, 0xbfb8aa3b, v1
    v_exp_f32 v2, v2
    v_exp_f32 v3, v3
    s_nop 0
    v_add_f32 v2, 1.0, v2
    v_add_f32 v3, 1.0, v3
    v_rcp_f32 v2, v2
    v_rcp_f32 v3, v3
    s_nop 0
    v_mul_f32 v0, v0, v2
    v_mul_f32 v1, v1, v3
    v_cvt_pk_bf16_f32 v14, v0, v1
    v_cvt_pk_bf16_f32 v4, v174, v175
    v_lshlrev_b32 v0, 16, v4
    v_and_b32 v1, 0xffff0000, v4
    v_lshlrev_b32 v2, 16, v77
    v_and_b32 v3, 0xffff0000, v77
    v_add_f32 v0, v0, v2
    v_add_f32 v1, v1, v3
    v_cvt_pk_bf16_f32 v4, v0, v1
    v_lshlrev_b32 v0, 16, v4
    v_and_b32 v1, 0xffff0000, v4
    v_mul_f32 v2, 0xbfb8aa3b, v0
    v_mul_f32 v3, 0xbfb8aa3b, v1
    v_exp_f32 v2, v2
    v_exp_f32 v3, v3
    s_nop 0
    v_add_f32 v2, 1.0, v2
    v_add_f32 v3, 1.0, v3
    v_rcp_f32 v2, v2
    v_rcp_f32 v3, v3
    s_nop 0
    v_mul_f32 v0, v0, v2
    v_mul_f32 v1, v1, v3
    v_cvt_pk_bf16_f32 v15, v0, v1
    buffer_store_dwordx2 v[14:15], v66, s[28:31], s3 offen offset:1536 sc1
    v_cvt_pk_bf16_f32 v4, v176, v177
    v_lshlrev_b32 v0, 16, v4
    v_and_b32 v1, 0xffff0000, v4
    v_lshlrev_b32 v2, 16, v78
    v_and_b32 v3, 0xffff0000, v78
    v_add_f32 v0, v0, v2
    v_add_f32 v1, v1, v3
    v_cvt_pk_bf16_f32 v4, v0, v1
    v_lshlrev_b32 v0, 16, v4
    v_and_b32 v1, 0xffff0000, v4
    v_mul_f32 v2, 0xbfb8aa3b, v0
    v_mul_f32 v3, 0xbfb8aa3b, v1
    v_exp_f32 v2, v2
    v_exp_f32 v3, v3
    s_nop 0
    v_add_f32 v2, 1.0, v2
    v_add_f32 v3, 1.0, v3
    v_rcp_f32 v2, v2
    v_rcp_f32 v3, v3
    s_nop 0
    v_mul_f32 v0, v0, v2
    v_mul_f32 v1, v1, v3
    v_cvt_pk_bf16_f32 v16, v0, v1
    v_cvt_pk_bf16_f32 v4, v178, v179
    v_lshlrev_b32 v0, 16, v4
    v_and_b32 v1, 0xffff0000, v4
    v_lshlrev_b32 v2, 16, v79
    v_and_b32 v3, 0xffff0000, v79
    v_add_f32 v0, v0, v2
    v_add_f32 v1, v1, v3
    v_cvt_pk_bf16_f32 v4, v0, v1
    v_lshlrev_b32 v0, 16, v4
    v_and_b32 v1, 0xffff0000, v4
    v_mul_f32 v2, 0xbfb8aa3b, v0
    v_mul_f32 v3, 0xbfb8aa3b, v1
    v_exp_f32 v2, v2
    v_exp_f32 v3, v3
    s_nop 0
    v_add_f32 v2, 1.0, v2
    v_add_f32 v3, 1.0, v3
    v_rcp_f32 v2, v2
    v_rcp_f32 v3, v3
    s_nop 0
    v_mul_f32 v0, v0, v2
    v_mul_f32 v1, v1, v3
    v_cvt_pk_bf16_f32 v17, v0, v1
    buffer_store_dwordx2 v[16:17], v66, s[28:31], s3 offen offset:2048 sc1
    s_add_u32 s73, s71, 288
    s_waitcnt vmcnt(0)
    s_barrier
    s_cmp_lg_u32 s33, 0
    s_cbranch_scc1 FA_22
    s_mov_b64 exec, 1
    s_lshl_b32 s3, s73, 7
    v_mov_b32 v254, 0
    v_mov_b32 v255, 1
    buffer_atomic_add v255, v254, s[76:79], s3 offen
    s_mov_b64 exec, -1
FA_22:
    s_sub_u32 s72, s71, 12
    s_cmp_ge_u32 s71, 12
    s_cbranch_scc1 P_loopA
    s_cmp_ge_u32 s71, 10
    s_cbranch_scc1 M_done2
    s_lshr_b32 s72, s70, 1
    s_and_b32 s58, s70, 1
    s_mul_i32 s58, s58, 10
    s_add_u32 s58, s58, s71
    s_lshl_b32 s58, s58, 1
    s_add_u32 s8, s6, 0x6800000
    s_addc_u32 s9, s7, 0
    s_mov_b32 s10, 0x500000
    s_mov_b32 s11, 0x20000
    s_add_u32 s57, s58, 0
    s_mul_hi_u32 s3, s57, 0x33333334
    s_mul_i32 s35, s3, 5
    s_sub_u32 s35, s57, s35
    s_lshl_b32 s3, s3, 7
    s_lshl_b32 s34, s33, 4
    s_add_u32 s3, s3, s34
    s_mul_i32 s3, s3, 5120
    s_lshl_b32 s35, s35, 10
    s_add_u32 s3, s3, s35
    s_lshl_b32 s34, s33, 14
    s_add_u32 m0, s34, 0
    s_nop 0
    buffer_load_dwordx4 v250, s[8:11], s3 offen sc1 lds
    s_add_u32 s3, s3, 5120
    s_add_u32 m0, s34, 1024
    s_nop 0
    buffer_load_dwordx4 v250, s[8:11], s3 offen sc1 lds
    s_add_u32 s3, s3, 5120
    s_add_u32 m0, s34, 2048
    s_nop 0
    buffer_load_dwordx4 v250, s[8:11], s3 offen sc1 lds
    s_add_u32 s3, s3, 5120
    s_add_u32 m0, s34, 3072
    s_nop 0
    buffer_load_dwordx4 v250, s[8:11], s3 offen sc1 lds
    s_add_u32 s3, s3, 5120
    s_add_u32 m0, s34, 4096
    s_nop 0
    buffer_load_dwordx4 v250, s[8:11], s3 offen sc1 lds
    s_add_u32 s3, s3, 5120
    s_add_u32 m0, s34, 5120
    s_nop 0
    buffer_load_dwordx4 v250, s[8:11], s3 offen sc1 lds
    s_add_u32 s3, s3, 5120
    s_add_u32 m0, s34, 6144
    s_nop 0
    buffer_load_dwordx4 v250, s[8:11], s3 offen sc1 lds
    s_add_u32 s3, s3, 5120
    s_add_u32 m0, s34, 7168
    s_nop 0
    buffer_load_dwordx4 v250, s[8:11], s3 offen sc1 lds
    s_add_u32 s3, s3, 5120
    s_add_u32 m0, s34, 8192
    s_nop 0
    buffer_load_dwordx4 v250, s[8:11], s3 offen sc1 lds
    s_add_u32 s3, s3, 5120
    s_add_u32 m0, s34, 9216
    s_nop 0
    buffer_load_dwordx4 v250, s[8:11], s3 offen sc1 lds
    s_add_u32 s3, s3, 5120
    s_add_u32 m0, s34, 10240
    s_nop 0
    buffer_load_dwordx4 v250, s[8:11], s3 offen sc1 lds
    s_add_u32 s3, s3, 5120
    s_add_u32 m0, s34, 11264
    s_nop 0
    buffer_load_dwordx4 v250, s[8:11], s3 offen sc1 lds
    s_add_u32 s3, s3, 5120
    s_add_u32 m0, s34, 12288
    s_nop 0
    buffer_load_dwordx4 v250, s[8:11], s3 offen sc1 lds
    s_add_u32 s3, s3, 5120
    s_add_u32 m0, s34, 13312
    s_nop 0
    buffer_load_dwordx4 v250, s[8:11], s3 offen sc1 lds
    s_add_u32 s3, s3, 5120
    s_add_u32 m0, s34, 14336
    s_nop 0
    buffer_load_dwordx4 v250, s[8:11], s3 offen sc1 lds
    s_add_u32 s3, s3, 5120
    s_add_u32 m0, s34, 15360
    s_nop 0
    buffer_load_dwordx4 v250, s[8:11], s3 offen sc1 lds
    s_add_u32 s3, s3, 5120
    s_add_u32 s57, s58, 1
    s_mul_hi_u32 s3, s57, 0x33333334
    s_mul_i32 s35, s3, 5
    s_sub_u32 s35, s57, s35
    s_lshl_b32 s3, s3, 7
    s_lshl_b32 s34, s33, 4
    s_add_u32 s3, s3, s34
    s_mul_i32 s3, s3, 5120
    s_lshl_b32 s35, s35, 10
    s_add_u32 s3, s3, s35
    buffer_load_dwordx4 v[64:67], v250, s[8:11], s3 offen sc1
    s_add_u32 s3, s3, 5120
    buffer_load_dwordx4 v[68:71], v250, s[8:11], s3 offen sc1
    s_add_u32 s3, s3, 5120
    buffer_load_dwordx4 v[72:75], v250, s[8:11], s3 offen sc1
    s_add_u32 s3, s3, 5120
    buffer_load_dwordx4 v[76:79], v250, s[8:11], s3 offen sc1
    s_add_u32 s3, s3, 5120
    buffer_load_dwordx4 v[80:83], v250, s[8:11], s3 offen sc1
    s_add_u32 s3, s3, 5120
    buffer_load_dwordx4 v[84:87], v250, s[8:11], s3 offen sc1
    s_add_u32 s3, s3, 5120
    buffer_load_dwordx4 v[88:91], v250, s[8:11], s3 offen sc1
    s_add_u32 s3, s3, 5120
    buffer_load_dwordx4 v[92:95], v250, s[8:11], s3 offen sc1
    s_add_u32 s3, s3, 5120
    buffer_load_dwordx4 v[96:99], v250, s[8:11], s3 offen sc1
    s_add_u32 s3, s3, 5120
    buffer_load_dwordx4 v[100:103], v250, s[8:11], s3 offen sc1
    s_add_u32 s3, s3, 5120
    buffer_load_dwordx4 v[104:107], v250, s[8:11], s3 offen sc1
    s_add_u32 s3, s3, 5120
    buffer_load_dwordx4 v[108:111], v250, s[8:11], s3 offen sc1
    s_add_u32 s3, s3, 5120
    buffer_load_dwordx4 v[112:115], v250, s[8:11], s3 offen sc1
    s_add_u32 s3, s3, 5120
    buffer_load_dwordx4 v[116:119], v250, s[8:11], s3 offen sc1
    s_add_u32 s3, s3, 5120
    buffer_load_dwordx4 v[120:123], v250, s[8:11], s3 offen sc1
    s_add_u32 s3, s3, 5120
    buffer_load_dwordx4 v[124:127], v250, s[8:11], s3 offen sc1
    s_add_u32 s3, s3, 5120
    s_waitcnt vmcnt(0)
    s_branch P_loopS
P_loopA:
    s_add_u32 s8, s6, 0x400000
    s_addc_u32 s9, s7, 0
    s_mov_b32 s10, 0x1000000
    s_mov_b32 s11, 0x20000
    s_add_u32 s12, s6, 0x1400000
    s_addc_u32 s13, s7, 0
    s_mov_b32 s14, 0x1000000
    s_mov_b32 s15, 0x20000
    s_add_u32 s16, s6, 0x2400000
    s_addc_u32 s17, s7, 0
    s_mov_b32 s18, 0x1000000
    s_mov_b32 s19, 0x20000
    s_add_u32 s20, s6, 0x5200000
    s_addc_u32 s21, s7, 0
    s_mov_b32 s22, 0x800000
    s_mov_b32 s23, 0x20000
    s_add_u32 s24, s6, 0x5a00000
    s_addc_u32 s25, s7, 0
    s_mov_b32 s26, 0x400000
    s_mov_b32 s27, 0x20000
    s_add_u32 s28, s6, 0x3c00000
    s_addc_u32 s29, s7, 0
    s_mov_b32 s30, 0x1000000
    s_mov_b32 s31, 0x20000
    s_mov_b32 s41, 0x3e0293ee
    v_add_u32 v252, 0x20000, v250
    v_mov_b32 v96, 0
    v_mov_b32 v97, 0
    v_mov_b32 v98, 0
    v_mov_b32 v99, 0
    v_mov_b32 v100, 0
    v_mov_b32 v101, 0
    v_mov_b32 v102, 0
    v_mov_b32 v103, 0
    v_mov_b32 v104, 0
    v_mov_b32 v105, 0
    v_mov_b32 v106, 0
    v_mov_b32 v107, 0
    v_mov_b32 v108, 0
    v_mov_b32 v109, 0
    v_mov_b32 v110, 0
    v_mov_b32 v111, 0
    s_lshl_b32 s74, s70, 4
    s_lshr_b32 s3, s72, 2
    s_add_u32 s74, s74, s3
    s_cmp_lg_u32 s33, 0
    s_cbranch_scc1 FK_24
    s_lshl_b32 s3, s74, 7
    v_mov_b32 v254, 0
FW_23:
    buffer_load_dword v255, v254, s[76:79], s3 offen sc1
    s_waitcnt vmcnt(0)
    v_readfirstlane_b32 s75, v255
    s_cmp_ge_u32 s75, 16
    s_cbranch_scc1 FK_24
    s_sleep 16
    s_sub_u32 s44, s44, 1
    s_cbranch_scc0 FW_23
    s_branch M_done2
FK_24:
    s_barrier
    s_lshl_b32 s74, s70, 3
    s_lshr_b32 s3, s72, 3
    s_add_u32 s74, s74, s3
    s_add_u32 s74, s74, 128
    s_cmp_lg_u32 s33, 0
    s_cbranch_scc1 FK_26
    s_lshl_b32 s3, s74, 7
    v_mov_b32 v254, 0
FW_25:
    buffer_load_dword v255, v254, s[76:79], s3 offen sc1
    s_waitcnt vmcnt(0)
    v_readfirstlane_b32 s75, v255
    s_cmp_ge_u32 s75, 2
    s_cbranch_scc1 FK_26
    s_sleep 16
    s_sub_u32 s44, s44, 1
    s_cbranch_scc0 FW_25
    s_branch M_done2
FK_26:
    s_barrier
    s_lshl_b32 s35, s70, 2
    s_and_b32 s3, s33, 3
    s_add_u32 s35, s35, s3
    s_lshl_b32 s3, s72, 5
    s_add_u32 s3, s3, s35
    s_lshl_b32 s36, s72, 18
    s_lshl_b32 s37, s35, 12
    s_add_u32 s36, s36, s37
    s_lshr_b32 s52, s33, 2
    s_lshl_b32 s37, s52, 17
    s_add_u32 s37, s37, s36
    s_lshl_b32 s38, s3, 13
    s_lshl_b32 s39, s3, 12
    s_lshl_b32 s40, s3, 11
    buffer_load_dwordx4 v[0:3], v250, s[8:11], s37 offen offset:0 sc1
    buffer_load_dwordx4 v[4:7], v250, s[8:11], s37 offen offset:1024 sc1
    buffer_load_dwordx4 v[8:11], v250, s[8:11], s37 offen offset:2048 sc1
    buffer_load_dwordx4 v[12:15], v250, s[8:11], s37 offen offset:3072 sc1
    buffer_load_dwordx4 v[16:19], v250, s[12:15], s36 offen offset:0 sc1
    buffer_load_dwordx4 v[20:23], v250, s[12:15], s36 offen offset:1024 sc1
    buffer_load_dwordx4 v[24:27], v250, s[12:15], s36 offen offset:2048 sc1
    buffer_load_dwordx4 v[28:31], v250, s[12:15], s36 offen offset:3072 sc1
    buffer_load_dwordx4 v[32:35], v252, s[12:15], s36 offen offset:0 sc1
    buffer_load_dwordx4 v[36:39], v252, s[12:15], s36 offen offset:1024 sc1
    buffer_load_dwordx4 v[40:43], v252, s[12:15], s36 offen offset:2048 sc1
    buffer_load_dwordx4 v[44:47], v252, s[12:15], s36 offen offset:3072 sc1
    buffer_load_dwordx4 v[64:67], v250, s[16:19], s38 offen offset:0 sc1
    buffer_load_dwordx4 v[68:71], v250, s[16:19], s38 offen offset:1024 sc1
    buffer_load_dwordx4 v[72:75], v250, s[16:19], s38 offen offset:2048 sc1
    buffer_load_dwordx4 v[76:79], v250, s[16:19], s38 offen offset:3072 sc1
    buffer_load_dwordx4 v[80:83], v253, s[16:19], s38 offen offset:0 sc1
    buffer_load_dwordx4 v[84:87], v253, s[16:19], s38 offen offset:1024 sc1
    buffer_load_dwordx4 v[88:91], v253, s[16:19], s38 offen offset:2048 sc1
    buffer_load_dwordx4 v[92:95], v253, s[16:19], s38 offen offset:3072 sc1
    s_cmp_lg_u32 s33, 0
    s_cbranch_scc1 P_lp_done
    s_mov_b64 exec, 1
P_lp:
    buffer_load_dword v164, v250, s[24:27], s40 offen sc1
    s_waitcnt vmcnt(0)
    v_cmp_eq_u32 vcc, -1, v164
    s_cbranch_vccz P_lp_ok
    s_sleep 12
    s_sub_u32 s44, s44, 1
    s_cbranch_scc0 P_lp
    s_branch M_done2
P_lp_ok:
    s_mov_b64 exec, -1
P_lp_done:
    s_barrier
P_at_poll:
    buffer_load_dwordx4 v[48:51], v250, s[20:23], s39 offen offset:0 sc1
    buffer_load_dwordx4 v[52:55], v250, s[20:23], s39 offen offset:1024 sc1
    buffer_load_dwordx4 v[56:59], v250, s[20:23], s39 offen offset:2048 sc1
    buffer_load_dwordx4 v[60:63], v250, s[20:23], s39 offen offset:3072 sc1
    s_mov_b32 exec_lo, 0
    buffer_load_dwordx4 v[96:99], v249, s[24:27], s40 offen offset:0 sc1
    buffer_load_dwordx4 v[100:103], v249, s[24:27], s40 offen offset:512 sc1
    buffer_load_dwordx4 v[104:107], v249, s[24:27], s40 offen offset:1024 sc1
    buffer_load_dwordx4 v[108:111], v249, s[24:27], s40 offen offset:1536 sc1
    s_mov_b32 exec_lo, -1
    s_waitcnt vmcnt(0)
    v_max3_u32 v164, v48, v49, v50
    v_max3_u32 v164, v164, v51, v52
    v_max3_u32 v164, v164, v53, v54
    v_max3_u32 v164, v164, v55, v56
    v_max3_u32 v164, v164, v57, v58
    v_max3_u32 v164, v164, v59, v60
    v_max3_u32 v164, v164, v61, v62
    v_max3_u32 v164, v164, v63, v96
    v_max3_u32 v164, v164, v97, v98
    v_max3_u32 v164, v164, v99, v100
    v_max3_u32 v164, v164, v101, v102
    v_max3_u32 v164, v164, v103, v104
    v_max3_u32 v164, v164, v105, v106
    v_max3_u32 v164, v164, v107, v108
    v_max3_u32 v164, v164, v109, v110
    v_max_u32 v164, v164, v111
    v_cmp_eq_u32 vcc, -1, v164
    s_cbranch_vccz P_at_ok
    s_sleep 2
    s_sub_u32 s44, s44, 1
    s_cbranch_scc0 P_at_poll
    s_branch M_done2
P_at_ok:
    s_cmp_eq_u32 s52, 1
    s_cbranch_scc1 P_q1
    v_mfma_f32_16x16x32_bf16 v[112:115], v[16:19], v[0:3], v[244:247]
    v_mfma_f32_16x16x32_bf16 v[120:123], v[48:51], v[0:3], v[240:243]
    v_mfma_f32_16x16x32_bf16 v[112:115], v[20:23], v[4:7], v[112:115]
    v_mfma_f32_16x16x32_bf16 v[120:123], v[52:55], v[4:7], v[120:123]
    v_mfma_f32_16x16x32_bf16 v[112:115], v[24:27], v[8:11], v[112:115]
    v_mfma_f32_16x16x32_bf16 v[120:123], v[56:59], v[8:11], v[120:123]
    v_mfma_f32_16x16x32_bf16 v[112:115], v[28:31], v[12:15], v[112:115]
    v_mfma_f32_16x16x32_bf16 v[120:123], v[60:63], v[12:15], v[120:123]
    s_nop 7
    v_max3_f32 v164, v112, v113, v114
    v_max3_f32 v164, v164, v115, v120
    v_max3_f32 v164, v164, v121, v122
    v_max_f32 v164, v164, v123
    v_mov_b32 v165, v164
    s_nop 1
    v_permlane32_swap_b32 v164, v165
    v_max_f32 v164, v164, v165
    v_mov_b32 v165, v164
    s_nop 1
    v_permlane16_swap_b32 v164, v165
    v_max_f32 v164, v164, v165
    v_mul_f32 v164, s41, v164
    v_fma_f32 v112, v112, s41, -v164
    v_fma_f32 v113, v113, s41, -v164
    v_fma_f32 v114, v114, s41, -v164
    v_fma_f32 v115, v115, s41, -v164
    v_fma_f32 v120, v120, s41, -v164
    v_fma_f32 v121, v121, s41, -v164
    v_fma_f32 v122, v122, s41, -v164
    v_fma_f32 v123, v123, s41, -v164
    v_exp_f32 v112, v112
    v_exp_f32 v113, v113
    v_exp_f32 v114, v114
    v_exp_f32 v115, v115
    v_exp_f32 v120, v120
    v_exp_f32 v121, v121
    v_exp_f32 v122, v122
    v_exp_f32 v123, v123
    v_cvt_pk_bf16_f32 v124, v112, v113
    v_cvt_pk_bf16_f32 v125, v114, v115
    v_mov_b32 v126, 0
    v_mov_b32 v127, 0
    v_cvt_pk_bf16_f32 v128, v120, v121
    v_cvt_pk_bf16_f32 v129, v122, v123
    v_add_f32 v166, v112, v113
    v_add_f32 v166, v166, v114
    v_add_f32 v166, v166, v115
    v_add_f32 v166, v166, v120
    v_add_f32 v166, v166, v121
    v_add_f32 v166, v166, v122
    v_add_f32 v166, v166, v123
    s_branch P_pv
P_q1:
    v_mfma_f32_16x16x32_bf16 v[112:115], v[16:19], v[0:3], 0
    v_mfma_f32_16x16x32_bf16 v[116:119], v[32:35], v[0:3], v[244:247]
    v_mfma_f32_16x16x32_bf16 v[120:123], v[48:51], v[0:3], v[240:243]
    v_mfma_f32_16x16x32_bf16 v[112:115], v[20:23], v[4:7], v[112:115]
    v_mfma_f32_16x16x32_bf16 v[116:119], v[36:39], v[4:7], v[116:119]
    v_mfma_f32_16x16x32_bf16 v[120:123], v[52:55], v[4:7], v[120:123]
    v_mfma_f32_16x16x32_bf16 v[112:115], v[24:27], v[8:11], v[112:115]
    v_mfma_f32_16x16x32_bf16 v[116:119], v[40:43], v[8:11], v[116:119]
    v_mfma_f32_16x16x32_bf16 v[120:123], v[56:59], v[8:11], v[120:123]
    v_mfma_f32_16x16x32_bf16 v[112:115], v[28:31], v[12:15], v[112:115]
    v_mfma_f32_16x16x32_bf16 v[116:119], v[44:47], v[12:15], v[116:119]
    v_mfma_f32_16x16x32_bf16 v[120:123], v[60:63], v[12:15], v[120:123]
    s_nop 7
    v_max3_f32 v164, v112, v113, v114
    v_max3_f32 v164, v164, v115, v116
    v_max3_f32 v164, v164, v117, v118
    v_max3_f32 v164, v164, v119, v120
    v_max3_f32 v164, v164, v121, v122
    v_max_f32 v164, v164, v123
    v_mov_b32 v165, v164
    s_nop 1
    v_permlane32_swap_b32 v164, v165
    v_max_f32 v164, v164, v165
    v_mov_b32 v165, v164
    s_nop 1
    v_permlane16_swap_b32 v164, v165
    v_max_f32 v164, v164, v165
    v_mul_f32 v164, s41, v164
    v_fma_f32 v112, v112, s41, -v164
    v_fma_f32 v113, v113, s41, -v164
    v_fma_f32 v114, v114, s41, -v164
    v_fma_f32 v115, v115, s41, -v164
    v_fma_f32 v116, v116, s41, -v164
    v_fma_f32 v117, v117, s41, -v164
    v_fma_f32 v118, v118, s41, -v164
    v_fma_f32 v119, v119, s41, -v164
    v_fma_f32 v120, v120, s41, -v164
    v_fma_f32 v121, v121, s41, -v164
    v_fma_f32 v122, v122, s41, -v164
    v_fma_f32 v123, v123, s41, -v164
    v_exp_f32 v112, v112
    v_exp_f32 v113, v113
    v_exp_f32 v114, v114
    v_exp_f32 v115, v115
    v_exp_f32 v116, v116
    v_exp_f32 v117, v117
    v_exp_f32 v118, v118
    v_exp_f32 v119, v119
    v_exp_f32 v120, v120
    v_exp_f32 v121, v121
    v_exp_f32 v122, v122
    v_exp_f32 v123, v123
    v_cvt_pk_bf16_f32 v124, v112, v113
    v_cvt_pk_bf16_f32 v125, v114, v115
    v_cvt_pk_bf16_f32 v126, v116, v117
    v_cvt_pk_bf16_f32 v127, v118, v119
    v_cvt_pk_bf16_f32 v128, v120, v121
    v_cvt_pk_bf16_f32 v129, v122, v123
    v_add_f32 v166, v112, v113
    v_add_f32 v166, v166, v114
    v_add_f32 v166, v166, v115
    v_add_f32 v166, v166, v116
    v_add_f32 v166, v166, v117
    v_add_f32 v166, v166, v118
    v_add_f32 v166, v166, v119
    v_add_f32 v166, v166, v120
    v_add_f32 v166, v166, v121
    v_add_f32 v166, v166, v122
    v_add_f32 v166, v166, v123
P_pv:
    v_mfma_f32_16x16x32_bf16 v[132:135], v[64:67], v[124:127], 0
    v_mfma_f32_16x16x32_bf16 v[136:139], v[68:71], v[124:127], 0
    v_mfma_f32_16x16x32_bf16 v[140:143], v[72:75], v[124:127], 0
    v_mfma_f32_16x16x32_bf16 v[144:147], v[76:79], v[124:127], 0
    v_mfma_f32_16x16x32_bf16 v[148:151], v[80:83], v[124:127], 0
    v_mfma_f32_16x16x32_bf16 v[152:155], v[84:87], v[124:127], 0
    v_mfma_f32_16x16x32_bf16 v[156:159], v[88:91], v[124:127], 0
    v_mfma_f32_16x16x32_bf16 v[160:163], v[92:95], v[124:127], 0
    v_mfma_f32_16x16x16_bf16 v[132:135], v[96:97], v[128:129], v[132:135]
    v_mfma_f32_16x16x16_bf16 v[136:139], v[98:99], v[128:129], v[136:139]
    v_mfma_f32_16x16x16_bf16 v[140:143], v[100:101], v[128:129], v[140:143]
    v_mfma_f32_16x16x16_bf16 v[144:147], v[102:103], v[128:129], v[144:147]
    v_mfma_f32_16x16x16_bf16 v[148:151], v[104:105], v[128:129], v[148:151]
    v_mfma_f32_16x16x16_bf16 v[152:155], v[106:107], v[128:129], v[152:155]
    v_mfma_f32_16x16x16_bf16 v[156:159], v[108:109], v[128:129], v[156:159]
    v_mfma_f32_16x16x16_bf16 v[160:163], v[110:111], v[128:129], v[160:163]
    v_mov_b32 v165, v166
    s_nop 1
    v_permlane32_swap_b32 v166, v165
    v_add_f32 v166, v166, v165
    v_mov_b32 v165, v166
    s_nop 1
    v_permlane16_swap_b32 v166, v165
    v_add_f32 v166, v166, v165
    v_rcp_f32 v166, v166
    s_nop 0
    v_mul_f32 v132, v132, v166
    v_mul_f32 v133, v133, v166
    v_mul_f32 v134, v134, v166
    v_mul_f32 v135, v135, v166
    v_mul_f32 v136, v136, v166
    v_mul_f32 v137, v137, v166
    v_mul_f32 v138, v138, v166
    v_mul_f32 v139, v139, v166
    v_cvt_pk_bf16_f32 v132, v132, v133
    v_cvt_pk_bf16_f32 v133, v134, v135
    v_cvt_pk_bf16_f32 v134, v136, v137
    v_cvt_pk_bf16_f32 v135, v138, v139
    buffer_store_dwordx4 v[132:135], v250, s[28:31], s37 offen offset:0 sc1
    v_mul_f32 v140, v140, v166
    v_mul_f32 v141, v141, v166
    v_mul_f32 v142, v142, v166
    v_mul_f32 v143, v143, v166
    v_mul_f32 v144, v144, v166
    v_mul_f32 v145, v145, v166
    v_mul_f32 v146, v146, v166
    v_mul_f32 v147, v147, v166
    v_cvt_pk_bf16_f32 v140, v140, v141
    v_cvt_pk_bf16_f32 v141, v142, v143
    v_cvt_pk_bf16_f32 v142, v144, v145
    v_cvt_pk_bf16_f32 v143, v146, v147
    buffer_store_dwordx4 v[140:143], v250, s[28:31], s37 offen offset:1024 sc1
    v_mul_f32 v148, v148, v166
    v_mul_f32 v149, v149, v166
    v_mul_f32 v150, v150, v166
    v_mul_f32 v151, v151, v166
    v_mul_f32 v152, v152, v166
    v_mul_f32 v153, v153, v166
    v_mul_f32 v154, v154, v166
    v_mul_f32 v155, v155, v166
    v_cvt_pk_bf16_f32 v148, v148, v149
    v_cvt_pk_bf16_f32 v149, v150, v151
    v_cvt_pk_bf16_f32 v150, v152, v153
    v_cvt_pk_bf16_f32 v151, v154, v155
    buffer_store_dwordx4 v[148:151], v250, s[28:31], s37 offen offset:2048 sc1
    v_mul_f32 v156, v156, v166
    v_mul_f32 v157, v157, v166
    v_mul_f32 v158, v158, v166
    v_mul_f32 v159, v159, v166
    v_mul_f32 v160, v160, v166
    v_mul_f32 v161, v161, v166
    v_mul_f32 v162, v162, v166
    v_mul_f32 v163, v163, v166
    v_cvt_pk_bf16_f32 v156, v156, v157
    v_cvt_pk_bf16_f32 v157, v158, v159
    v_cvt_pk_bf16_f32 v158, v160, v161
    v_cvt_pk_bf16_f32 v159, v162, v163
    buffer_store_dwordx4 v[156:159], v250, s[28:31], s37 offen offset:3072 sc1
    s_add_u32 s73, s72, 208
    s_waitcnt vmcnt(0)
    s_barrier
    s_cmp_lg_u32 s33, 0
    s_cbranch_scc1 FA_27
    s_mov_b64 exec, 1
    s_lshl_b32 s3, s73, 7
    v_mov_b32 v254, 0
    v_mov_b32 v255, 1
    buffer_atomic_add v255, v254, s[76:79], s3 offen
    s_mov_b64 exec, -1
FA_27:
    s_add_u32 s72, s72, 4
    s_cmp_lt_u32 s72, 64
    s_cbranch_scc1 P_loopA
    s_branch M_done2
P_loopS:
    s_add_u32 s16, s6, 0x3c00000
    s_addc_u32 s17, s7, 0
    s_mov_b32 s18, 0x1000000
    s_mov_b32 s19, 0x20000
    s_lshr_b32 s74, s72, 2
    s_add_u32 s74, s74, 288
    s_cmp_lg_u32 s33, 0
    s_cbranch_scc1 FK_29
    s_lshl_b32 s3, s74, 7
    v_mov_b32 v254, 0
FW_28:
    buffer_load_dword v255, v254, s[76:79], s3 offen sc1
    s_waitcnt vmcnt(0)
    v_readfirstlane_b32 s75, v255
    s_cmp_ge_u32 s75, 8
    s_cbranch_scc1 FK_29
    s_sleep 16
    s_sub_u32 s44, s44, 1
    s_cbranch_scc0 FW_28
    s_branch M_done2
FK_29:
    s_barrier
    s_add_u32 s74, s72, 208
    s_cmp_lg_u32 s33, 0
    s_cbranch_scc1 FK_31
    s_lshl_b32 s3, s74, 7
    v_mov_b32 v254, 0
FW_30:
    buffer_load_dword v255, v254, s[76:79], s3 offen sc1
    s_waitcnt vmcnt(0)
    v_readfirstlane_b32 s75, v255
    s_cmp_ge_u32 s75, 8
    s_cbranch_scc1 FK_31
    s_sleep 4
    s_sub_u32 s44, s44, 1
    s_cbranch_scc0 FW_30
    s_branch M_done2
FK_31:
    s_barrier
    s_lshl_b32 s40, s72, 18
    s_lshl_b32 s3, s33, 14
    s_add_u32 s40, s40, s3
    v_add_u32 v252, 0x20000, v250
    s_lshl_b32 s3, s33, 14
    v_add_u32 v248, s3, v250
    buffer_load_dwordx4 v[0:3], v250, s[16:19], s40 offen offset:0 sc1
    buffer_load_dwordx4 v[4:7], v252, s[16:19], s40 offen offset:0 sc1
    buffer_load_dwordx4 v[8:11], v250, s[16:19], s40 offen offset:1024 sc1
    buffer_load_dwordx4 v[12:15], v252, s[16:19], s40 offen offset:1024 sc1
    buffer_load_dwordx4 v[16:19], v250, s[16:19], s40 offen offset:2048 sc1
    buffer_load_dwordx4 v[20:23], v252, s[16:19], s40 offen offset:2048 sc1
    buffer_load_dwordx4 v[24:27], v250, s[16:19], s40 offen offset:3072 sc1
    buffer_load_dwordx4 v[28:31], v252, s[16:19], s40 offen offset:3072 sc1
    s_add_u32 s40, s40, 4096
    buffer_load_dwordx4 v[32:35], v250, s[16:19], s40 offen offset:0 sc1
    buffer_load_dwordx4 v[36:39], v252, s[16:19], s40 offen offset:0 sc1
    buffer_load_dwordx4 v[40:43], v250, s[16:19], s40 offen offset:1024 sc1
    buffer_load_dwordx4 v[44:47], v252, s[16:19], s40 offen offset:1024 sc1
    buffer_load_dwordx4 v[48:51], v250, s[16:19], s40 offen offset:2048 sc1
    buffer_load_dwordx4 v[52:55], v252, s[16:19], s40 offen offset:2048 sc1
    buffer_load_dwordx4 v[56:59], v250, s[16:19], s40 offen offset:3072 sc1
    buffer_load_dwordx4 v[60:63], v252, s[16:19], s40 offen offset:3072 sc1
    s_add_u32 s40, s40, 4096
    buffer_load_dwordx4 v[176:179], v250, s[16:19], s40 offen offset:0 sc1
    buffer_load_dwordx4 v[180:183], v252, s[16:19], s40 offen offset:0 sc1
    buffer_load_dwordx4 v[184:187], v250, s[16:19], s40 offen offset:1024 sc1
    buffer_load_dwordx4 v[188:191], v252, s[16:19], s40 offen offset:1024 sc1
    buffer_load_dwordx4 v[192:195], v250, s[16:19], s40 offen offset:2048 sc1
    buffer_load_dwordx4 v[196:199], v252, s[16:19], s40 offen offset:2048 sc1
    buffer_load_dwordx4 v[200:203], v250, s[16:19], s40 offen offset:3072 sc1
    buffer_load_dwordx4 v[204:207], v252, s[16:19], s40 offen offset:3072 sc1
    s_add_u32 s40, s40, 4096
    buffer_load_dwordx4 v[208:211], v250, s[16:19], s40 offen offset:0 sc1
    buffer_load_dwordx4 v[212:215], v252, s[16:19], s40 offen offset:0 sc1
    buffer_load_dwordx4 v[216:219], v250, s[16:19], s40 offen offset:1024 sc1
    buffer_load_dwordx4 v[220:223], v252, s[16:19], s40 offen offset:1024 sc1
    buffer_load_dwordx4 v[224:227], v250, s[16:19], s40 offen offset:2048 sc1
    buffer_load_dwordx4 v[228:231], v252, s[16:19], s40 offen offset:2048 sc1
    buffer_load_dwordx4 v[232:235], v250, s[16:19], s40 offen offset:3072 sc1
    buffer_load_dwordx4 v[236:239], v252, s[16:19], s40 offen offset:3072 sc1
    s_add_u32 s40, s40, 4096
    s_mov_b32 s24, s68
    s_mov_b32 s25, s69
    s_mov_b32 s26, 0x280000
    s_mov_b32 s27, 0x20000
    s_mov_b32 s28, s82
    s_mov_b32 s29, s83
    s_mov_b32 s30, 0x280000
    s_mov_b32 s31, 0x20000
    s_add_u32 s36, s6, 0x7400000
    s_addc_u32 s37, s7, 0
    s_mov_b32 s38, 0x280000
    s_mov_b32 s39, 0x20000
    ds_read_b128 v[128:131], v248 offset:0
    ds_read_b128 v[132:135], v248 offset:1024
    ds_read_b128 v[136:139], v248 offset:2048
    ds_read_b128 v[140:143], v248 offset:3072
    ds_read_b128 v[144:147], v248 offset:4096
    ds_read_b128 v[148:151], v248 offset:5120
    ds_read_b128 v[152:155], v248 offset:6144
    ds_read_b128 v[156:159], v248 offset:7168
    s_waitcnt lgkmcnt(0)
    s_waitcnt vmcnt(30)
    v_mfma_f32_16x16x32_bf16 v[160:163], v[128:131], v[0:3], 0
    v_mfma_f32_16x16x32_bf16 v[164:167], v[128:131], v[4:7], 0
    v_mfma_f32_16x16x32_bf16 v[168:171], v[64:67], v[0:3], 0
    v_mfma_f32_16x16x32_bf16 v[172:175], v[64:67], v[4:7], 0
    s_waitcnt vmcnt(28)
    v_mfma_f32_16x16x32_bf16 v[160:163], v[132:135], v[8:11], v[160:163]
    v_mfma_f32_16x16x32_bf16 v[164:167], v[132:135], v[12:15], v[164:167]
    v_mfma_f32_16x16x32_bf16 v[168:171], v[68:71], v[8:11], v[168:171]
    v_mfma_f32_16x16x32_bf16 v[172:175], v[68:71], v[12:15], v[172:175]
    s_waitcnt vmcnt(26)
    v_mfma_f32_16x16x32_bf16 v[160:163], v[136:139], v[16:19], v[160:163]
    v_mfma_f32_16x16x32_bf16 v[164:167], v[136:139], v[20:23], v[164:167]
    v_mfma_f32_16x16x32_bf16 v[168:171], v[72:75], v[16:19], v[168:171]
    v_mfma_f32_16x16x32_bf16 v[172:175], v[72:75], v[20:23], v[172:175]
    s_waitcnt vmcnt(24)
    v_mfma_f32_16x16x32_bf16 v[160:163], v[140:143], v[24:27], v[160:163]
    v_mfma_f32_16x16x32_bf16 v[164:167], v[140:143], v[28:31], v[164:167]
    v_mfma_f32_16x16x32_bf16 v[168:171], v[76:79], v[24:27], v[168:171]
    v_mfma_f32_16x16x32_bf16 v[172:175], v[76:79], v[28:31], v[172:175]
    s_waitcnt vmcnt(22)
    v_mfma_f32_16x16x32_bf16 v[160:163], v[144:147], v[32:35], v[160:163]
    v_mfma_f32_16x16x32_bf16 v[164:167], v[144:147], v[36:39], v[164:167]
    v_mfma_f32_16x16x32_bf16 v[168:171], v[80:83], v[32:35], v[168:171]
    v_mfma_f32_16x16x32_bf16 v[172:175], v[80:83], v[36:39], v[172:175]
    s_waitcnt vmcnt(20)
    v_mfma_f32_16x16x32_bf16 v[160:163], v[148:151], v[40:43], v[160:163]
    v_mfma_f32_16x16x32_bf16 v[164:167], v[148:151], v[44:47], v[164:167]
    v_mfma_f32_16x16x32_bf16 v[168:171], v[84:87], v[40:43], v[168:171]
    v_mfma_f32_16x16x32_bf16 v[172:175], v[84:87], v[44:47], v[172:175]
    s_waitcnt vmcnt(18)
    v_mfma_f32_16x16x32_bf16 v[160:163], v[152:155], v[48:51], v[160:163]
    v_mfma_f32_16x16x32_bf16 v[164:167], v[152:155], v[52:55], v[164:167]
    v_mfma_f32_16x16x32_bf16 v[168:171], v[88:91], v[48:51], v[168:171]
    v_mfma_f32_16x16x32_bf16 v[172:175], v[88:91], v[52:55], v[172:175]
    s_waitcnt vmcnt(16)
    v_mfma_f32_16x16x32_bf16 v[160:163], v[156:159], v[56:59], v[160:163]
    v_mfma_f32_16x16x32_bf16 v[164:167], v[156:159], v[60:63], v[164:167]
    v_mfma_f32_16x16x32_bf16 v[168:171], v[92:95], v[56:59], v[168:171]
    v_mfma_f32_16x16x32_bf16 v[172:175], v[92:95], v[60:63], v[172:175]
    ds_read_b128 v[128:131], v248 offset:8192
    ds_read_b128 v[132:135], v248 offset:9216
    ds_read_b128 v[136:139], v248 offset:10240
    ds_read_b128 v[140:143], v248 offset:11264
    ds_read_b128 v[144:147], v248 offset:12288
    ds_read_b128 v[148:151], v248 offset:13312
    ds_read_b128 v[152:155], v248 offset:14336
    ds_read_b128 v[156:159], v248 offset:15360
    s_waitcnt lgkmcnt(0)
    s_waitcnt vmcnt(14)
    v_mfma_f32_16x16x32_bf16 v[160:163], v[128:131], v[176:179], v[160:163]
    v_mfma_f32_16x16x32_bf16 v[164:167], v[128:131], v[180:183], v[164:167]
    v_mfma_f32_16x16x32_bf16 v[168:171], v[96:99], v[176:179], v[168:171]
    v_mfma_f32_16x16x32_bf16 v[172:175], v[96:99], v[180:183], v[172:175]
    s_waitcnt vmcnt(12)
    v_mfma_f32_16x16x32_bf16 v[160:163], v[132:135], v[184:187], v[160:163]
    v_mfma_f32_16x16x32_bf16 v[164:167], v[132:135], v[188:191], v[164:167]
    v_mfma_f32_16x16x32_bf16 v[168:171], v[100:103], v[184:187], v[168:171]
    v_mfma_f32_16x16x32_bf16 v[172:175], v[100:103], v[188:191], v[172:175]
    s_waitcnt vmcnt(10)
    v_mfma_f32_16x16x32_bf16 v[160:163], v[136:139], v[192:195], v[160:163]
    v_mfma_f32_16x16x32_bf16 v[164:167], v[136:139], v[196:199], v[164:167]
    v_mfma_f32_16x16x32_bf16 v[168:171], v[104:107], v[192:195], v[168:171]
    v_mfma_f32_16x16x32_bf16 v[172:175], v[104:107], v[196:199], v[172:175]
    s_waitcnt vmcnt(8)
    v_mfma_f32_16x16x32_bf16 v[160:163], v[140:143], v[200:203], v[160:163]
    v_mfma_f32_16x16x32_bf16 v[164:167], v[140:143], v[204:207], v[164:167]
    v_mfma_f32_16x16x32_bf16 v[168:171], v[108:111], v[200:203], v[168:171]
    v_mfma_f32_16x16x32_bf16 v[172:175], v[108:111], v[204:207], v[172:175]
    s_waitcnt vmcnt(6)
    v_mfma_f32_16x16x32_bf16 v[160:163], v[144:147], v[208:211], v[160:163]
    v_mfma_f32_16x16x32_bf16 v[164:167], v[144:147], v[212:215], v[164:167]
    v_mfma_f32_16x16x32_bf16 v[168:171], v[112:115], v[208:211], v[168:171]
    v_mfma_f32_16x16x32_bf16 v[172:175], v[112:115], v[212:215], v[172:175]
    s_waitcnt vmcnt(4)
    v_mfma_f32_16x16x32_bf16 v[160:163], v[148:151], v[216:219], v[160:163]
    v_mfma_f32_16x16x32_bf16 v[164:167], v[148:151], v[220:223], v[164:167]
    v_mfma_f32_16x16x32_bf16 v[168:171], v[116:119], v[216:219], v[168:171]
    v_mfma_f32_16x16x32_bf16 v[172:175], v[116:119], v[220:223], v[172:175]
    s_waitcnt vmcnt(2)
    v_mfma_f32_16x16x32_bf16 v[160:163], v[152:155], v[224:227], v[160:163]
    v_mfma_f32_16x16x32_bf16 v[164:167], v[152:155], v[228:231], v[164:167]
    v_mfma_f32_16x16x32_bf16 v[168:171], v[120:123], v[224:227], v[168:171]
    v_mfma_f32_16x16x32_bf16 v[172:175], v[120:123], v[228:231], v[172:175]
    s_waitcnt vmcnt(0)
    v_mfma_f32_16x16x32_bf16 v[160:163], v[156:159], v[232:235], v[160:163]
    v_mfma_f32_16x16x32_bf16 v[164:167], v[156:159], v[236:239], v[164:167]
    v_mfma_f32_16x16x32_bf16 v[168:171], v[124:127], v[232:235], v[168:171]
    v_mfma_f32_16x16x32_bf16 v[172:175], v[124:127], v[236:239], v[172:175]
    s_lshl_b32 s3, s33, 10
    s_add_u32 s3, s3, 131072
    v_add_u32 v0, s3, v250
    s_nop 4
    s_barrier
    ds_write_b128 v0, v[160:163] offset:0
    ds_write_b128 v0, v[164:167] offset:8192
    ds_write_b128 v0, v[168:171] offset:16384
    ds_write_b128 v0, v[172:175] offset:24576
    s_waitcnt lgkmcnt(0)
    s_barrier
    s_cmp_ge_u32 s33, 4
    s_cbranch_scc1 P_next
    s_lshl_b32 s3, s33, 13
    s_add_u32 s3, s3, 131072
    v_add_u32 v0, s3, v250
    ds_read_b128 v[16:19], v0 offset:0
    ds_read_b128 v[20:23], v0 offset:1024
    ds_read_b128 v[24:27], v0 offset:2048
    ds_read_b128 v[28:31], v0 offset:3072
    ds_read_b128 v[32:35], v0 offset:4096
    ds_read_b128 v[36:39], v0 offset:5120
    ds_read_b128 v[40:43], v0 offset:6144
    ds_read_b128 v[44:47], v0 offset:7168
    s_lshr_b32 s57, s33, 1
    s_add_u32 s57, s57, s58
    s_and_b32 s56, s33, 1
    v_and_b32 v4, 15, v251
    v_lshrrev_b32 v5, 4, v251
    v_lshlrev_b32 v5, 3, v5
    v_mul_u32_u24 v4, 1280, v4
    v_add_u32 v4, v4, v5
    v_lshlrev_b32 v6, 3, v251
    s_lshl_b32 s3, s72, 1
    s_add_u32 s3, s3, s56
    s_mul_i32 s35, s3, 40
    s_add_u32 s35, s35, s57
    s_lshl_b32 s35, s35, 9
    s_mul_i32 s3, s3, 20480
    s_lshl_b32 s34, s57, 5
    s_add_u32 s3, s3, s34
    buffer_load_dwordx2 v[8:9], v4, s[24:27], s3 offen
    buffer_load_dwordx2 v[10:11], v6, s[36:39], s35 offen sc1
    s_waitcnt lgkmcnt(0)
    v_add_f32 v12, v16, v20
    v_add_f32 v12, v12, v24
    v_add_f32 v12, v12, v28
    v_add_f32 v12, v12, v32
    v_add_f32 v12, v12, v36
    v_add_f32 v12, v12, v40
    v_add_f32 v12, v12, v44
    v_add_f32 v13, v17, v21
    v_add_f32 v13, v13, v25
    v_add_f32 v13, v13, v29
    v_add_f32 v13, v13, v33
    v_add_f32 v13, v13, v37
    v_add_f32 v13, v13, v41
    v_add_f32 v13, v13, v45
    v_add_f32 v14, v18, v22
    v_add_f32 v14, v14, v26
    v_add_f32 v14, v14, v30
    v_add_f32 v14, v14, v34
    v_add_f32 v14, v14, v38
    v_add_f32 v14, v14, v42
    v_add_f32 v14, v14, v46
    v_add_f32 v15, v19, v23
    v_add_f32 v15, v15, v27
    v_add_f32 v15, v15, v31
    v_add_f32 v15, v15, v35
    v_add_f32 v15, v15, v39
    v_add_f32 v15, v15, v43
    v_add_f32 v15, v15, v47
    s_waitcnt vmcnt(0)
    v_lshlrev_b32 v16, 16, v10
    v_and_b32 v17, 0xffff0000, v10
    v_cvt_pk_bf16_f32 v20, v12, v13
    v_lshlrev_b32 v18, 16, v20
    v_and_b32 v19, 0xffff0000, v20
    v_mul_f32 v16, v16, v18
    v_mul_f32 v17, v17, v19
    v_cvt_pk_bf16_f32 v20, v16, v17
    v_lshlrev_b32 v16, 16, v20
    v_and_b32 v17, 0xffff0000, v20
    v_lshlrev_b32 v18, 16, v8
    v_and_b32 v19, 0xffff0000, v8
    v_add_f32 v16, v16, v18
    v_add_f32 v17, v17, v19
    v_cvt_pk_bf16_f32 v24, v16, v17
    v_lshlrev_b32 v16, 16, v11
    v_and_b32 v17, 0xffff0000, v11
    v_cvt_pk_bf16_f32 v20, v14, v15
    v_lshlrev_b32 v18, 16, v20
    v_and_b32 v19, 0xffff0000, v20
    v_mul_f32 v16, v16, v18
    v_mul_f32 v17, v17, v19
    v_cvt_pk_bf16_f32 v20, v16, v17
    v_lshlrev_b32 v16, 16, v20
    v_and_b32 v17, 0xffff0000, v20
    v_lshlrev_b32 v18, 16, v9
    v_and_b32 v19, 0xffff0000, v9
    v_add_f32 v16, v16, v18
    v_add_f32 v17, v17, v19
    v_cvt_pk_bf16_f32 v25, v16, v17
    buffer_store_dwordx2 v[24:25], v4, s[28:31], s3 offen
P_next:
    s_add_u32 s72, s72, 4
    s_cmp_lt_u32 s72, 64
    s_cbranch_scc1 P_loopS
M_done2:
    s_endpgm
.section .rodata,"a"
.p2align 6
.amdhsa_kernel ln_init_kernel
  .amdhsa_next_free_vgpr 88
  .amdhsa_next_free_sgpr 102
  .amdhsa_accum_offset 88
  .amdhsa_group_segment_fixed_size 0
  .amdhsa_kernarg_size 120
  .amdhsa_user_sgpr_count 2
  .amdhsa_user_sgpr_kernarg_segment_ptr 1
  .amdhsa_system_sgpr_workgroup_id_x 1
  .amdhsa_float_denorm_mode_32 3
.end_amdhsa_kernel
.section .rodata,"a"
.p2align 6
.amdhsa_kernel mega_kernel
  .amdhsa_next_free_vgpr 256
  .amdhsa_next_free_sgpr 102
  .amdhsa_accum_offset 256
  .amdhsa_group_segment_fixed_size 0
  .amdhsa_kernarg_size 120
  .amdhsa_user_sgpr_count 2
  .amdhsa_user_sgpr_kernarg_segment_ptr 1
  .amdhsa_system_sgpr_workgroup_id_x 1
  .amdhsa_float_denorm_mode_32 3
.end_amdhsa_kernel
```
